```python
import torch

def _softmax(x, axis=-1):
    return torch.softmax(x, dim=axis)
def _gelu(x):
    return torch.nn.functional.gelu(x, approximate="tanh")
def _silu(x):
    return torch.nn.functional.silu(x)
def _sigmoid(x):
    return torch.sigmoid(x)
def _layernorm(x, axis=-1, eps=1e-5):
    m = x.mean(dim=axis, keepdim=True)
    v = x.var(dim=axis, keepdim=True, unbiased=False)
    return (x - m) / torch.sqrt(v + eps)
def _scatter_add(tgt, idx, src, axis=0):
    return tgt.clone().index_add_(axis, idx, src)
def _segment_sum(src, seg, n):
    out = torch.zeros((n,) + src.shape[1:], dtype=src.dtype)
    return out.index_add_(0, seg, src)
def _pad(x, pw):
    flat = tuple(v for pair in reversed(pw) for v in pair)
    return torch.nn.functional.pad(x, flat)

kernel_name = 'parallel_sum__grouped_kv_mqa__swiglu_ffn__prompt'

def setup_inputs():

    _w = (lambda a: (lambda t: t.to(torch.bfloat16) if t.is_floating_point() else t)(torch.as_tensor(a)))
    def _A_setup():
        B, S, D, H = 1, 2048, 640, 32
        Dh = D // H
        return {
            "x": _w((lambda *s: torch.randn(*s, dtype=torch.bfloat16) * 0.05)(B, S, D)),
            "wq": _w((lambda *s: torch.randn(*s, dtype=torch.bfloat16) * 0.2)(D, H * Dh)),
            "wk": _w((lambda *s: torch.randn(*s, dtype=torch.bfloat16) * 0.2)(D, Dh)),
            "wv": _w((lambda *s: torch.randn(*s, dtype=torch.bfloat16) * 0.1)(D, Dh)),
            "wo": _w((lambda *s: torch.randn(*s, dtype=torch.bfloat16) * 0.1)(H * Dh, D)),
        }
    _A_in = _A_setup()

    def _B_setup():
        B, S, D, F = 1, 2048, 640, 1536
        return {
            "x": _w((lambda *s: torch.randn(*s, dtype=torch.bfloat16) * 0.05)(B, S, D)),
            "w_gate": _w((lambda *s: torch.randn(*s, dtype=torch.bfloat16) * 0.1)(D, F)),
            "w_up": _w((lambda *s: torch.randn(*s, dtype=torch.bfloat16) * 0.1)(D, F)),
            "w_down": _w((lambda *s: torch.randn(*s, dtype=torch.bfloat16) * 0.1)(F, D)),
        }
    _B_in = _B_setup()

    return {
        "A_x": _A_in["x"],
        "A_wq": _A_in["wq"],
        "A_wk": _A_in["wk"],
        "A_wv": _A_in["wv"],
        "A_wo": _A_in["wo"],
        "B_x": _B_in["x"],
        "B_w_gate": _B_in["w_gate"],
        "B_w_up": _B_in["w_up"],
        "B_w_down": _B_in["w_down"],
    }

def reference(A_x, A_wq, A_wk, A_wv, A_wo, B_x, B_w_gate, B_w_up, B_w_down):
    def _A_ref(x, wq, wk, wv, wo):
        B, S, D = x.shape
        H = 32
        Dh = D // H
        q = (lambda x, *d: x.permute(*d))((x @ wq).reshape(B, S, H, Dh), 0, 2, 1, 3)
        k = x @ wk
        v = x @ wv
        scores = torch.einsum("bhqd,bkd->bhqk", q, k) * (Dh ** -0.5)
        p = _softmax(scores, axis=-1)
        o = torch.einsum("bhqk,bkd->bhqd", p, v)
        return (lambda x, *d: x.permute(*d))(o, 0, 2, 1, 3).reshape(B, S, H * Dh) @ wo

    def _B_ref(x, w_gate, w_up, w_down):
        g = _silu(x @ w_gate)
        u = x @ w_up
        return (g * u) @ w_down

    x = A_x
    xn = _layernorm(x, axis=-1)
    return x + _A_ref(xn, A_wq, A_wk, A_wv, A_wo) + _B_ref(xn, B_w_gate, B_w_up, B_w_down)
```

```asm
; @launch grid=(256,1,1) block=(512,1,1) lds=159872
.amdgcn_target "amdgcn-amd-amdhsa--gfx950"
.text
.globl parallel_sum__grouped_kv_mqa__swiglu_ffn__prompt_kernel
.p2align 8
.type parallel_sum__grouped_kv_mqa__swiglu_ffn__prompt_kernel,@function
parallel_sum__grouped_kv_mqa__swiglu_ffn__prompt_kernel:
    s_cmp_ge_u32 s2, 256
    s_cbranch_scc1 k_end
    s_load_dwordx16 s[40:55], s[0:1], 0
    s_load_dwordx8 s[56:63], s[0:1], 64
    v_and_b32 v1, 63, v0
    v_lshrrev_b32 v6, 6, v0
    v_lshlrev_b32 v2, 4, v1
    v_readfirstlane_b32 s28, v6
    v_lshlrev_b32 v3, 3, v1
    s_and_b32 s29, s2, 1
    s_lshl_b32 s29, s29, 3
    s_bfe_u32 s38, s2, 0x30003
    s_add_u32 s29, s29, s38
    s_lshr_b32 s31, s2, 6
    s_bfe_u32 s30, s2, 0x20001
    s_lshl_b32 s70, s28, 11
    s_lshl_b32 s71, s28, 10
    s_cmp_eq_u32 s31, 0
    s_cbranch_scc1 ab_q
    s_mul_i32 s30, s30, 3
    s_add_u32 s30, s30, s31
    s_sub_u32 s30, s30, 1
    s_lshl_b32 s69, s30, 8
    s_cmp_ge_u32 s28, 4
    s_cbranch_scc1 ab_cF
    s_lshl_b32 s70, s28, 12
    s_lshl_b32 s71, s28, 11
    v_lshrrev_b32 v6, 3, v1
    s_lshl_b32 s36, s28, 5
    s_lshl_b32 s37, s29, 7
    s_add_u32 s36, s36, s37
    v_add_u32 v7, s36, v6
    v_mul_u32_u24 v7, 1280, v7
    v_lshrrev_b32 v6, 4, v1
    v_and_b32 v8, 7, v1
    v_xor_b32 v8, v8, v6
    v_lshl_add_u32 v96, v8, 4, v7
    v_xor_b32 v97, 64, v96
    v_add_u32 v97, 9216, v97
    s_lshl_b32 s36, s28, 4
    v_add_u32 v7, s36, v6
    v_mul_u32_u24 v7, 3072, v7
    v_lshlrev_b32 v6, 2, v6
    v_and_b32 v8, 15, v1
    v_xor_b32 v8, v8, v6
    v_lshl_add_u32 v98, v8, 4, v7
    v_add_u32 v98, s69, v98
    v_xor_b32 v99, 32, v98
    s_waitcnt lgkmcnt(0)
    s_mov_b32 s4, s40
    s_and_b32 s5, s41, 0xffff
    s_mov_b32 s6, 2621440
    s_mov_b32 s7, 0x00020000
    s_mov_b32 s8, s52
    s_and_b32 s9, s53, 0xffff
    s_mov_b32 s10, 1966080
    s_mov_b32 s11, 0x00020000
    s_mov_b32 s12, s54
    s_and_b32 s13, s55, 0xffff
    s_mov_b32 s14, 1966080
    s_mov_b32 s15, 0x00020000
    s_add_u32 m0, s70, 0
    s_mov_b32 s32, 0
    buffer_load_dwordx4 v96, s[4:7], s32 offen offset:0 lds
    buffer_load_dwordx4 v97, s[4:7], s32 offen offset:1024 lds
    s_mov_b32 s32, 18432
    buffer_load_dwordx4 v96, s[4:7], s32 offen offset:2048 lds
    buffer_load_dwordx4 v97, s[4:7], s32 offen offset:3072 lds
    s_add_u32 m0, s70, 16384
    s_mov_b32 s33, 0
    buffer_load_dwordx4 v98, s[8:11], s33 offen offset:0 lds
    s_mov_b32 s33, 11264
    buffer_load_dwordx4 v98, s[8:11], s33 offen offset:1024 lds
    s_mov_b32 s33, 22528
    buffer_load_dwordx4 v98, s[8:11], s33 offen offset:2048 lds
    s_mov_b32 s33, 33792
    buffer_load_dwordx4 v98, s[8:11], s33 offen offset:3072 lds
    s_add_u32 m0, s70, 32768
    s_mov_b32 s33, 0
    buffer_load_dwordx4 v99, s[12:15], s33 offen offset:0 lds
    s_mov_b32 s33, 11264
    buffer_load_dwordx4 v99, s[12:15], s33 offen offset:1024 lds
    s_mov_b32 s33, 22528
    buffer_load_dwordx4 v99, s[12:15], s33 offen offset:2048 lds
    s_mov_b32 s33, 33792
    buffer_load_dwordx4 v99, s[12:15], s33 offen offset:3072 lds
    s_mov_b32 s16, s62
    s_and_b32 s17, s63, 0xffff
    s_mov_b32 s18, 16777216
    s_mov_b32 s19, 0x00020000
    s_mov_b32 s20, s60
    s_and_b32 s21, s61, 0xffff
    s_mov_b32 s22, 256
    s_mov_b32 s23, 0x00020000
    s_mov_b32 s24, s58
    s_and_b32 s25, s59, 0xffff
    s_mov_b32 s26, 2621440
    s_mov_b32 s27, 0x00020000
    s_bfe_u32 s36, s2, 0x20001
    s_lshl_b32 s67, s2, 7
    s_add_u32 s67, s67, 4063232
    s_lshl_b32 s79, s36, 3
    s_bfe_u32 s37, s2, 0x30003
    s_add_u32 s79, s79, s37
    s_and_b32 s73, s2, 1
    s_lshl_b32 s73, s73, 2
    s_add_u32 s73, s73, s31
    s_lshr_b32 s72, s28, 2
    s_and_b32 s74, s28, 3
    v_mov_b32 v4, 0xdddddddd
    v_and_b32 v5, 3, v1
    v_lshlrev_b32 v5, 6, v5
    v_lshlrev_b32 v102, 2, v1
    s_cmp_eq_u32 s28, 0
    s_cselect_b32 s88, s52, s54
    s_cselect_b32 s89, s53, s55
    s_mov_b32 s90, 1966080
    s_mov_b32 s93, 196608
    s_mul_i32 s36, s2, 768
    s_mul_i32 s37, s2, 5
    s_lshr_b32 s37, s37, 1
    s_lshl_b32 s37, s37, 7
    s_cmp_eq_u32 s28, 2
    s_cselect_b32 s88, s42, s88
    s_cselect_b32 s89, s43, s89
    s_cselect_b32 s90, 819200, s90
    s_cselect_b32 s93, 81920, s93
    s_cselect_b32 s36, s37, s36
    s_cselect_b32 s38, 2, 5
    s_cmp_gt_u32 s28, 2
    s_cselect_b32 s36, 1073741824, s36
    s_and_b32 s89, s89, 0xffff
    s_mov_b32 s91, 0x00020000
    v_mul_u32_u24 v6, 10923, v1
    v_lshrrev_b32 v6, 16, v6
    v_mul_u32_u24 v7, 6, v6
    v_sub_u32 v7, v1, v7
    v_min_u32 v7, s38, v7
    v_mul_lo_u32 v100, v6, s93
    v_lshl_add_u32 v100, v7, 7, v100
    v_add_u32 v100, s36, v100
    s_add_u32 m0, s70, 49152
    s_mov_b32 s32, 128
    buffer_load_dwordx4 v96, s[4:7], s32 offen offset:0 lds
    buffer_load_dwordx4 v97, s[4:7], s32 offen offset:1024 lds
    s_mov_b32 s32, 18560
    buffer_load_dwordx4 v96, s[4:7], s32 offen offset:2048 lds
    buffer_load_dwordx4 v97, s[4:7], s32 offen offset:3072 lds
    s_add_u32 m0, s70, 65536
    s_mov_b32 s33, 196608
    buffer_load_dwordx4 v98, s[8:11], s33 offen offset:0 lds
    s_mov_b32 s33, 207872
    buffer_load_dwordx4 v98, s[8:11], s33 offen offset:1024 lds
    s_mov_b32 s33, 219136
    buffer_load_dwordx4 v98, s[8:11], s33 offen offset:2048 lds
    s_mov_b32 s33, 230400
    buffer_load_dwordx4 v98, s[8:11], s33 offen offset:3072 lds
    s_add_u32 m0, s70, 81920
    s_mov_b32 s33, 196608
    buffer_load_dwordx4 v99, s[12:15], s33 offen offset:0 lds
    s_mov_b32 s33, 207872
    buffer_load_dwordx4 v99, s[12:15], s33 offen offset:1024 lds
    s_mov_b32 s33, 219136
    buffer_load_dwordx4 v99, s[12:15], s33 offen offset:2048 lds
    s_mov_b32 s33, 230400
    buffer_load_dwordx4 v99, s[12:15], s33 offen offset:3072 lds
    s_mul_i32 s92, s93, 2
    s_mov_b32 exec_lo, 0x3ffff
    s_mov_b32 exec_hi, 0x0
    buffer_load_dword v101, v100, s[88:91], s92 offen
    s_mov_b64 exec, -1
    s_lshl_b32 s68, s2, 2
    s_add_u32 s68, s68, s28
    s_mul_i32 s36, s68, 2560
    v_lshrrev_b32 v6, 5, v1
    v_lshl_add_u32 v6, v6, 10, v3
    buffer_load_dwordx2 v[104:105], v6, s[4:7], s36 offen offset:0
    buffer_load_dwordx2 v[106:107], v6, s[4:7], s36 offen offset:256
    buffer_load_dwordx2 v[108:109], v6, s[4:7], s36 offen offset:512
    buffer_load_dwordx2 v[110:111], v6, s[4:7], s36 offen offset:768
    buffer_load_dwordx2 v[112:113], v6, s[4:7], s36 offen offset:1024
    s_cmp_lg_u32 s28, 0
    s_cbranch_scc1 w0_1
    v_lshlrev_b32 v8, 15, v1
    v_mov_b32 v9, 0
    s_mov_b64 exec, 3
    buffer_store_dword v9, v8, s[16:19], s67 offen sc1
    s_mov_b64 exec, -1
w0_1:
    s_waitcnt vmcnt(18)
    s_barrier
    s_mul_i32 s92, s93, 5
    s_mov_b32 exec_lo, 0x3fffffff
    s_mov_b32 exec_hi, 0x0
    buffer_load_dword v101, v100, s[88:91], s92 offen
    s_mov_b64 exec, -1
    s_add_u32 m0, s70, 98304
    s_mov_b32 s32, 256
    buffer_load_dwordx4 v96, s[4:7], s32 offen offset:0 lds
    buffer_load_dwordx4 v97, s[4:7], s32 offen offset:1024 lds
    s_mov_b32 s32, 18688
    buffer_load_dwordx4 v96, s[4:7], s32 offen offset:2048 lds
    buffer_load_dwordx4 v97, s[4:7], s32 offen offset:3072 lds
    s_add_u32 m0, s70, 114688
    s_mov_b32 s33, 393216
    buffer_load_dwordx4 v98, s[8:11], s33 offen offset:0 lds
    s_mov_b32 s33, 404480
    buffer_load_dwordx4 v98, s[8:11], s33 offen offset:1024 lds
    s_mov_b32 s33, 415744
    buffer_load_dwordx4 v98, s[8:11], s33 offen offset:2048 lds
    s_mov_b32 s33, 427008
    buffer_load_dwordx4 v98, s[8:11], s33 offen offset:3072 lds
    s_add_u32 m0, s70, 131072
    s_mov_b32 s33, 393216
    buffer_load_dwordx4 v99, s[12:15], s33 offen offset:0 lds
    s_mov_b32 s33, 404480
    buffer_load_dwordx4 v99, s[12:15], s33 offen offset:1024 lds
    s_mov_b32 s33, 415744
    buffer_load_dwordx4 v99, s[12:15], s33 offen offset:2048 lds
    s_mov_b32 s33, 427008
    buffer_load_dwordx4 v99, s[12:15], s33 offen offset:3072 lds
    s_waitcnt vmcnt(19)
    s_barrier
    s_add_u32 m0, s70, 0
    s_mov_b32 s32, 384
    buffer_load_dwordx4 v96, s[4:7], s32 offen offset:0 lds
    buffer_load_dwordx4 v97, s[4:7], s32 offen offset:1024 lds
    s_mov_b32 s32, 18816
    buffer_load_dwordx4 v96, s[4:7], s32 offen offset:2048 lds
    buffer_load_dwordx4 v97, s[4:7], s32 offen offset:3072 lds
    s_add_u32 m0, s70, 16384
    s_mov_b32 s33, 589824
    buffer_load_dwordx4 v98, s[8:11], s33 offen offset:0 lds
    s_mov_b32 s33, 601088
    buffer_load_dwordx4 v98, s[8:11], s33 offen offset:1024 lds
    s_mov_b32 s33, 612352
    buffer_load_dwordx4 v98, s[8:11], s33 offen offset:2048 lds
    s_mov_b32 s33, 623616
    buffer_load_dwordx4 v98, s[8:11], s33 offen offset:3072 lds
    s_add_u32 m0, s70, 32768
    s_mov_b32 s33, 589824
    buffer_load_dwordx4 v99, s[12:15], s33 offen offset:0 lds
    s_mov_b32 s33, 601088
    buffer_load_dwordx4 v99, s[12:15], s33 offen offset:1024 lds
    s_mov_b32 s33, 612352
    buffer_load_dwordx4 v99, s[12:15], s33 offen offset:2048 lds
    s_mov_b32 s33, 623616
    buffer_load_dwordx4 v99, s[12:15], s33 offen offset:3072 lds
    s_waitcnt vmcnt(25)
    v_lshlrev_b32 v116, 16, v104
    v_and_b32 v117, 0xffff0000, v104
    v_add_f32 v114, v116, v117
    v_mul_f32 v115, v116, v116
    v_fmac_f32 v115, v117, v117
    v_lshlrev_b32 v116, 16, v105
    v_and_b32 v117, 0xffff0000, v105
    v_add_f32 v114, v114, v116
    v_fmac_f32 v115, v116, v116
    v_add_f32 v114, v114, v117
    v_fmac_f32 v115, v117, v117
    v_lshlrev_b32 v116, 16, v106
    v_and_b32 v117, 0xffff0000, v106
    v_add_f32 v114, v114, v116
    v_fmac_f32 v115, v116, v116
    v_add_f32 v114, v114, v117
    v_fmac_f32 v115, v117, v117
    v_lshlrev_b32 v116, 16, v107
    v_and_b32 v117, 0xffff0000, v107
    v_add_f32 v114, v114, v116
    v_fmac_f32 v115, v116, v116
    v_add_f32 v114, v114, v117
    v_fmac_f32 v115, v117, v117
    v_lshlrev_b32 v116, 16, v108
    v_and_b32 v117, 0xffff0000, v108
    v_add_f32 v114, v114, v116
    v_fmac_f32 v115, v116, v116
    v_add_f32 v114, v114, v117
    v_fmac_f32 v115, v117, v117
    v_lshlrev_b32 v116, 16, v109
    v_and_b32 v117, 0xffff0000, v109
    v_add_f32 v114, v114, v116
    v_fmac_f32 v115, v116, v116
    v_add_f32 v114, v114, v117
    v_fmac_f32 v115, v117, v117
    v_lshlrev_b32 v116, 16, v110
    v_and_b32 v117, 0xffff0000, v110
    v_add_f32 v114, v114, v116
    v_fmac_f32 v115, v116, v116
    v_add_f32 v114, v114, v117
    v_fmac_f32 v115, v117, v117
    v_lshlrev_b32 v116, 16, v111
    v_and_b32 v117, 0xffff0000, v111
    v_add_f32 v114, v114, v116
    v_fmac_f32 v115, v116, v116
    v_add_f32 v114, v114, v117
    v_fmac_f32 v115, v117, v117
    v_lshlrev_b32 v116, 16, v112
    v_and_b32 v117, 0xffff0000, v112
    v_add_f32 v114, v114, v116
    v_fmac_f32 v115, v116, v116
    v_add_f32 v114, v114, v117
    v_fmac_f32 v115, v117, v117
    v_lshlrev_b32 v116, 16, v113
    v_and_b32 v117, 0xffff0000, v113
    v_add_f32 v114, v114, v116
    v_fmac_f32 v115, v116, v116
    v_add_f32 v114, v114, v117
    v_fmac_f32 v115, v117, v117
    v_mov_b64 v[116:117], v[114:115]
    s_nop 1
    v_permlane16_swap_b32 v114, v116
    v_permlane16_swap_b32 v115, v117
    s_nop 1
    v_add_f32 v114, v114, v116
    v_add_f32 v115, v115, v117
    s_nop 1
    v_add_f32_dpp v114, v114, v114 row_ror:8 row_mask:0xf bank_mask:0xf
    v_add_f32_dpp v115, v115, v115 row_ror:8 row_mask:0xf bank_mask:0xf
    s_nop 1
    v_add_f32_dpp v114, v114, v114 row_ror:4 row_mask:0xf bank_mask:0xf
    v_add_f32_dpp v115, v115, v115 row_ror:4 row_mask:0xf bank_mask:0xf
    s_nop 1
    v_add_f32_dpp v114, v114, v114 row_ror:2 row_mask:0xf bank_mask:0xf
    v_add_f32_dpp v115, v115, v115 row_ror:2 row_mask:0xf bank_mask:0xf
    s_nop 1
    v_add_f32_dpp v114, v114, v114 row_ror:1 row_mask:0xf bank_mask:0xf
    v_add_f32_dpp v115, v115, v115 row_ror:1 row_mask:0xf bank_mask:0xf
    v_mul_f32 v114, 0x3acccccd, v114
    v_mul_f32 v115, 0x3acccccd, v115
    v_fma_f32 v115, -v114, v114, v115
    v_max_f32 v115, 0, v115
    v_cvt_pk_bf16_f32 v114, v114, v114
    v_and_b32 v114, 0xffff0000, v114
    v_cvt_pk_bf16_f32 v115, v115, v115
    v_and_b32 v115, 0xffff0000, v115
    v_add_f32 v115, 0x3727c5ac, v115
    v_cvt_pk_bf16_f32 v115, v115, v115
    v_and_b32 v115, 0xffff0000, v115
    v_sqrt_f32 v115, v115
    s_nop 0
    v_cvt_pk_bf16_f32 v115, v115, v115
    v_and_b32 v115, 0xffff0000, v115
    s_lshl_b32 s36, s68, 4
    s_add_u32 s36, s36, 3932160
    v_lshrrev_b32 v116, 2, v1
    s_mov_b32 exec_lo, 1
    s_mov_b32 exec_hi, 1
    buffer_store_dwordx2 v[114:115], v116, s[16:19], s36 offen sc1
    s_mov_b64 exec, -1
    s_waitcnt vmcnt(13)
    s_barrier
    s_add_u32 m0, s70, 49152
    s_mov_b32 s32, 512
    buffer_load_dwordx4 v96, s[4:7], s32 offen offset:0 lds
    buffer_load_dwordx4 v97, s[4:7], s32 offen offset:1024 lds
    s_mov_b32 s32, 18944
    buffer_load_dwordx4 v96, s[4:7], s32 offen offset:2048 lds
    buffer_load_dwordx4 v97, s[4:7], s32 offen offset:3072 lds
    s_add_u32 m0, s70, 65536
    s_mov_b32 s33, 786432
    buffer_load_dwordx4 v98, s[8:11], s33 offen offset:0 lds
    s_mov_b32 s33, 797696
    buffer_load_dwordx4 v98, s[8:11], s33 offen offset:1024 lds
    s_mov_b32 s33, 808960
    buffer_load_dwordx4 v98, s[8:11], s33 offen offset:2048 lds
    s_mov_b32 s33, 820224
    buffer_load_dwordx4 v98, s[8:11], s33 offen offset:3072 lds
    s_add_u32 m0, s70, 81920
    s_mov_b32 s33, 786432
    buffer_load_dwordx4 v99, s[12:15], s33 offen offset:0 lds
    s_mov_b32 s33, 797696
    buffer_load_dwordx4 v99, s[12:15], s33 offen offset:1024 lds
    s_mov_b32 s33, 808960
    buffer_load_dwordx4 v99, s[12:15], s33 offen offset:2048 lds
    s_mov_b32 s33, 820224
    buffer_load_dwordx4 v99, s[12:15], s33 offen offset:3072 lds
    s_waitcnt vmcnt(13)
    s_barrier
    s_add_u32 m0, s70, 98304
    s_mov_b32 s32, 640
    buffer_load_dwordx4 v96, s[4:7], s32 offen offset:0 lds
    buffer_load_dwordx4 v97, s[4:7], s32 offen offset:1024 lds
    s_mov_b32 s32, 19072
    buffer_load_dwordx4 v96, s[4:7], s32 offen offset:2048 lds
    buffer_load_dwordx4 v97, s[4:7], s32 offen offset:3072 lds
    s_add_u32 m0, s70, 114688
    s_mov_b32 s33, 983040
    buffer_load_dwordx4 v98, s[8:11], s33 offen offset:0 lds
    s_mov_b32 s33, 994304
    buffer_load_dwordx4 v98, s[8:11], s33 offen offset:1024 lds
    s_mov_b32 s33, 1005568
    buffer_load_dwordx4 v98, s[8:11], s33 offen offset:2048 lds
    s_mov_b32 s33, 1016832
    buffer_load_dwordx4 v98, s[8:11], s33 offen offset:3072 lds
    s_add_u32 m0, s70, 131072
    s_mov_b32 s33, 983040
    buffer_load_dwordx4 v99, s[12:15], s33 offen offset:0 lds
    s_mov_b32 s33, 994304
    buffer_load_dwordx4 v99, s[12:15], s33 offen offset:1024 lds
    s_mov_b32 s33, 1005568
    buffer_load_dwordx4 v99, s[12:15], s33 offen offset:2048 lds
    s_mov_b32 s33, 1016832
    buffer_load_dwordx4 v99, s[12:15], s33 offen offset:3072 lds
    s_waitcnt vmcnt(12)
    s_barrier
    s_cmp_lg_u32 s28, 0
    s_cbranch_scc1 w0_2
    s_bfe_u32 s38, s2, 0x20003
    s_lshl_b32 s38, s38, 6
    v_mov_b32 v8, 0
    v_mov_b32 v9, 1
    s_mov_b64 exec, 1
    buffer_atomic_add v9, v8, s[20:23], s38 offen sc1
    s_mov_b64 exec, -1
w0_2:
    s_add_u32 m0, s70, 0
    s_mov_b32 s32, 768
    buffer_load_dwordx4 v96, s[4:7], s32 offen offset:0 lds
    buffer_load_dwordx4 v97, s[4:7], s32 offen offset:1024 lds
    s_mov_b32 s32, 19200
    buffer_load_dwordx4 v96, s[4:7], s32 offen offset:2048 lds
    buffer_load_dwordx4 v97, s[4:7], s32 offen offset:3072 lds
    s_add_u32 m0, s70, 16384
    s_mov_b32 s33, 1179648
    buffer_load_dwordx4 v98, s[8:11], s33 offen offset:0 lds
    s_mov_b32 s33, 1190912
    buffer_load_dwordx4 v98, s[8:11], s33 offen offset:1024 lds
    s_mov_b32 s33, 1202176
    buffer_load_dwordx4 v98, s[8:11], s33 offen offset:2048 lds
    s_mov_b32 s33, 1213440
    buffer_load_dwordx4 v98, s[8:11], s33 offen offset:3072 lds
    s_add_u32 m0, s70, 32768
    s_mov_b32 s33, 1179648
    buffer_load_dwordx4 v99, s[12:15], s33 offen offset:0 lds
    s_mov_b32 s33, 1190912
    buffer_load_dwordx4 v99, s[12:15], s33 offen offset:1024 lds
    s_mov_b32 s33, 1202176
    buffer_load_dwordx4 v99, s[12:15], s33 offen offset:2048 lds
    s_mov_b32 s33, 1213440
    buffer_load_dwordx4 v99, s[12:15], s33 offen offset:3072 lds
    s_waitcnt vmcnt(12)
    s_barrier
    s_add_u32 m0, s70, 49152
    s_mov_b32 s32, 896
    buffer_load_dwordx4 v96, s[4:7], s32 offen offset:0 lds
    buffer_load_dwordx4 v97, s[4:7], s32 offen offset:1024 lds
    s_mov_b32 s32, 19328
    buffer_load_dwordx4 v96, s[4:7], s32 offen offset:2048 lds
    buffer_load_dwordx4 v97, s[4:7], s32 offen offset:3072 lds
    s_add_u32 m0, s70, 65536
    s_mov_b32 s33, 1376256
    buffer_load_dwordx4 v98, s[8:11], s33 offen offset:0 lds
    s_mov_b32 s33, 1387520
    buffer_load_dwordx4 v98, s[8:11], s33 offen offset:1024 lds
    s_mov_b32 s33, 1398784
    buffer_load_dwordx4 v98, s[8:11], s33 offen offset:2048 lds
    s_mov_b32 s33, 1410048
    buffer_load_dwordx4 v98, s[8:11], s33 offen offset:3072 lds
    s_add_u32 m0, s70, 81920
    s_mov_b32 s33, 1376256
    buffer_load_dwordx4 v99, s[12:15], s33 offen offset:0 lds
    s_mov_b32 s33, 1387520
    buffer_load_dwordx4 v99, s[12:15], s33 offen offset:1024 lds
    s_mov_b32 s33, 1398784
    buffer_load_dwordx4 v99, s[12:15], s33 offen offset:2048 lds
    s_mov_b32 s33, 1410048
    buffer_load_dwordx4 v99, s[12:15], s33 offen offset:3072 lds
    s_cmp_eq_u32 s28, 0
    s_cselect_b32 s88, s56, s48
    s_cselect_b32 s89, s57, s49
    s_mov_b32 s90, 819200
    s_cselect_b32 s90, 1966080, s90
    s_cselect_b32 s36, 60, 25
    s_and_b32 s89, s89, 0xffff
    s_mul_i32 s92, s36, s2
    s_lshl_b32 s92, s92, 7
    s_cmp_gt_u32 s28, 1
    s_cselect_b32 s92, 1073741824, s92
    s_sub_u32 s36, s36, 1
    v_min_u32 v100, s36, v1
    v_lshlrev_b32 v100, 7, v100
    buffer_load_dword v101, v100, s[88:91], s92 offen
    s_waitcnt vmcnt(13)
    s_barrier
    s_add_u32 m0, s70, 98304
    s_mov_b32 s32, 1024
    buffer_load_dwordx4 v96, s[4:7], s32 offen offset:0 lds
    buffer_load_dwordx4 v97, s[4:7], s32 offen offset:1024 lds
    s_mov_b32 s32, 19456
    buffer_load_dwordx4 v96, s[4:7], s32 offen offset:2048 lds
    buffer_load_dwordx4 v97, s[4:7], s32 offen offset:3072 lds
    s_add_u32 m0, s70, 114688
    s_mov_b32 s33, 1572864
    buffer_load_dwordx4 v98, s[8:11], s33 offen offset:0 lds
    s_mov_b32 s33, 1584128
    buffer_load_dwordx4 v98, s[8:11], s33 offen offset:1024 lds
    s_mov_b32 s33, 1595392
    buffer_load_dwordx4 v98, s[8:11], s33 offen offset:2048 lds
    s_mov_b32 s33, 1606656
    buffer_load_dwordx4 v98, s[8:11], s33 offen offset:3072 lds
    s_add_u32 m0, s70, 131072
    s_mov_b32 s33, 1572864
    buffer_load_dwordx4 v99, s[12:15], s33 offen offset:0 lds
    s_mov_b32 s33, 1584128
    buffer_load_dwordx4 v99, s[12:15], s33 offen offset:1024 lds
    s_mov_b32 s33, 1595392
    buffer_load_dwordx4 v99, s[12:15], s33 offen offset:2048 lds
    s_mov_b32 s33, 1606656
    buffer_load_dwordx4 v99, s[12:15], s33 offen offset:3072 lds
    s_waitcnt vmcnt(13)
    s_barrier
    s_add_u32 m0, s70, 0
    s_mov_b32 s32, 1152
    buffer_load_dwordx4 v96, s[4:7], s32 offen offset:0 lds
    buffer_load_dwordx4 v97, s[4:7], s32 offen offset:1024 lds
    s_mov_b32 s32, 19584
    buffer_load_dwordx4 v96, s[4:7], s32 offen offset:2048 lds
    buffer_load_dwordx4 v97, s[4:7], s32 offen offset:3072 lds
    s_add_u32 m0, s70, 16384
    s_mov_b32 s33, 1769472
    buffer_load_dwordx4 v98, s[8:11], s33 offen offset:0 lds
    s_mov_b32 s33, 1780736
    buffer_load_dwordx4 v98, s[8:11], s33 offen offset:1024 lds
    s_mov_b32 s33, 1792000
    buffer_load_dwordx4 v98, s[8:11], s33 offen offset:2048 lds
    s_mov_b32 s33, 1803264
    buffer_load_dwordx4 v98, s[8:11], s33 offen offset:3072 lds
    s_add_u32 m0, s70, 32768
    s_mov_b32 s33, 1769472
    buffer_load_dwordx4 v99, s[12:15], s33 offen offset:0 lds
    s_mov_b32 s33, 1780736
    buffer_load_dwordx4 v99, s[12:15], s33 offen offset:1024 lds
    s_mov_b32 s33, 1792000
    buffer_load_dwordx4 v99, s[12:15], s33 offen offset:2048 lds
    s_mov_b32 s33, 1803264
    buffer_load_dwordx4 v99, s[12:15], s33 offen offset:3072 lds
    s_waitcnt vmcnt(12)
    s_barrier
    buffer_load_dword v11, v5, s[20:23], 0 offen sc1
    s_waitcnt vmcnt(0)
    v_cmp_le_u32 vcc, 64, v11
    s_mov_b32 s78, 0
    s_cmp_eq_u64 vcc, exec
    s_cbranch_scc1 poll_ok_3
poll_lp_4:
    s_sleep 4
    buffer_load_dword v11, v5, s[20:23], 0 offen sc1
    s_add_u32 s78, s78, 1
    s_cmp_gt_u32 s78, 0x8000
    s_cbranch_scc1 poll_ok_3
    s_waitcnt vmcnt(0)
    v_cmp_le_u32 vcc, 64, v11
    s_nop 0
    s_cmp_eq_u64 vcc, exec
    s_cbranch_scc0 poll_lp_4
poll_ok_3:
    s_barrier
    v_lshlrev_b32 v5, 7, v1
    v_add_u32 v5, 4063232, v5
    s_lshl_b32 s36, s28, 8
    s_add_u32 s36, s36, 147456
    v_add_u32 v7, s36, v102
    s_barrier
    ds_read_b32 v118, v7 offset:6144
    ds_read_b32 v119, v7 offset:7168
    s_waitcnt lgkmcnt(0)
    v_add_f32 v118, v118, v119
    ds_write_b32 v7, v118
    s_waitcnt lgkmcnt(0)
    s_barrier
    s_sub_u32 s94, s2, 64
    s_lshl_b32 s94, s94, 2
    s_add_u32 s94, s94, s74
    s_cmp_ge_u32 s94, 680
    s_cbranch_scc1 rp_a_end
    v_lshrrev_b32 v8, 5, v1
    v_bfe_u32 v7, v1, 3, 2
    v_mul_u32_u24 v9, 1280, v7
    v_and_b32 v7, 7, v1
    v_lshl_add_u32 v9, v7, 4, v9
    s_lshl_b32 s83, s74, 12
    s_add_u32 s83, s83, 114688
    s_mul_i32 s36, s94, 6554
    s_lshr_b32 s36, s36, 16
    s_mul_i32 s37, s36, 10
    s_sub_u32 s37, s94, s37
    s_lshl_b32 s33, s36, 5
    s_mov_b32 s34, 16
    s_mov_b32 s35, 8
    s_mov_b32 s66, 5120
    s_cmp_lt_u32 s36, 48
    s_cselect_b32 s8, s56, s48
    s_cselect_b32 s9, s57, s49
    s_mov_b32 s10, 819200
    s_cselect_b32 s10, 1966080, s10
    s_cbranch_scc1 rp_go
    s_cmp_ge_u32 s36, 58
    s_cselect_b32 s38, 40, 0
    s_cselect_b32 s39, 58, 48
    s_sub_u32 s36, s36, s39
    s_mul_i32 s33, s36, 80
    s_add_u32 s33, s33, s38
    s_mov_b32 s34, 20
    s_cmp_lt_u32 s36, 8
    s_cbranch_scc1 rp_go
    s_sub_u32 s33, s36, 8
    s_mul_i32 s33, s33, 320
    s_add_u32 s33, s33, s38
    s_add_u32 s33, s33, 16
    s_mov_b32 s34, 160
    s_mov_b32 s35, 20
    s_mov_b32 s66, 102400
rp_go:
    s_and_b32 s9, s9, 0xffff
    v_mad_u32_u24 v6, v8, s66, v9
    s_lshl_b32 s37, s37, 7
    s_mul_i32 s36, s34, 0
    s_mul_i32 s38, s35, 0
    s_add_u32 s36, s36, s38
    s_add_u32 s36, s36, s33
    s_mul_i32 s36, s36, 1280
    s_add_u32 m0, s83, 0
    s_add_u32 s36, s36, s37
    buffer_load_dwordx4 v6, s[8:11], s36 offen lds
    s_mul_i32 s36, s34, 0
    s_mul_i32 s38, s35, 1
    s_add_u32 s36, s36, s38
    s_add_u32 s36, s36, s33
    s_mul_i32 s36, s36, 1280
    s_add_u32 m0, s83, 1024
    s_add_u32 s36, s36, s37
    buffer_load_dwordx4 v6, s[8:11], s36 offen lds
    s_mul_i32 s36, s34, 1
    s_mul_i32 s38, s35, 0
    s_add_u32 s36, s36, s38
    s_add_u32 s36, s36, s33
    s_mul_i32 s36, s36, 1280
    s_add_u32 m0, s83, 2048
    s_add_u32 s36, s36, s37
    buffer_load_dwordx4 v6, s[8:11], s36 offen lds
    s_mul_i32 s36, s34, 1
    s_mul_i32 s38, s35, 1
    s_add_u32 s36, s36, s38
    s_add_u32 s36, s36, s33
    s_mul_i32 s36, s36, 1280
    s_add_u32 m0, s83, 3072
    s_add_u32 s36, s36, s37
    buffer_load_dwordx4 v6, s[8:11], s36 offen lds
rp_a_end:
    s_branch attn_start
ab_cF:
    s_and_b32 s64, s28, 1
    s_bfe_u32 s65, s28, 0x10001
    v_lshlrev_b32 v89, 2, v1
    v_and_b32 v6, 31, v1
    v_lshrrev_b32 v7, 5, v1
    v_bfe_u32 v8, v1, 1, 3
    v_xor_b32 v8, v8, v7
    v_lshlrev_b32 v8, 4, v8
    v_lshl_add_u32 v16, v6, 7, v8
    s_lshl_b32 s36, s64, 13
    v_add_u32 v16, s36, v16
    s_lshl_b32 s36, s64, 6
    v_xor_b32 v16, s36, v16
    v_xor_b32 v17, 32, v16
    v_xor_b32 v18, 64, v16
    v_xor_b32 v19, 96, v16
    v_bfe_u32 v6, v1, 2, 2
    v_lshl_add_u32 v8, v7, 3, v6
    v_bfe_u32 v9, v1, 4, 1
    v_lshlrev_b32 v8, 8, v8
    v_lshl_add_u32 v8, v9, 14, v8
    v_lshlrev_b32 v6, 6, v6
    v_lshl_or_b32 v6, v9, 5, v6
    v_and_b32 v9, 3, v1
    v_lshl_add_u32 v6, v9, 3, v6
    v_add_u32 v6, v6, v8
    s_lshl_b32 s36, s65, 7
    v_xor_b32 v24, s36, v6
    v_xor_b32 v26, 32, v24
    v_xor_b32 v28, 64, v24
    v_xor_b32 v30, 96, v24
    s_mul_i32 s36, s64, 8192
    s_add_u32 s36, s36, 16384
    v_add_u32 v24, s36, v24
    v_xor_b32 v25, 8192, v24
    v_add_u32 v26, s36, v26
    v_xor_b32 v27, 8192, v26
    v_add_u32 v28, s36, v28
    v_xor_b32 v29, 8192, v28
    v_add_u32 v30, s36, v30
    v_xor_b32 v31, 8192, v30
    v_add_u32 v20, 98304, v16
    v_add_u32 v21, 98304, v17
    v_add_u32 v22, 98304, v18
    v_add_u32 v23, 98304, v19
    v_add_u32 v32, 98304, v24
    v_add_u32 v33, 98304, v25
    v_add_u32 v34, 98304, v26
    v_add_u32 v35, 98304, v27
    v_add_u32 v36, 98304, v28
    v_add_u32 v37, 98304, v29
    v_add_u32 v38, 98304, v30
    v_add_u32 v39, 98304, v31
    v_bfe_u32 v6, v1, 3, 1
    v_lshrrev_b32 v7, 5, v1
    v_xor_b32 v6, v6, v7
    v_and_b32 v7, 6, v1
    v_or_b32 v6, v6, v7
    v_mov_b32 v7, 0x3f803f80
    v_cmp_eq_u32 vcc, 0, v6
    v_cmp_eq_u32 s[84:85], 4, v6
    v_and_b32 v8, 1, v1
    v_mul_u32_u24 v8, 0xaaaa, v8
    v_cndmask_b32 v224, 0, v7, vcc
    v_cndmask_b32 v225, 0, v7, vcc
    v_cndmask_b32 v226, 0, v7, s[84:85]
    v_cndmask_b32 v227, 0, v7, s[84:85]
    v_add_u32 v88, 0x4444, v8
    v_mov_b64 v[228:229], 0
    v_mov_b64 v[230:231], 0
    v_mov_b64 v[232:233], 0
    v_mov_b64 v[234:235], 0
    v_and_b32 v6, 60, v89
    v_add_u32 v6, 159744, v6
    v_mov_b32 v7, 0
    ds_write_b32 v6, v7
    s_waitcnt lgkmcnt(0)
    s_mov_b32 s4, s40
    s_and_b32 s5, s41, 0xffff
    s_mov_b32 s6, 2621440
    s_mov_b32 s7, 0x00020000
    s_mov_b32 s16, s62
    s_and_b32 s17, s63, 0xffff
    s_mov_b32 s18, 16777216
    s_mov_b32 s19, 0x00020000
    s_mov_b32 s20, s60
    s_and_b32 s21, s61, 0xffff
    s_mov_b32 s22, 256
    s_mov_b32 s23, 0x00020000
    s_mov_b32 s24, s58
    s_and_b32 s25, s59, 0xffff
    s_mov_b32 s26, 2621440
    s_mov_b32 s27, 0x00020000
    s_bfe_u32 s36, s2, 0x20001
    s_lshl_b32 s67, s2, 7
    s_add_u32 s67, s67, 4063232
    s_lshl_b32 s79, s36, 3
    s_bfe_u32 s37, s2, 0x30003
    s_add_u32 s79, s79, s37
    s_and_b32 s73, s2, 1
    s_lshl_b32 s73, s73, 2
    s_add_u32 s73, s73, s31
    s_lshr_b32 s72, s28, 2
    s_and_b32 s74, s28, 3
    v_mov_b32 v4, 0xdddddddd
    v_and_b32 v5, 3, v1
    v_lshlrev_b32 v5, 6, v5
    s_mov_b32 s94, 1023
    s_barrier
    s_setprio 1
    ds_read_b128 v[56:59], v16 offset:0
    ds_read_b64_tr_b16 v[40:41], v24 offset:0
    ds_read_b64_tr_b16 v[42:43], v24 offset:1024
    ds_read_b128 v[60:63], v16 offset:4096
    ds_read_b64_tr_b16 v[44:45], v26 offset:0
    ds_read_b64_tr_b16 v[46:47], v26 offset:1024
    ds_read_b64_tr_b16 v[48:49], v28 offset:0
    ds_read_b64_tr_b16 v[50:51], v28 offset:1024
    ds_read_b64_tr_b16 v[52:53], v30 offset:0
    ds_read_b64_tr_b16 v[54:55], v30 offset:1024
    s_waitcnt lgkmcnt(0)
    v_mfma_f32_32x32x16_bf16 v[96:111], v[40:43], v[56:59], 0
    ds_read_b128 v[80:83], v17 offset:0
    ds_read_b64_tr_b16 v[64:65], v24 offset:4096
    v_mfma_f32_32x32x16_bf16 v[112:127], v[40:43], v[60:63], 0
    ds_read_b64_tr_b16 v[66:67], v24 offset:5120
    ds_read_b128 v[84:87], v17 offset:4096
    v_mfma_f32_32x32x16_bf16 v[128:143], v[44:47], v[56:59], 0
    ds_read_b64_tr_b16 v[68:69], v26 offset:4096
    ds_read_b64_tr_b16 v[70:71], v26 offset:5120
    v_mfma_f32_32x32x16_bf16 v[144:159], v[44:47], v[60:63], 0
    ds_read_b64_tr_b16 v[72:73], v28 offset:4096
    ds_read_b64_tr_b16 v[74:75], v28 offset:5120
    v_mfma_f32_32x32x16_bf16 v[160:175], v[48:51], v[56:59], 0
    ds_read_b64_tr_b16 v[76:77], v30 offset:4096
    ds_read_b64_tr_b16 v[78:79], v30 offset:5120
    v_mfma_f32_32x32x16_bf16 v[176:191], v[48:51], v[60:63], 0
    v_mfma_f32_32x32x16_bf16 v[192:207], v[52:55], v[56:59], 0
    v_mfma_f32_32x32x16_bf16 v[208:223], v[52:55], v[60:63], 0
    v_smfmac_f32_16x16x64_bf16 v[228:231], v[224:227], v[40:47], v88
    v_smfmac_f32_16x16x64_bf16 v[232:235], v[224:227], v[48:55], v88
    s_waitcnt lgkmcnt(0)
    v_mfma_f32_32x32x16_bf16 v[96:111], v[64:67], v[80:83], v[96:111]
    ds_read_b128 v[56:59], v18 offset:0
    ds_read_b64_tr_b16 v[40:41], v25 offset:0
    v_mfma_f32_32x32x16_bf16 v[112:127], v[64:67], v[84:87], v[112:127]
    ds_read_b64_tr_b16 v[42:43], v25 offset:1024
    ds_read_b128 v[60:63], v18 offset:4096
    v_mfma_f32_32x32x16_bf16 v[128:143], v[68:71], v[80:83], v[128:143]
    ds_read_b64_tr_b16 v[44:45], v27 offset:0
    ds_read_b64_tr_b16 v[46:47], v27 offset:1024
    v_mfma_f32_32x32x16_bf16 v[144:159], v[68:71], v[84:87], v[144:159]
    ds_read_b64_tr_b16 v[48:49], v29 offset:0
    ds_read_b64_tr_b16 v[50:51], v29 offset:1024
    v_mfma_f32_32x32x16_bf16 v[160:175], v[72:75], v[80:83], v[160:175]
    ds_read_b64_tr_b16 v[52:53], v31 offset:0
    ds_read_b64_tr_b16 v[54:55], v31 offset:1024
    v_mfma_f32_32x32x16_bf16 v[176:191], v[72:75], v[84:87], v[176:191]
    v_mfma_f32_32x32x16_bf16 v[192:207], v[76:79], v[80:83], v[192:207]
    v_mfma_f32_32x32x16_bf16 v[208:223], v[76:79], v[84:87], v[208:223]
    v_smfmac_f32_16x16x64_bf16 v[228:231], v[224:227], v[64:71], v88
    v_smfmac_f32_16x16x64_bf16 v[232:235], v[224:227], v[72:79], v88
    s_waitcnt lgkmcnt(0)
    v_mfma_f32_32x32x16_bf16 v[96:111], v[40:43], v[56:59], v[96:111]
    ds_read_b128 v[80:83], v19 offset:0
    ds_read_b64_tr_b16 v[64:65], v25 offset:4096
    v_mfma_f32_32x32x16_bf16 v[112:127], v[40:43], v[60:63], v[112:127]
    ds_read_b64_tr_b16 v[66:67], v25 offset:5120
    ds_read_b128 v[84:87], v19 offset:4096
    v_mfma_f32_32x32x16_bf16 v[128:143], v[44:47], v[56:59], v[128:143]
    ds_read_b64_tr_b16 v[68:69], v27 offset:4096
    ds_read_b64_tr_b16 v[70:71], v27 offset:5120
    v_mfma_f32_32x32x16_bf16 v[144:159], v[44:47], v[60:63], v[144:159]
    ds_read_b64_tr_b16 v[72:73], v29 offset:4096
    ds_read_b64_tr_b16 v[74:75], v29 offset:5120
    v_mfma_f32_32x32x16_bf16 v[160:175], v[48:51], v[56:59], v[160:175]
    ds_read_b64_tr_b16 v[76:77], v31 offset:4096
    ds_read_b64_tr_b16 v[78:79], v31 offset:5120
    v_mfma_f32_32x32x16_bf16 v[176:191], v[48:51], v[60:63], v[176:191]
    v_mfma_f32_32x32x16_bf16 v[192:207], v[52:55], v[56:59], v[192:207]
    v_mfma_f32_32x32x16_bf16 v[208:223], v[52:55], v[60:63], v[208:223]
    s_waitcnt lgkmcnt(0)
    s_barrier
    v_mfma_f32_32x32x16_bf16 v[96:111], v[64:67], v[80:83], v[96:111]
    ds_read_b128 v[56:59], v16 offset:49152
    ds_read_b64_tr_b16 v[40:41], v24 offset:49152
    v_mfma_f32_32x32x16_bf16 v[112:127], v[64:67], v[84:87], v[112:127]
    ds_read_b64_tr_b16 v[42:43], v24 offset:50176
    ds_read_b128 v[60:63], v16 offset:53248
    v_mfma_f32_32x32x16_bf16 v[128:143], v[68:71], v[80:83], v[128:143]
    ds_read_b64_tr_b16 v[44:45], v26 offset:49152
    ds_read_b64_tr_b16 v[46:47], v26 offset:50176
    v_mfma_f32_32x32x16_bf16 v[144:159], v[68:71], v[84:87], v[144:159]
    ds_read_b64_tr_b16 v[48:49], v28 offset:49152
    ds_read_b64_tr_b16 v[50:51], v28 offset:50176
    v_mfma_f32_32x32x16_bf16 v[160:175], v[72:75], v[80:83], v[160:175]
    ds_read_b64_tr_b16 v[52:53], v30 offset:49152
    ds_read_b64_tr_b16 v[54:55], v30 offset:50176
    v_mfma_f32_32x32x16_bf16 v[176:191], v[72:75], v[84:87], v[176:191]
    v_mfma_f32_32x32x16_bf16 v[192:207], v[76:79], v[80:83], v[192:207]
    v_mfma_f32_32x32x16_bf16 v[208:223], v[76:79], v[84:87], v[208:223]
    s_waitcnt lgkmcnt(0)
    v_mfma_f32_32x32x16_bf16 v[96:111], v[40:43], v[56:59], v[96:111]
    ds_read_b128 v[80:83], v17 offset:49152
    ds_read_b64_tr_b16 v[64:65], v24 offset:53248
    v_mfma_f32_32x32x16_bf16 v[112:127], v[40:43], v[60:63], v[112:127]
    ds_read_b64_tr_b16 v[66:67], v24 offset:54272
    ds_read_b128 v[84:87], v17 offset:53248
    v_mfma_f32_32x32x16_bf16 v[128:143], v[44:47], v[56:59], v[128:143]
    ds_read_b64_tr_b16 v[68:69], v26 offset:53248
    ds_read_b64_tr_b16 v[70:71], v26 offset:54272
    v_mfma_f32_32x32x16_bf16 v[144:159], v[44:47], v[60:63], v[144:159]
    ds_read_b64_tr_b16 v[72:73], v28 offset:53248
    ds_read_b64_tr_b16 v[74:75], v28 offset:54272
    v_mfma_f32_32x32x16_bf16 v[160:175], v[48:51], v[56:59], v[160:175]
    ds_read_b64_tr_b16 v[76:77], v30 offset:53248
    ds_read_b64_tr_b16 v[78:79], v30 offset:54272
    v_mfma_f32_32x32x16_bf16 v[176:191], v[48:51], v[60:63], v[176:191]
    v_mfma_f32_32x32x16_bf16 v[192:207], v[52:55], v[56:59], v[192:207]
    v_mfma_f32_32x32x16_bf16 v[208:223], v[52:55], v[60:63], v[208:223]
    v_smfmac_f32_16x16x64_bf16 v[228:231], v[224:227], v[40:47], v88
    v_smfmac_f32_16x16x64_bf16 v[232:235], v[224:227], v[48:55], v88
    s_waitcnt lgkmcnt(0)
    v_mfma_f32_32x32x16_bf16 v[96:111], v[64:67], v[80:83], v[96:111]
    ds_read_b128 v[56:59], v18 offset:49152
    ds_read_b64_tr_b16 v[40:41], v25 offset:49152
    v_mfma_f32_32x32x16_bf16 v[112:127], v[64:67], v[84:87], v[112:127]
    ds_read_b64_tr_b16 v[42:43], v25 offset:50176
    ds_read_b128 v[60:63], v18 offset:53248
    v_mfma_f32_32x32x16_bf16 v[128:143], v[68:71], v[80:83], v[128:143]
    ds_read_b64_tr_b16 v[44:45], v27 offset:49152
    ds_read_b64_tr_b16 v[46:47], v27 offset:50176
    v_mfma_f32_32x32x16_bf16 v[144:159], v[68:71], v[84:87], v[144:159]
    ds_read_b64_tr_b16 v[48:49], v29 offset:49152
    ds_read_b64_tr_b16 v[50:51], v29 offset:50176
    v_mfma_f32_32x32x16_bf16 v[160:175], v[72:75], v[80:83], v[160:175]
    ds_read_b64_tr_b16 v[52:53], v31 offset:49152
    ds_read_b64_tr_b16 v[54:55], v31 offset:50176
    v_mfma_f32_32x32x16_bf16 v[176:191], v[72:75], v[84:87], v[176:191]
    v_mfma_f32_32x32x16_bf16 v[192:207], v[76:79], v[80:83], v[192:207]
    v_mfma_f32_32x32x16_bf16 v[208:223], v[76:79], v[84:87], v[208:223]
    v_smfmac_f32_16x16x64_bf16 v[228:231], v[224:227], v[64:71], v88
    v_smfmac_f32_16x16x64_bf16 v[232:235], v[224:227], v[72:79], v88
    s_waitcnt lgkmcnt(0)
    v_mfma_f32_32x32x16_bf16 v[96:111], v[40:43], v[56:59], v[96:111]
    ds_read_b128 v[80:83], v19 offset:49152
    ds_read_b64_tr_b16 v[64:65], v25 offset:53248
    v_mfma_f32_32x32x16_bf16 v[112:127], v[40:43], v[60:63], v[112:127]
    ds_read_b64_tr_b16 v[66:67], v25 offset:54272
    ds_read_b128 v[84:87], v19 offset:53248
    v_mfma_f32_32x32x16_bf16 v[128:143], v[44:47], v[56:59], v[128:143]
    ds_read_b64_tr_b16 v[68:69], v27 offset:53248
    ds_read_b64_tr_b16 v[70:71], v27 offset:54272
    v_mfma_f32_32x32x16_bf16 v[144:159], v[44:47], v[60:63], v[144:159]
    ds_read_b64_tr_b16 v[72:73], v29 offset:53248
    ds_read_b64_tr_b16 v[74:75], v29 offset:54272
    v_mfma_f32_32x32x16_bf16 v[160:175], v[48:51], v[56:59], v[160:175]
    ds_read_b64_tr_b16 v[76:77], v31 offset:53248
    ds_read_b64_tr_b16 v[78:79], v31 offset:54272
    v_mfma_f32_32x32x16_bf16 v[176:191], v[48:51], v[60:63], v[176:191]
    v_mfma_f32_32x32x16_bf16 v[192:207], v[52:55], v[56:59], v[192:207]
    v_mfma_f32_32x32x16_bf16 v[208:223], v[52:55], v[60:63], v[208:223]
    s_waitcnt lgkmcnt(0)
    s_barrier
    v_mfma_f32_32x32x16_bf16 v[96:111], v[64:67], v[80:83], v[96:111]
    ds_read_b128 v[56:59], v20 offset:0
    ds_read_b64_tr_b16 v[40:41], v32 offset:0
    v_mfma_f32_32x32x16_bf16 v[112:127], v[64:67], v[84:87], v[112:127]
    ds_read_b64_tr_b16 v[42:43], v32 offset:1024
    ds_read_b128 v[60:63], v20 offset:4096
    v_mfma_f32_32x32x16_bf16 v[128:143], v[68:71], v[80:83], v[128:143]
    ds_read_b64_tr_b16 v[44:45], v34 offset:0
    ds_read_b64_tr_b16 v[46:47], v34 offset:1024
    v_mfma_f32_32x32x16_bf16 v[144:159], v[68:71], v[84:87], v[144:159]
    ds_read_b64_tr_b16 v[48:49], v36 offset:0
    ds_read_b64_tr_b16 v[50:51], v36 offset:1024
    v_mfma_f32_32x32x16_bf16 v[160:175], v[72:75], v[80:83], v[160:175]
    ds_read_b64_tr_b16 v[52:53], v38 offset:0
    ds_read_b64_tr_b16 v[54:55], v38 offset:1024
    v_mfma_f32_32x32x16_bf16 v[176:191], v[72:75], v[84:87], v[176:191]
    v_mfma_f32_32x32x16_bf16 v[192:207], v[76:79], v[80:83], v[192:207]
    v_mfma_f32_32x32x16_bf16 v[208:223], v[76:79], v[84:87], v[208:223]
    s_waitcnt lgkmcnt(0)
    v_mfma_f32_32x32x16_bf16 v[96:111], v[40:43], v[56:59], v[96:111]
    ds_read_b128 v[80:83], v21 offset:0
    ds_read_b64_tr_b16 v[64:65], v32 offset:4096
    v_mfma_f32_32x32x16_bf16 v[112:127], v[40:43], v[60:63], v[112:127]
    ds_read_b64_tr_b16 v[66:67], v32 offset:5120
    ds_read_b128 v[84:87], v21 offset:4096
    v_mfma_f32_32x32x16_bf16 v[128:143], v[44:47], v[56:59], v[128:143]
    ds_read_b64_tr_b16 v[68:69], v34 offset:4096
    ds_read_b64_tr_b16 v[70:71], v34 offset:5120
    v_mfma_f32_32x32x16_bf16 v[144:159], v[44:47], v[60:63], v[144:159]
    ds_read_b64_tr_b16 v[72:73], v36 offset:4096
    ds_read_b64_tr_b16 v[74:75], v36 offset:5120
    v_mfma_f32_32x32x16_bf16 v[160:175], v[48:51], v[56:59], v[160:175]
    ds_read_b64_tr_b16 v[76:77], v38 offset:4096
    ds_read_b64_tr_b16 v[78:79], v38 offset:5120
    v_mfma_f32_32x32x16_bf16 v[176:191], v[48:51], v[60:63], v[176:191]
    v_mfma_f32_32x32x16_bf16 v[192:207], v[52:55], v[56:59], v[192:207]
    v_mfma_f32_32x32x16_bf16 v[208:223], v[52:55], v[60:63], v[208:223]
    v_smfmac_f32_16x16x64_bf16 v[228:231], v[224:227], v[40:47], v88
    v_smfmac_f32_16x16x64_bf16 v[232:235], v[224:227], v[48:55], v88
    s_waitcnt lgkmcnt(0)
    v_mfma_f32_32x32x16_bf16 v[96:111], v[64:67], v[80:83], v[96:111]
    ds_read_b128 v[56:59], v22 offset:0
    ds_read_b64_tr_b16 v[40:41], v33 offset:0
    v_mfma_f32_32x32x16_bf16 v[112:127], v[64:67], v[84:87], v[112:127]
    ds_read_b64_tr_b16 v[42:43], v33 offset:1024
    ds_read_b128 v[60:63], v22 offset:4096
    v_mfma_f32_32x32x16_bf16 v[128:143], v[68:71], v[80:83], v[128:143]
    ds_read_b64_tr_b16 v[44:45], v35 offset:0
    ds_read_b64_tr_b16 v[46:47], v35 offset:1024
    v_mfma_f32_32x32x16_bf16 v[144:159], v[68:71], v[84:87], v[144:159]
    ds_read_b64_tr_b16 v[48:49], v37 offset:0
    ds_read_b64_tr_b16 v[50:51], v37 offset:1024
    v_mfma_f32_32x32x16_bf16 v[160:175], v[72:75], v[80:83], v[160:175]
    ds_read_b64_tr_b16 v[52:53], v39 offset:0
    ds_read_b64_tr_b16 v[54:55], v39 offset:1024
    v_mfma_f32_32x32x16_bf16 v[176:191], v[72:75], v[84:87], v[176:191]
    v_mfma_f32_32x32x16_bf16 v[192:207], v[76:79], v[80:83], v[192:207]
    v_mfma_f32_32x32x16_bf16 v[208:223], v[76:79], v[84:87], v[208:223]
    v_smfmac_f32_16x16x64_bf16 v[228:231], v[224:227], v[64:71], v88
    v_smfmac_f32_16x16x64_bf16 v[232:235], v[224:227], v[72:79], v88
    s_waitcnt lgkmcnt(0)
    v_mfma_f32_32x32x16_bf16 v[96:111], v[40:43], v[56:59], v[96:111]
    ds_read_b128 v[80:83], v23 offset:0
    ds_read_b64_tr_b16 v[64:65], v33 offset:4096
    v_mfma_f32_32x32x16_bf16 v[112:127], v[40:43], v[60:63], v[112:127]
    ds_read_b64_tr_b16 v[66:67], v33 offset:5120
    ds_read_b128 v[84:87], v23 offset:4096
    v_mfma_f32_32x32x16_bf16 v[128:143], v[44:47], v[56:59], v[128:143]
    ds_read_b64_tr_b16 v[68:69], v35 offset:4096
    ds_read_b64_tr_b16 v[70:71], v35 offset:5120
    v_mfma_f32_32x32x16_bf16 v[144:159], v[44:47], v[60:63], v[144:159]
    ds_read_b64_tr_b16 v[72:73], v37 offset:4096
    ds_read_b64_tr_b16 v[74:75], v37 offset:5120
    v_mfma_f32_32x32x16_bf16 v[160:175], v[48:51], v[56:59], v[160:175]
    ds_read_b64_tr_b16 v[76:77], v39 offset:4096
    ds_read_b64_tr_b16 v[78:79], v39 offset:5120
    v_mfma_f32_32x32x16_bf16 v[176:191], v[48:51], v[60:63], v[176:191]
    v_mfma_f32_32x32x16_bf16 v[192:207], v[52:55], v[56:59], v[192:207]
    v_mfma_f32_32x32x16_bf16 v[208:223], v[52:55], v[60:63], v[208:223]
    s_waitcnt lgkmcnt(0)
    s_barrier
    v_mfma_f32_32x32x16_bf16 v[96:111], v[64:67], v[80:83], v[96:111]
    ds_read_b128 v[56:59], v16 offset:0
    ds_read_b64_tr_b16 v[40:41], v24 offset:0
    v_mfma_f32_32x32x16_bf16 v[112:127], v[64:67], v[84:87], v[112:127]
    ds_read_b64_tr_b16 v[42:43], v24 offset:1024
    ds_read_b128 v[60:63], v16 offset:4096
    v_mfma_f32_32x32x16_bf16 v[128:143], v[68:71], v[80:83], v[128:143]
    ds_read_b64_tr_b16 v[44:45], v26 offset:0
    ds_read_b64_tr_b16 v[46:47], v26 offset:1024
    v_mfma_f32_32x32x16_bf16 v[144:159], v[68:71], v[84:87], v[144:159]
    ds_read_b64_tr_b16 v[48:49], v28 offset:0
    ds_read_b64_tr_b16 v[50:51], v28 offset:1024
    v_mfma_f32_32x32x16_bf16 v[160:175], v[72:75], v[80:83], v[160:175]
    ds_read_b64_tr_b16 v[52:53], v30 offset:0
    ds_read_b64_tr_b16 v[54:55], v30 offset:1024
    v_mfma_f32_32x32x16_bf16 v[176:191], v[72:75], v[84:87], v[176:191]
    v_mfma_f32_32x32x16_bf16 v[192:207], v[76:79], v[80:83], v[192:207]
    v_mfma_f32_32x32x16_bf16 v[208:223], v[76:79], v[84:87], v[208:223]
    s_waitcnt lgkmcnt(0)
    v_mfma_f32_32x32x16_bf16 v[96:111], v[40:43], v[56:59], v[96:111]
    ds_read_b128 v[80:83], v17 offset:0
    ds_read_b64_tr_b16 v[64:65], v24 offset:4096
    v_mfma_f32_32x32x16_bf16 v[112:127], v[40:43], v[60:63], v[112:127]
    ds_read_b64_tr_b16 v[66:67], v24 offset:5120
    ds_read_b128 v[84:87], v17 offset:4096
    v_mfma_f32_32x32x16_bf16 v[128:143], v[44:47], v[56:59], v[128:143]
    ds_read_b64_tr_b16 v[68:69], v26 offset:4096
    ds_read_b64_tr_b16 v[70:71], v26 offset:5120
    v_mfma_f32_32x32x16_bf16 v[144:159], v[44:47], v[60:63], v[144:159]
    ds_read_b64_tr_b16 v[72:73], v28 offset:4096
    ds_read_b64_tr_b16 v[74:75], v28 offset:5120
    v_mfma_f32_32x32x16_bf16 v[160:175], v[48:51], v[56:59], v[160:175]
    ds_read_b64_tr_b16 v[76:77], v30 offset:4096
    ds_read_b64_tr_b16 v[78:79], v30 offset:5120
    v_mfma_f32_32x32x16_bf16 v[176:191], v[48:51], v[60:63], v[176:191]
    v_mfma_f32_32x32x16_bf16 v[192:207], v[52:55], v[56:59], v[192:207]
    v_mfma_f32_32x32x16_bf16 v[208:223], v[52:55], v[60:63], v[208:223]
    v_smfmac_f32_16x16x64_bf16 v[228:231], v[224:227], v[40:47], v88
    v_smfmac_f32_16x16x64_bf16 v[232:235], v[224:227], v[48:55], v88
    s_waitcnt lgkmcnt(0)
    v_mfma_f32_32x32x16_bf16 v[96:111], v[64:67], v[80:83], v[96:111]
    ds_read_b128 v[56:59], v18 offset:0
    ds_read_b64_tr_b16 v[40:41], v25 offset:0
    v_mfma_f32_32x32x16_bf16 v[112:127], v[64:67], v[84:87], v[112:127]
    ds_read_b64_tr_b16 v[42:43], v25 offset:1024
    ds_read_b128 v[60:63], v18 offset:4096
    v_mfma_f32_32x32x16_bf16 v[128:143], v[68:71], v[80:83], v[128:143]
    ds_read_b64_tr_b16 v[44:45], v27 offset:0
    ds_read_b64_tr_b16 v[46:47], v27 offset:1024
    v_mfma_f32_32x32x16_bf16 v[144:159], v[68:71], v[84:87], v[144:159]
    ds_read_b64_tr_b16 v[48:49], v29 offset:0
    ds_read_b64_tr_b16 v[50:51], v29 offset:1024
    v_mfma_f32_32x32x16_bf16 v[160:175], v[72:75], v[80:83], v[160:175]
    ds_read_b64_tr_b16 v[52:53], v31 offset:0
    ds_read_b64_tr_b16 v[54:55], v31 offset:1024
    v_mfma_f32_32x32x16_bf16 v[176:191], v[72:75], v[84:87], v[176:191]
    v_mfma_f32_32x32x16_bf16 v[192:207], v[76:79], v[80:83], v[192:207]
    v_mfma_f32_32x32x16_bf16 v[208:223], v[76:79], v[84:87], v[208:223]
    v_smfmac_f32_16x16x64_bf16 v[228:231], v[224:227], v[64:71], v88
    v_smfmac_f32_16x16x64_bf16 v[232:235], v[224:227], v[72:79], v88
    s_waitcnt lgkmcnt(0)
    v_mfma_f32_32x32x16_bf16 v[96:111], v[40:43], v[56:59], v[96:111]
    ds_read_b128 v[80:83], v19 offset:0
    ds_read_b64_tr_b16 v[64:65], v25 offset:4096
    v_mfma_f32_32x32x16_bf16 v[112:127], v[40:43], v[60:63], v[112:127]
    ds_read_b64_tr_b16 v[66:67], v25 offset:5120
    ds_read_b128 v[84:87], v19 offset:4096
    v_mfma_f32_32x32x16_bf16 v[128:143], v[44:47], v[56:59], v[128:143]
    ds_read_b64_tr_b16 v[68:69], v27 offset:4096
    ds_read_b64_tr_b16 v[70:71], v27 offset:5120
    v_mfma_f32_32x32x16_bf16 v[144:159], v[44:47], v[60:63], v[144:159]
    ds_read_b64_tr_b16 v[72:73], v29 offset:4096
    ds_read_b64_tr_b16 v[74:75], v29 offset:5120
    v_mfma_f32_32x32x16_bf16 v[160:175], v[48:51], v[56:59], v[160:175]
    ds_read_b64_tr_b16 v[76:77], v31 offset:4096
    ds_read_b64_tr_b16 v[78:79], v31 offset:5120
    v_mfma_f32_32x32x16_bf16 v[176:191], v[48:51], v[60:63], v[176:191]
    v_mfma_f32_32x32x16_bf16 v[192:207], v[52:55], v[56:59], v[192:207]
    v_mfma_f32_32x32x16_bf16 v[208:223], v[52:55], v[60:63], v[208:223]
    s_waitcnt lgkmcnt(0)
    s_barrier
    v_mfma_f32_32x32x16_bf16 v[96:111], v[64:67], v[80:83], v[96:111]
    ds_read_b128 v[56:59], v16 offset:49152
    ds_read_b64_tr_b16 v[40:41], v24 offset:49152
    v_mfma_f32_32x32x16_bf16 v[112:127], v[64:67], v[84:87], v[112:127]
    ds_read_b64_tr_b16 v[42:43], v24 offset:50176
    ds_read_b128 v[60:63], v16 offset:53248
    v_mfma_f32_32x32x16_bf16 v[128:143], v[68:71], v[80:83], v[128:143]
    ds_read_b64_tr_b16 v[44:45], v26 offset:49152
    ds_read_b64_tr_b16 v[46:47], v26 offset:50176
    v_mfma_f32_32x32x16_bf16 v[144:159], v[68:71], v[84:87], v[144:159]
    ds_read_b64_tr_b16 v[48:49], v28 offset:49152
    ds_read_b64_tr_b16 v[50:51], v28 offset:50176
    v_mfma_f32_32x32x16_bf16 v[160:175], v[72:75], v[80:83], v[160:175]
    ds_read_b64_tr_b16 v[52:53], v30 offset:49152
    ds_read_b64_tr_b16 v[54:55], v30 offset:50176
    v_mfma_f32_32x32x16_bf16 v[176:191], v[72:75], v[84:87], v[176:191]
    v_mfma_f32_32x32x16_bf16 v[192:207], v[76:79], v[80:83], v[192:207]
    v_mfma_f32_32x32x16_bf16 v[208:223], v[76:79], v[84:87], v[208:223]
    s_waitcnt lgkmcnt(0)
    v_mfma_f32_32x32x16_bf16 v[96:111], v[40:43], v[56:59], v[96:111]
    ds_read_b128 v[80:83], v17 offset:49152
    ds_read_b64_tr_b16 v[64:65], v24 offset:53248
    v_mfma_f32_32x32x16_bf16 v[112:127], v[40:43], v[60:63], v[112:127]
    ds_read_b64_tr_b16 v[66:67], v24 offset:54272
    ds_read_b128 v[84:87], v17 offset:53248
    v_mfma_f32_32x32x16_bf16 v[128:143], v[44:47], v[56:59], v[128:143]
    ds_read_b64_tr_b16 v[68:69], v26 offset:53248
    ds_read_b64_tr_b16 v[70:71], v26 offset:54272
    v_mfma_f32_32x32x16_bf16 v[144:159], v[44:47], v[60:63], v[144:159]
    ds_read_b64_tr_b16 v[72:73], v28 offset:53248
    ds_read_b64_tr_b16 v[74:75], v28 offset:54272
    v_mfma_f32_32x32x16_bf16 v[160:175], v[48:51], v[56:59], v[160:175]
    ds_read_b64_tr_b16 v[76:77], v30 offset:53248
    ds_read_b64_tr_b16 v[78:79], v30 offset:54272
    v_mfma_f32_32x32x16_bf16 v[176:191], v[48:51], v[60:63], v[176:191]
    v_mfma_f32_32x32x16_bf16 v[192:207], v[52:55], v[56:59], v[192:207]
    v_mfma_f32_32x32x16_bf16 v[208:223], v[52:55], v[60:63], v[208:223]
    v_smfmac_f32_16x16x64_bf16 v[228:231], v[224:227], v[40:47], v88
    v_smfmac_f32_16x16x64_bf16 v[232:235], v[224:227], v[48:55], v88
    s_waitcnt lgkmcnt(0)
    v_mfma_f32_32x32x16_bf16 v[96:111], v[64:67], v[80:83], v[96:111]
    ds_read_b128 v[56:59], v18 offset:49152
    ds_read_b64_tr_b16 v[40:41], v25 offset:49152
    v_mfma_f32_32x32x16_bf16 v[112:127], v[64:67], v[84:87], v[112:127]
    ds_read_b64_tr_b16 v[42:43], v25 offset:50176
    ds_read_b128 v[60:63], v18 offset:53248
    v_mfma_f32_32x32x16_bf16 v[128:143], v[68:71], v[80:83], v[128:143]
    ds_read_b64_tr_b16 v[44:45], v27 offset:49152
    ds_read_b64_tr_b16 v[46:47], v27 offset:50176
    v_mfma_f32_32x32x16_bf16 v[144:159], v[68:71], v[84:87], v[144:159]
    ds_read_b64_tr_b16 v[48:49], v29 offset:49152
    ds_read_b64_tr_b16 v[50:51], v29 offset:50176
    v_mfma_f32_32x32x16_bf16 v[160:175], v[72:75], v[80:83], v[160:175]
    ds_read_b64_tr_b16 v[52:53], v31 offset:49152
    ds_read_b64_tr_b16 v[54:55], v31 offset:50176
    v_mfma_f32_32x32x16_bf16 v[176:191], v[72:75], v[84:87], v[176:191]
    v_mfma_f32_32x32x16_bf16 v[192:207], v[76:79], v[80:83], v[192:207]
    v_mfma_f32_32x32x16_bf16 v[208:223], v[76:79], v[84:87], v[208:223]
    v_smfmac_f32_16x16x64_bf16 v[228:231], v[224:227], v[64:71], v88
    v_smfmac_f32_16x16x64_bf16 v[232:235], v[224:227], v[72:79], v88
    s_waitcnt lgkmcnt(0)
    v_mfma_f32_32x32x16_bf16 v[96:111], v[40:43], v[56:59], v[96:111]
    ds_read_b128 v[80:83], v19 offset:49152
    ds_read_b64_tr_b16 v[64:65], v25 offset:53248
    v_mfma_f32_32x32x16_bf16 v[112:127], v[40:43], v[60:63], v[112:127]
    ds_read_b64_tr_b16 v[66:67], v25 offset:54272
    ds_read_b128 v[84:87], v19 offset:53248
    v_mfma_f32_32x32x16_bf16 v[128:143], v[44:47], v[56:59], v[128:143]
    ds_read_b64_tr_b16 v[68:69], v27 offset:53248
    ds_read_b64_tr_b16 v[70:71], v27 offset:54272
    v_mfma_f32_32x32x16_bf16 v[144:159], v[44:47], v[60:63], v[144:159]
    ds_read_b64_tr_b16 v[72:73], v29 offset:53248
    ds_read_b64_tr_b16 v[74:75], v29 offset:54272
    v_mfma_f32_32x32x16_bf16 v[160:175], v[48:51], v[56:59], v[160:175]
    ds_read_b64_tr_b16 v[76:77], v31 offset:53248
    ds_read_b64_tr_b16 v[78:79], v31 offset:54272
    v_mfma_f32_32x32x16_bf16 v[176:191], v[48:51], v[60:63], v[176:191]
    v_mfma_f32_32x32x16_bf16 v[192:207], v[52:55], v[56:59], v[192:207]
    v_mfma_f32_32x32x16_bf16 v[208:223], v[52:55], v[60:63], v[208:223]
    s_waitcnt lgkmcnt(0)
    s_barrier
    v_mfma_f32_32x32x16_bf16 v[96:111], v[64:67], v[80:83], v[96:111]
    ds_read_b128 v[56:59], v20 offset:0
    ds_read_b64_tr_b16 v[40:41], v32 offset:0
    v_mfma_f32_32x32x16_bf16 v[112:127], v[64:67], v[84:87], v[112:127]
    ds_read_b64_tr_b16 v[42:43], v32 offset:1024
    ds_read_b128 v[60:63], v20 offset:4096
    v_mfma_f32_32x32x16_bf16 v[128:143], v[68:71], v[80:83], v[128:143]
    ds_read_b64_tr_b16 v[44:45], v34 offset:0
    ds_read_b64_tr_b16 v[46:47], v34 offset:1024
    v_mfma_f32_32x32x16_bf16 v[144:159], v[68:71], v[84:87], v[144:159]
    ds_read_b64_tr_b16 v[48:49], v36 offset:0
    ds_read_b64_tr_b16 v[50:51], v36 offset:1024
    v_mfma_f32_32x32x16_bf16 v[160:175], v[72:75], v[80:83], v[160:175]
    ds_read_b64_tr_b16 v[52:53], v38 offset:0
    ds_read_b64_tr_b16 v[54:55], v38 offset:1024
    v_mfma_f32_32x32x16_bf16 v[176:191], v[72:75], v[84:87], v[176:191]
    v_mfma_f32_32x32x16_bf16 v[192:207], v[76:79], v[80:83], v[192:207]
    v_mfma_f32_32x32x16_bf16 v[208:223], v[76:79], v[84:87], v[208:223]
    s_waitcnt lgkmcnt(0)
    v_mfma_f32_32x32x16_bf16 v[96:111], v[40:43], v[56:59], v[96:111]
    ds_read_b128 v[80:83], v21 offset:0
    ds_read_b64_tr_b16 v[64:65], v32 offset:4096
    v_mfma_f32_32x32x16_bf16 v[112:127], v[40:43], v[60:63], v[112:127]
    ds_read_b64_tr_b16 v[66:67], v32 offset:5120
    ds_read_b128 v[84:87], v21 offset:4096
    v_mfma_f32_32x32x16_bf16 v[128:143], v[44:47], v[56:59], v[128:143]
    ds_read_b64_tr_b16 v[68:69], v34 offset:4096
    ds_read_b64_tr_b16 v[70:71], v34 offset:5120
    v_mfma_f32_32x32x16_bf16 v[144:159], v[44:47], v[60:63], v[144:159]
    ds_read_b64_tr_b16 v[72:73], v36 offset:4096
    ds_read_b64_tr_b16 v[74:75], v36 offset:5120
    v_mfma_f32_32x32x16_bf16 v[160:175], v[48:51], v[56:59], v[160:175]
    ds_read_b64_tr_b16 v[76:77], v38 offset:4096
    ds_read_b64_tr_b16 v[78:79], v38 offset:5120
    v_mfma_f32_32x32x16_bf16 v[176:191], v[48:51], v[60:63], v[176:191]
    v_mfma_f32_32x32x16_bf16 v[192:207], v[52:55], v[56:59], v[192:207]
    v_mfma_f32_32x32x16_bf16 v[208:223], v[52:55], v[60:63], v[208:223]
    v_smfmac_f32_16x16x64_bf16 v[228:231], v[224:227], v[40:47], v88
    v_smfmac_f32_16x16x64_bf16 v[232:235], v[224:227], v[48:55], v88
    s_waitcnt lgkmcnt(0)
    v_mfma_f32_32x32x16_bf16 v[96:111], v[64:67], v[80:83], v[96:111]
    ds_read_b128 v[56:59], v22 offset:0
    ds_read_b64_tr_b16 v[40:41], v33 offset:0
    v_mfma_f32_32x32x16_bf16 v[112:127], v[64:67], v[84:87], v[112:127]
    ds_read_b64_tr_b16 v[42:43], v33 offset:1024
    ds_read_b128 v[60:63], v22 offset:4096
    v_mfma_f32_32x32x16_bf16 v[128:143], v[68:71], v[80:83], v[128:143]
    ds_read_b64_tr_b16 v[44:45], v35 offset:0
    ds_read_b64_tr_b16 v[46:47], v35 offset:1024
    v_mfma_f32_32x32x16_bf16 v[144:159], v[68:71], v[84:87], v[144:159]
    ds_read_b64_tr_b16 v[48:49], v37 offset:0
    ds_read_b64_tr_b16 v[50:51], v37 offset:1024
    v_mfma_f32_32x32x16_bf16 v[160:175], v[72:75], v[80:83], v[160:175]
    ds_read_b64_tr_b16 v[52:53], v39 offset:0
    ds_read_b64_tr_b16 v[54:55], v39 offset:1024
    v_mfma_f32_32x32x16_bf16 v[176:191], v[72:75], v[84:87], v[176:191]
    v_mfma_f32_32x32x16_bf16 v[192:207], v[76:79], v[80:83], v[192:207]
    v_mfma_f32_32x32x16_bf16 v[208:223], v[76:79], v[84:87], v[208:223]
    v_smfmac_f32_16x16x64_bf16 v[228:231], v[224:227], v[64:71], v88
    v_smfmac_f32_16x16x64_bf16 v[232:235], v[224:227], v[72:79], v88
    s_waitcnt lgkmcnt(0)
    v_mfma_f32_32x32x16_bf16 v[96:111], v[40:43], v[56:59], v[96:111]
    ds_read_b128 v[80:83], v23 offset:0
    ds_read_b64_tr_b16 v[64:65], v33 offset:4096
    v_mfma_f32_32x32x16_bf16 v[112:127], v[40:43], v[60:63], v[112:127]
    ds_read_b64_tr_b16 v[66:67], v33 offset:5120
    ds_read_b128 v[84:87], v23 offset:4096
    v_mfma_f32_32x32x16_bf16 v[128:143], v[44:47], v[56:59], v[128:143]
    ds_read_b64_tr_b16 v[68:69], v35 offset:4096
    ds_read_b64_tr_b16 v[70:71], v35 offset:5120
    v_mfma_f32_32x32x16_bf16 v[144:159], v[44:47], v[60:63], v[144:159]
    ds_read_b64_tr_b16 v[72:73], v37 offset:4096
    ds_read_b64_tr_b16 v[74:75], v37 offset:5120
    v_mfma_f32_32x32x16_bf16 v[160:175], v[48:51], v[56:59], v[160:175]
    ds_read_b64_tr_b16 v[76:77], v39 offset:4096
    ds_read_b64_tr_b16 v[78:79], v39 offset:5120
    v_mfma_f32_32x32x16_bf16 v[176:191], v[48:51], v[60:63], v[176:191]
    v_mfma_f32_32x32x16_bf16 v[192:207], v[52:55], v[56:59], v[192:207]
    v_mfma_f32_32x32x16_bf16 v[208:223], v[52:55], v[60:63], v[208:223]
    s_waitcnt lgkmcnt(0)
    s_barrier
    v_mfma_f32_32x32x16_bf16 v[96:111], v[64:67], v[80:83], v[96:111]
    ds_read_b128 v[56:59], v16 offset:0
    ds_read_b64_tr_b16 v[40:41], v24 offset:0
    v_mfma_f32_32x32x16_bf16 v[112:127], v[64:67], v[84:87], v[112:127]
    ds_read_b64_tr_b16 v[42:43], v24 offset:1024
    ds_read_b128 v[60:63], v16 offset:4096
    v_mfma_f32_32x32x16_bf16 v[128:143], v[68:71], v[80:83], v[128:143]
    ds_read_b64_tr_b16 v[44:45], v26 offset:0
    ds_read_b64_tr_b16 v[46:47], v26 offset:1024
    v_mfma_f32_32x32x16_bf16 v[144:159], v[68:71], v[84:87], v[144:159]
    ds_read_b64_tr_b16 v[48:49], v28 offset:0
    ds_read_b64_tr_b16 v[50:51], v28 offset:1024
    v_mfma_f32_32x32x16_bf16 v[160:175], v[72:75], v[80:83], v[160:175]
    ds_read_b64_tr_b16 v[52:53], v30 offset:0
    ds_read_b64_tr_b16 v[54:55], v30 offset:1024
    v_mfma_f32_32x32x16_bf16 v[176:191], v[72:75], v[84:87], v[176:191]
    v_mfma_f32_32x32x16_bf16 v[192:207], v[76:79], v[80:83], v[192:207]
    v_mfma_f32_32x32x16_bf16 v[208:223], v[76:79], v[84:87], v[208:223]
    s_waitcnt lgkmcnt(0)
    v_mfma_f32_32x32x16_bf16 v[96:111], v[40:43], v[56:59], v[96:111]
    ds_read_b128 v[80:83], v17 offset:0
    ds_read_b64_tr_b16 v[64:65], v24 offset:4096
    v_mfma_f32_32x32x16_bf16 v[112:127], v[40:43], v[60:63], v[112:127]
    ds_read_b64_tr_b16 v[66:67], v24 offset:5120
    ds_read_b128 v[84:87], v17 offset:4096
    v_mfma_f32_32x32x16_bf16 v[128:143], v[44:47], v[56:59], v[128:143]
    ds_read_b64_tr_b16 v[68:69], v26 offset:4096
    ds_read_b64_tr_b16 v[70:71], v26 offset:5120
    v_mfma_f32_32x32x16_bf16 v[144:159], v[44:47], v[60:63], v[144:159]
    ds_read_b64_tr_b16 v[72:73], v28 offset:4096
    ds_read_b64_tr_b16 v[74:75], v28 offset:5120
    v_mfma_f32_32x32x16_bf16 v[160:175], v[48:51], v[56:59], v[160:175]
    ds_read_b64_tr_b16 v[76:77], v30 offset:4096
    ds_read_b64_tr_b16 v[78:79], v30 offset:5120
    v_mfma_f32_32x32x16_bf16 v[176:191], v[48:51], v[60:63], v[176:191]
    v_mfma_f32_32x32x16_bf16 v[192:207], v[52:55], v[56:59], v[192:207]
    v_mfma_f32_32x32x16_bf16 v[208:223], v[52:55], v[60:63], v[208:223]
    v_smfmac_f32_16x16x64_bf16 v[228:231], v[224:227], v[40:47], v88
    v_smfmac_f32_16x16x64_bf16 v[232:235], v[224:227], v[48:55], v88
    s_waitcnt lgkmcnt(0)
    v_mfma_f32_32x32x16_bf16 v[96:111], v[64:67], v[80:83], v[96:111]
    ds_read_b128 v[56:59], v18 offset:0
    ds_read_b64_tr_b16 v[40:41], v25 offset:0
    v_mfma_f32_32x32x16_bf16 v[112:127], v[64:67], v[84:87], v[112:127]
    ds_read_b64_tr_b16 v[42:43], v25 offset:1024
    ds_read_b128 v[60:63], v18 offset:4096
    v_mfma_f32_32x32x16_bf16 v[128:143], v[68:71], v[80:83], v[128:143]
    ds_read_b64_tr_b16 v[44:45], v27 offset:0
    ds_read_b64_tr_b16 v[46:47], v27 offset:1024
    v_mfma_f32_32x32x16_bf16 v[144:159], v[68:71], v[84:87], v[144:159]
    ds_read_b64_tr_b16 v[48:49], v29 offset:0
    ds_read_b64_tr_b16 v[50:51], v29 offset:1024
    v_mfma_f32_32x32x16_bf16 v[160:175], v[72:75], v[80:83], v[160:175]
    ds_read_b64_tr_b16 v[52:53], v31 offset:0
    ds_read_b64_tr_b16 v[54:55], v31 offset:1024
    v_mfma_f32_32x32x16_bf16 v[176:191], v[72:75], v[84:87], v[176:191]
    v_mfma_f32_32x32x16_bf16 v[192:207], v[76:79], v[80:83], v[192:207]
    v_mfma_f32_32x32x16_bf16 v[208:223], v[76:79], v[84:87], v[208:223]
    v_smfmac_f32_16x16x64_bf16 v[228:231], v[224:227], v[64:71], v88
    v_smfmac_f32_16x16x64_bf16 v[232:235], v[224:227], v[72:79], v88
    s_waitcnt lgkmcnt(0)
    v_mfma_f32_32x32x16_bf16 v[96:111], v[40:43], v[56:59], v[96:111]
    ds_read_b128 v[80:83], v19 offset:0
    ds_read_b64_tr_b16 v[64:65], v25 offset:4096
    v_mfma_f32_32x32x16_bf16 v[112:127], v[40:43], v[60:63], v[112:127]
    ds_read_b64_tr_b16 v[66:67], v25 offset:5120
    ds_read_b128 v[84:87], v19 offset:4096
    v_mfma_f32_32x32x16_bf16 v[128:143], v[44:47], v[56:59], v[128:143]
    ds_read_b64_tr_b16 v[68:69], v27 offset:4096
    ds_read_b64_tr_b16 v[70:71], v27 offset:5120
    v_mfma_f32_32x32x16_bf16 v[144:159], v[44:47], v[60:63], v[144:159]
    ds_read_b64_tr_b16 v[72:73], v29 offset:4096
    ds_read_b64_tr_b16 v[74:75], v29 offset:5120
    v_mfma_f32_32x32x16_bf16 v[160:175], v[48:51], v[56:59], v[160:175]
    ds_read_b64_tr_b16 v[76:77], v31 offset:4096
    ds_read_b64_tr_b16 v[78:79], v31 offset:5120
    v_mfma_f32_32x32x16_bf16 v[176:191], v[48:51], v[60:63], v[176:191]
    v_mfma_f32_32x32x16_bf16 v[192:207], v[52:55], v[56:59], v[192:207]
    v_mfma_f32_32x32x16_bf16 v[208:223], v[52:55], v[60:63], v[208:223]
    s_waitcnt lgkmcnt(0)
    s_barrier
    v_mfma_f32_32x32x16_bf16 v[96:111], v[64:67], v[80:83], v[96:111]
    ds_read_b128 v[56:59], v16 offset:49152
    ds_read_b64_tr_b16 v[40:41], v24 offset:49152
    v_mfma_f32_32x32x16_bf16 v[112:127], v[64:67], v[84:87], v[112:127]
    ds_read_b64_tr_b16 v[42:43], v24 offset:50176
    ds_read_b128 v[60:63], v16 offset:53248
    v_mfma_f32_32x32x16_bf16 v[128:143], v[68:71], v[80:83], v[128:143]
    ds_read_b64_tr_b16 v[44:45], v26 offset:49152
    ds_read_b64_tr_b16 v[46:47], v26 offset:50176
    v_mfma_f32_32x32x16_bf16 v[144:159], v[68:71], v[84:87], v[144:159]
    ds_read_b64_tr_b16 v[48:49], v28 offset:49152
    ds_read_b64_tr_b16 v[50:51], v28 offset:50176
    v_mfma_f32_32x32x16_bf16 v[160:175], v[72:75], v[80:83], v[160:175]
    ds_read_b64_tr_b16 v[52:53], v30 offset:49152
    ds_read_b64_tr_b16 v[54:55], v30 offset:50176
    v_mfma_f32_32x32x16_bf16 v[176:191], v[72:75], v[84:87], v[176:191]
    v_mfma_f32_32x32x16_bf16 v[192:207], v[76:79], v[80:83], v[192:207]
    v_mfma_f32_32x32x16_bf16 v[208:223], v[76:79], v[84:87], v[208:223]
    s_waitcnt lgkmcnt(0)
    v_mfma_f32_32x32x16_bf16 v[96:111], v[40:43], v[56:59], v[96:111]
    ds_read_b128 v[80:83], v17 offset:49152
    ds_read_b64_tr_b16 v[64:65], v24 offset:53248
    v_mfma_f32_32x32x16_bf16 v[112:127], v[40:43], v[60:63], v[112:127]
    ds_read_b64_tr_b16 v[66:67], v24 offset:54272
    ds_read_b128 v[84:87], v17 offset:53248
    v_mfma_f32_32x32x16_bf16 v[128:143], v[44:47], v[56:59], v[128:143]
    ds_read_b64_tr_b16 v[68:69], v26 offset:53248
    ds_read_b64_tr_b16 v[70:71], v26 offset:54272
    v_mfma_f32_32x32x16_bf16 v[144:159], v[44:47], v[60:63], v[144:159]
    ds_read_b64_tr_b16 v[72:73], v28 offset:53248
    ds_read_b64_tr_b16 v[74:75], v28 offset:54272
    v_mfma_f32_32x32x16_bf16 v[160:175], v[48:51], v[56:59], v[160:175]
    ds_read_b64_tr_b16 v[76:77], v30 offset:53248
    ds_read_b64_tr_b16 v[78:79], v30 offset:54272
    v_mfma_f32_32x32x16_bf16 v[176:191], v[48:51], v[60:63], v[176:191]
    v_mfma_f32_32x32x16_bf16 v[192:207], v[52:55], v[56:59], v[192:207]
    v_mfma_f32_32x32x16_bf16 v[208:223], v[52:55], v[60:63], v[208:223]
    v_smfmac_f32_16x16x64_bf16 v[228:231], v[224:227], v[40:47], v88
    v_smfmac_f32_16x16x64_bf16 v[232:235], v[224:227], v[48:55], v88
    s_waitcnt lgkmcnt(0)
    v_mfma_f32_32x32x16_bf16 v[96:111], v[64:67], v[80:83], v[96:111]
    ds_read_b128 v[56:59], v18 offset:49152
    ds_read_b64_tr_b16 v[40:41], v25 offset:49152
    v_mfma_f32_32x32x16_bf16 v[112:127], v[64:67], v[84:87], v[112:127]
    ds_read_b64_tr_b16 v[42:43], v25 offset:50176
    ds_read_b128 v[60:63], v18 offset:53248
    v_mfma_f32_32x32x16_bf16 v[128:143], v[68:71], v[80:83], v[128:143]
    ds_read_b64_tr_b16 v[44:45], v27 offset:49152
    ds_read_b64_tr_b16 v[46:47], v27 offset:50176
    v_mfma_f32_32x32x16_bf16 v[144:159], v[68:71], v[84:87], v[144:159]
    ds_read_b64_tr_b16 v[48:49], v29 offset:49152
    ds_read_b64_tr_b16 v[50:51], v29 offset:50176
    v_mfma_f32_32x32x16_bf16 v[160:175], v[72:75], v[80:83], v[160:175]
    ds_read_b64_tr_b16 v[52:53], v31 offset:49152
    ds_read_b64_tr_b16 v[54:55], v31 offset:50176
    v_mfma_f32_32x32x16_bf16 v[176:191], v[72:75], v[84:87], v[176:191]
    v_mfma_f32_32x32x16_bf16 v[192:207], v[76:79], v[80:83], v[192:207]
    v_mfma_f32_32x32x16_bf16 v[208:223], v[76:79], v[84:87], v[208:223]
    v_smfmac_f32_16x16x64_bf16 v[228:231], v[224:227], v[64:71], v88
    v_smfmac_f32_16x16x64_bf16 v[232:235], v[224:227], v[72:79], v88
    s_waitcnt lgkmcnt(0)
    v_mfma_f32_32x32x16_bf16 v[96:111], v[40:43], v[56:59], v[96:111]
    ds_read_b128 v[80:83], v19 offset:49152
    ds_read_b64_tr_b16 v[64:65], v25 offset:53248
    v_mfma_f32_32x32x16_bf16 v[112:127], v[40:43], v[60:63], v[112:127]
    ds_read_b64_tr_b16 v[66:67], v25 offset:54272
    ds_read_b128 v[84:87], v19 offset:53248
    v_mfma_f32_32x32x16_bf16 v[128:143], v[44:47], v[56:59], v[128:143]
    ds_read_b64_tr_b16 v[68:69], v27 offset:53248
    ds_read_b64_tr_b16 v[70:71], v27 offset:54272
    v_mfma_f32_32x32x16_bf16 v[144:159], v[44:47], v[60:63], v[144:159]
    ds_read_b64_tr_b16 v[72:73], v29 offset:53248
    ds_read_b64_tr_b16 v[74:75], v29 offset:54272
    v_mfma_f32_32x32x16_bf16 v[160:175], v[48:51], v[56:59], v[160:175]
    ds_read_b64_tr_b16 v[76:77], v31 offset:53248
    ds_read_b64_tr_b16 v[78:79], v31 offset:54272
    v_mfma_f32_32x32x16_bf16 v[176:191], v[48:51], v[60:63], v[176:191]
    v_mfma_f32_32x32x16_bf16 v[192:207], v[52:55], v[56:59], v[192:207]
    v_mfma_f32_32x32x16_bf16 v[208:223], v[52:55], v[60:63], v[208:223]
    s_waitcnt lgkmcnt(0)
    s_barrier
    v_mfma_f32_32x32x16_bf16 v[96:111], v[64:67], v[80:83], v[96:111]
    ds_read_b128 v[56:59], v20 offset:0
    ds_read_b64_tr_b16 v[40:41], v32 offset:0
    v_mfma_f32_32x32x16_bf16 v[112:127], v[64:67], v[84:87], v[112:127]
    ds_read_b64_tr_b16 v[42:43], v32 offset:1024
    ds_read_b128 v[60:63], v20 offset:4096
    v_mfma_f32_32x32x16_bf16 v[128:143], v[68:71], v[80:83], v[128:143]
    ds_read_b64_tr_b16 v[44:45], v34 offset:0
    ds_read_b64_tr_b16 v[46:47], v34 offset:1024
    v_mfma_f32_32x32x16_bf16 v[144:159], v[68:71], v[84:87], v[144:159]
    ds_read_b64_tr_b16 v[48:49], v36 offset:0
    ds_read_b64_tr_b16 v[50:51], v36 offset:1024
    v_mfma_f32_32x32x16_bf16 v[160:175], v[72:75], v[80:83], v[160:175]
    ds_read_b64_tr_b16 v[52:53], v38 offset:0
    ds_read_b64_tr_b16 v[54:55], v38 offset:1024
    v_mfma_f32_32x32x16_bf16 v[176:191], v[72:75], v[84:87], v[176:191]
    v_mfma_f32_32x32x16_bf16 v[192:207], v[76:79], v[80:83], v[192:207]
    v_mfma_f32_32x32x16_bf16 v[208:223], v[76:79], v[84:87], v[208:223]
    s_waitcnt lgkmcnt(0)
    v_mfma_f32_32x32x16_bf16 v[96:111], v[40:43], v[56:59], v[96:111]
    ds_read_b128 v[80:83], v21 offset:0
    ds_read_b64_tr_b16 v[64:65], v32 offset:4096
    v_mfma_f32_32x32x16_bf16 v[112:127], v[40:43], v[60:63], v[112:127]
    ds_read_b64_tr_b16 v[66:67], v32 offset:5120
    ds_read_b128 v[84:87], v21 offset:4096
    v_mfma_f32_32x32x16_bf16 v[128:143], v[44:47], v[56:59], v[128:143]
    ds_read_b64_tr_b16 v[68:69], v34 offset:4096
    ds_read_b64_tr_b16 v[70:71], v34 offset:5120
    v_mfma_f32_32x32x16_bf16 v[144:159], v[44:47], v[60:63], v[144:159]
    ds_read_b64_tr_b16 v[72:73], v36 offset:4096
    ds_read_b64_tr_b16 v[74:75], v36 offset:5120
    v_mfma_f32_32x32x16_bf16 v[160:175], v[48:51], v[56:59], v[160:175]
    ds_read_b64_tr_b16 v[76:77], v38 offset:4096
    ds_read_b64_tr_b16 v[78:79], v38 offset:5120
    v_mfma_f32_32x32x16_bf16 v[176:191], v[48:51], v[60:63], v[176:191]
    v_mfma_f32_32x32x16_bf16 v[192:207], v[52:55], v[56:59], v[192:207]
    v_mfma_f32_32x32x16_bf16 v[208:223], v[52:55], v[60:63], v[208:223]
    v_smfmac_f32_16x16x64_bf16 v[228:231], v[224:227], v[40:47], v88
    v_smfmac_f32_16x16x64_bf16 v[232:235], v[224:227], v[48:55], v88
    s_waitcnt lgkmcnt(0)
    v_mfma_f32_32x32x16_bf16 v[96:111], v[64:67], v[80:83], v[96:111]
    ds_read_b128 v[56:59], v22 offset:0
    ds_read_b64_tr_b16 v[40:41], v33 offset:0
    v_mfma_f32_32x32x16_bf16 v[112:127], v[64:67], v[84:87], v[112:127]
    ds_read_b64_tr_b16 v[42:43], v33 offset:1024
    ds_read_b128 v[60:63], v22 offset:4096
    v_mfma_f32_32x32x16_bf16 v[128:143], v[68:71], v[80:83], v[128:143]
    ds_read_b64_tr_b16 v[44:45], v35 offset:0
    ds_read_b64_tr_b16 v[46:47], v35 offset:1024
    v_mfma_f32_32x32x16_bf16 v[144:159], v[68:71], v[84:87], v[144:159]
    ds_read_b64_tr_b16 v[48:49], v37 offset:0
    ds_read_b64_tr_b16 v[50:51], v37 offset:1024
    v_mfma_f32_32x32x16_bf16 v[160:175], v[72:75], v[80:83], v[160:175]
    ds_read_b64_tr_b16 v[52:53], v39 offset:0
    ds_read_b64_tr_b16 v[54:55], v39 offset:1024
    v_mfma_f32_32x32x16_bf16 v[176:191], v[72:75], v[84:87], v[176:191]
    v_mfma_f32_32x32x16_bf16 v[192:207], v[76:79], v[80:83], v[192:207]
    v_mfma_f32_32x32x16_bf16 v[208:223], v[76:79], v[84:87], v[208:223]
    v_smfmac_f32_16x16x64_bf16 v[228:231], v[224:227], v[64:71], v88
    v_smfmac_f32_16x16x64_bf16 v[232:235], v[224:227], v[72:79], v88
    s_waitcnt lgkmcnt(0)
    v_mfma_f32_32x32x16_bf16 v[96:111], v[40:43], v[56:59], v[96:111]
    ds_read_b128 v[80:83], v23 offset:0
    ds_read_b64_tr_b16 v[64:65], v33 offset:4096
    v_mfma_f32_32x32x16_bf16 v[112:127], v[40:43], v[60:63], v[112:127]
    ds_read_b64_tr_b16 v[66:67], v33 offset:5120
    ds_read_b128 v[84:87], v23 offset:4096
    v_mfma_f32_32x32x16_bf16 v[128:143], v[44:47], v[56:59], v[128:143]
    ds_read_b64_tr_b16 v[68:69], v35 offset:4096
    ds_read_b64_tr_b16 v[70:71], v35 offset:5120
    v_mfma_f32_32x32x16_bf16 v[144:159], v[44:47], v[60:63], v[144:159]
    ds_read_b64_tr_b16 v[72:73], v37 offset:4096
    ds_read_b64_tr_b16 v[74:75], v37 offset:5120
    v_mfma_f32_32x32x16_bf16 v[160:175], v[48:51], v[56:59], v[160:175]
    ds_read_b64_tr_b16 v[76:77], v39 offset:4096
    ds_read_b64_tr_b16 v[78:79], v39 offset:5120
    v_mfma_f32_32x32x16_bf16 v[176:191], v[48:51], v[60:63], v[176:191]
    v_mfma_f32_32x32x16_bf16 v[192:207], v[52:55], v[56:59], v[192:207]
    v_mfma_f32_32x32x16_bf16 v[208:223], v[52:55], v[60:63], v[208:223]
    s_waitcnt lgkmcnt(0)
    s_barrier
    v_mfma_f32_32x32x16_bf16 v[96:111], v[64:67], v[80:83], v[96:111]
    ds_read_b128 v[56:59], v16 offset:0
    ds_read_b64_tr_b16 v[40:41], v24 offset:0
    v_mfma_f32_32x32x16_bf16 v[112:127], v[64:67], v[84:87], v[112:127]
    ds_read_b64_tr_b16 v[42:43], v24 offset:1024
    ds_read_b128 v[60:63], v16 offset:4096
    v_mfma_f32_32x32x16_bf16 v[128:143], v[68:71], v[80:83], v[128:143]
    ds_read_b64_tr_b16 v[44:45], v26 offset:0
    ds_read_b64_tr_b16 v[46:47], v26 offset:1024
    v_mfma_f32_32x32x16_bf16 v[144:159], v[68:71], v[84:87], v[144:159]
    ds_read_b64_tr_b16 v[48:49], v28 offset:0
    ds_read_b64_tr_b16 v[50:51], v28 offset:1024
    v_mfma_f32_32x32x16_bf16 v[160:175], v[72:75], v[80:83], v[160:175]
    ds_read_b64_tr_b16 v[52:53], v30 offset:0
    ds_read_b64_tr_b16 v[54:55], v30 offset:1024
    v_mfma_f32_32x32x16_bf16 v[176:191], v[72:75], v[84:87], v[176:191]
    v_mfma_f32_32x32x16_bf16 v[192:207], v[76:79], v[80:83], v[192:207]
    v_mfma_f32_32x32x16_bf16 v[208:223], v[76:79], v[84:87], v[208:223]
    s_lshl_b32 s36, s29, 10
    s_lshl_b32 s37, s64, 9
    s_add_u32 s36, s36, s37
    s_add_u32 s36, s36, 3932160
    v_and_b32 v7, 0xff, v3
    buffer_load_dwordx2 v[12:13], v7, s[16:19], s36 offen sc1
    buffer_load_dwordx2 v[14:15], v7, s[16:19], s36 offen offset:256 sc1
    s_waitcnt lgkmcnt(0)
    v_mfma_f32_32x32x16_bf16 v[96:111], v[40:43], v[56:59], v[96:111]
    ds_read_b128 v[80:83], v17 offset:0
    ds_read_b64_tr_b16 v[64:65], v24 offset:4096
    v_mfma_f32_32x32x16_bf16 v[112:127], v[40:43], v[60:63], v[112:127]
    ds_read_b64_tr_b16 v[66:67], v24 offset:5120
    ds_read_b128 v[84:87], v17 offset:4096
    v_mfma_f32_32x32x16_bf16 v[128:143], v[44:47], v[56:59], v[128:143]
    ds_read_b64_tr_b16 v[68:69], v26 offset:4096
    ds_read_b64_tr_b16 v[70:71], v26 offset:5120
    v_mfma_f32_32x32x16_bf16 v[144:159], v[44:47], v[60:63], v[144:159]
    ds_read_b64_tr_b16 v[72:73], v28 offset:4096
    ds_read_b64_tr_b16 v[74:75], v28 offset:5120
    v_mfma_f32_32x32x16_bf16 v[160:175], v[48:51], v[56:59], v[160:175]
    ds_read_b64_tr_b16 v[76:77], v30 offset:4096
    ds_read_b64_tr_b16 v[78:79], v30 offset:5120
    v_mfma_f32_32x32x16_bf16 v[176:191], v[48:51], v[60:63], v[176:191]
    v_mfma_f32_32x32x16_bf16 v[192:207], v[52:55], v[56:59], v[192:207]
    v_mfma_f32_32x32x16_bf16 v[208:223], v[52:55], v[60:63], v[208:223]
    v_smfmac_f32_16x16x64_bf16 v[228:231], v[224:227], v[40:47], v88
    v_smfmac_f32_16x16x64_bf16 v[232:235], v[224:227], v[48:55], v88
    s_waitcnt lgkmcnt(0)
    v_smfmac_f32_16x16x64_bf16 v[228:231], v[224:227], v[64:71], v88
    v_smfmac_f32_16x16x64_bf16 v[232:235], v[224:227], v[72:79], v88
    v_mfma_f32_32x32x16_bf16 v[96:111], v[64:67], v[80:83], v[96:111]
    ds_read_b128 v[56:59], v18 offset:0
    ds_read_b64_tr_b16 v[40:41], v25 offset:0
    v_mfma_f32_32x32x16_bf16 v[112:127], v[64:67], v[84:87], v[112:127]
    ds_read_b64_tr_b16 v[42:43], v25 offset:1024
    ds_read_b128 v[60:63], v18 offset:4096
    v_mfma_f32_32x32x16_bf16 v[128:143], v[68:71], v[80:83], v[128:143]
    ds_read_b64_tr_b16 v[44:45], v27 offset:0
    ds_read_b64_tr_b16 v[46:47], v27 offset:1024
    v_mfma_f32_32x32x16_bf16 v[144:159], v[68:71], v[84:87], v[144:159]
    ds_read_b64_tr_b16 v[48:49], v29 offset:0
    ds_read_b64_tr_b16 v[50:51], v29 offset:1024
    v_mfma_f32_32x32x16_bf16 v[160:175], v[72:75], v[80:83], v[160:175]
    ds_read_b64_tr_b16 v[52:53], v31 offset:0
    ds_read_b64_tr_b16 v[54:55], v31 offset:1024
    v_mfma_f32_32x32x16_bf16 v[176:191], v[72:75], v[84:87], v[176:191]
    v_mfma_f32_32x32x16_bf16 v[192:207], v[76:79], v[80:83], v[192:207]
    v_mfma_f32_32x32x16_bf16 v[208:223], v[76:79], v[84:87], v[208:223]
    s_lshl_b32 s36, s64, 10
    s_mul_i32 s37, s65, 512
    s_add_u32 s36, s36, s37
    s_add_u32 s36, s36, 153600
    v_add_u32 v6, s36, v89
    v_add_f32 v228, v228, v229
    v_add_f32 v232, v232, v233
    ds_write_b32 v6, v228
    ds_write_b32 v6, v232 offset:256
    s_waitcnt lgkmcnt(0)
    s_barrier
    v_mfma_f32_32x32x16_bf16 v[96:111], v[40:43], v[56:59], v[96:111]
    ds_read_b128 v[80:83], v19 offset:0
    ds_read_b64_tr_b16 v[64:65], v25 offset:4096
    v_mfma_f32_32x32x16_bf16 v[112:127], v[40:43], v[60:63], v[112:127]
    ds_read_b64_tr_b16 v[66:67], v25 offset:5120
    ds_read_b128 v[84:87], v19 offset:4096
    v_mfma_f32_32x32x16_bf16 v[128:143], v[44:47], v[56:59], v[128:143]
    ds_read_b64_tr_b16 v[68:69], v27 offset:4096
    ds_read_b64_tr_b16 v[70:71], v27 offset:5120
    v_mfma_f32_32x32x16_bf16 v[144:159], v[44:47], v[60:63], v[144:159]
    ds_read_b64_tr_b16 v[72:73], v29 offset:4096
    ds_read_b64_tr_b16 v[74:75], v29 offset:5120
    v_mfma_f32_32x32x16_bf16 v[160:175], v[48:51], v[56:59], v[160:175]
    ds_read_b64_tr_b16 v[76:77], v31 offset:4096
    ds_read_b64_tr_b16 v[78:79], v31 offset:5120
    v_mfma_f32_32x32x16_bf16 v[176:191], v[48:51], v[60:63], v[176:191]
    v_mfma_f32_32x32x16_bf16 v[192:207], v[52:55], v[56:59], v[192:207]
    v_mfma_f32_32x32x16_bf16 v[208:223], v[52:55], v[60:63], v[208:223]
    s_waitcnt lgkmcnt(0)
    s_barrier
    v_mfma_f32_32x32x16_bf16 v[96:111], v[64:67], v[80:83], v[96:111]
    v_lshrrev_b32 v9, 5, v1
    s_mul_i32 s36, s65, 512
    s_add_u32 s36, s36, 147456
    v_lshl_add_u32 v9, v9, 4, s36
    ds_read_b128 v[40:43], v9 offset:0
    ds_read_b128 v[44:47], v9 offset:32
    ds_read_b128 v[48:51], v9 offset:64
    ds_read_b128 v[52:55], v9 offset:96
    v_mfma_f32_32x32x16_bf16 v[112:127], v[64:67], v[84:87], v[112:127]
    ds_read_b128 v[16:19], v9 offset:128
    ds_read_b128 v[20:23], v9 offset:160
    ds_read_b128 v[24:27], v9 offset:192
    ds_read_b128 v[28:31], v9 offset:224
    v_mfma_f32_32x32x16_bf16 v[128:143], v[68:71], v[80:83], v[128:143]
    v_mfma_f32_32x32x16_bf16 v[144:159], v[68:71], v[84:87], v[144:159]
    v_mfma_f32_32x32x16_bf16 v[160:175], v[72:75], v[80:83], v[160:175]
    v_mfma_f32_32x32x16_bf16 v[176:191], v[72:75], v[84:87], v[176:191]
    v_mfma_f32_32x32x16_bf16 v[192:207], v[76:79], v[80:83], v[192:207]
    v_mfma_f32_32x32x16_bf16 v[208:223], v[76:79], v[84:87], v[208:223]
    s_setprio 2
    s_waitcnt vmcnt(0)
    v_rcp_f32 v240, v13
    v_mul_f32 v241, v13, v13
    v_mul_f32 v240, 0xbfb8aa3b, v240
    v_rcp_f32 v242, v15
    v_mul_f32 v243, v15, v15
    v_mul_f32 v242, 0xbfb8aa3b, v242
    s_lshl_b32 s36, s29, 1
    s_add_u32 s36, s36, s64
    s_mul_i32 s36, s36, 272
    s_lshl_b32 s37, s30, 1
    s_add_u32 s37, s37, s65
    s_lshl_b32 s37, s37, 2
    s_add_u32 s36, s36, s37
    s_lshl_b32 s36, s36, 10
    s_add_u32 s33, s36, 4194304
    s_add_u32 s34, s33, 139264
    s_lshl_b32 s36, s74, 12
    s_add_u32 s36, s36, 131072
    v_add_u32 v8, s36, v2
    s_waitcnt lgkmcnt(4)
    v_pk_fma_f32 v[96:97], v[40:41], v[12:13], v[96:97] op_sel_hi:[1,0,1] neg_lo:[0,1,0] neg_hi:[0,1,0]
    v_pk_fma_f32 v[98:99], v[42:43], v[12:13], v[98:99] op_sel_hi:[1,0,1] neg_lo:[0,1,0] neg_hi:[0,1,0]
    v_pk_fma_f32 v[100:101], v[44:45], v[12:13], v[100:101] op_sel_hi:[1,0,1] neg_lo:[0,1,0] neg_hi:[0,1,0]
    v_pk_fma_f32 v[102:103], v[46:47], v[12:13], v[102:103] op_sel_hi:[1,0,1] neg_lo:[0,1,0] neg_hi:[0,1,0]
    v_pk_fma_f32 v[104:105], v[48:49], v[12:13], v[104:105] op_sel_hi:[1,0,1] neg_lo:[0,1,0] neg_hi:[0,1,0]
    v_pk_fma_f32 v[106:107], v[50:51], v[12:13], v[106:107] op_sel_hi:[1,0,1] neg_lo:[0,1,0] neg_hi:[0,1,0]
    v_pk_fma_f32 v[108:109], v[52:53], v[12:13], v[108:109] op_sel_hi:[1,0,1] neg_lo:[0,1,0] neg_hi:[0,1,0]
    v_pk_fma_f32 v[110:111], v[54:55], v[12:13], v[110:111] op_sel_hi:[1,0,1] neg_lo:[0,1,0] neg_hi:[0,1,0]
    v_pk_fma_f32 v[112:113], v[40:41], v[14:15], v[112:113] op_sel_hi:[1,0,1] neg_lo:[0,1,0] neg_hi:[0,1,0]
    v_pk_fma_f32 v[114:115], v[42:43], v[14:15], v[114:115] op_sel_hi:[1,0,1] neg_lo:[0,1,0] neg_hi:[0,1,0]
    v_pk_fma_f32 v[116:117], v[44:45], v[14:15], v[116:117] op_sel_hi:[1,0,1] neg_lo:[0,1,0] neg_hi:[0,1,0]
    v_pk_fma_f32 v[118:119], v[46:47], v[14:15], v[118:119] op_sel_hi:[1,0,1] neg_lo:[0,1,0] neg_hi:[0,1,0]
    v_pk_fma_f32 v[120:121], v[48:49], v[14:15], v[120:121] op_sel_hi:[1,0,1] neg_lo:[0,1,0] neg_hi:[0,1,0]
    v_pk_fma_f32 v[122:123], v[50:51], v[14:15], v[122:123] op_sel_hi:[1,0,1] neg_lo:[0,1,0] neg_hi:[0,1,0]
    v_pk_fma_f32 v[124:125], v[52:53], v[14:15], v[124:125] op_sel_hi:[1,0,1] neg_lo:[0,1,0] neg_hi:[0,1,0]
    v_pk_fma_f32 v[126:127], v[54:55], v[14:15], v[126:127] op_sel_hi:[1,0,1] neg_lo:[0,1,0] neg_hi:[0,1,0]
    ds_read_b128 v[40:43], v9 offset:256
    ds_read_b128 v[44:47], v9 offset:288
    ds_read_b128 v[48:51], v9 offset:320
    ds_read_b128 v[52:55], v9 offset:352
    v_pk_mul_f32 v[244:245], v[96:97], v[240:241] op_sel_hi:[1,0]
    v_pk_mul_f32 v[246:247], v[98:99], v[240:241] op_sel_hi:[1,0]
    v_pk_mul_f32 v[248:249], v[100:101], v[240:241] op_sel_hi:[1,0]
    v_pk_mul_f32 v[250:251], v[102:103], v[240:241] op_sel_hi:[1,0]
    v_exp_f32 v244, v244
    v_exp_f32 v245, v245
    v_exp_f32 v246, v246
    v_exp_f32 v247, v247
    v_exp_f32 v248, v248
    v_exp_f32 v249, v249
    v_exp_f32 v250, v250
    v_exp_f32 v251, v251
    v_pk_mul_f32 v[96:97], v[96:97], v[104:105]
    v_pk_mul_f32 v[98:99], v[98:99], v[106:107]
    v_pk_mul_f32 v[100:101], v[100:101], v[108:109]
    v_pk_mul_f32 v[102:103], v[102:103], v[110:111]
    v_pk_fma_f32 v[244:245], v[244:245], v[240:241], v[240:241] op_sel:[0,1,1] op_sel_hi:[1,1,1]
    v_pk_fma_f32 v[246:247], v[246:247], v[240:241], v[240:241] op_sel:[0,1,1] op_sel_hi:[1,1,1]
    v_pk_fma_f32 v[248:249], v[248:249], v[240:241], v[240:241] op_sel:[0,1,1] op_sel_hi:[1,1,1]
    v_pk_fma_f32 v[250:251], v[250:251], v[240:241], v[240:241] op_sel:[0,1,1] op_sel_hi:[1,1,1]
    v_rcp_f32 v244, v244
    v_rcp_f32 v245, v245
    v_rcp_f32 v246, v246
    v_rcp_f32 v247, v247
    v_rcp_f32 v248, v248
    v_rcp_f32 v249, v249
    v_rcp_f32 v250, v250
    v_rcp_f32 v251, v251
    s_nop 0
    v_pk_mul_f32 v[96:97], v[96:97], v[244:245]
    v_pk_mul_f32 v[98:99], v[98:99], v[246:247]
    v_pk_mul_f32 v[100:101], v[100:101], v[248:249]
    v_pk_mul_f32 v[102:103], v[102:103], v[250:251]
    v_cvt_pk_bf16_f32 v224, v96, v97
    v_cvt_pk_bf16_f32 v225, v98, v99
    v_cvt_pk_bf16_f32 v226, v100, v101
    v_cvt_pk_bf16_f32 v227, v102, v103
    v_pk_mul_f32 v[244:245], v[112:113], v[242:243] op_sel_hi:[1,0]
    v_pk_mul_f32 v[246:247], v[114:115], v[242:243] op_sel_hi:[1,0]
    v_pk_mul_f32 v[248:249], v[116:117], v[242:243] op_sel_hi:[1,0]
    v_pk_mul_f32 v[250:251], v[118:119], v[242:243] op_sel_hi:[1,0]
    v_exp_f32 v244, v244
    v_exp_f32 v245, v245
    v_exp_f32 v246, v246
    v_exp_f32 v247, v247
    v_exp_f32 v248, v248
    v_exp_f32 v249, v249
    v_exp_f32 v250, v250
    v_exp_f32 v251, v251
    v_pk_mul_f32 v[112:113], v[112:113], v[120:121]
    v_pk_mul_f32 v[114:115], v[114:115], v[122:123]
    v_pk_mul_f32 v[116:117], v[116:117], v[124:125]
    v_pk_mul_f32 v[118:119], v[118:119], v[126:127]
    v_pk_fma_f32 v[244:245], v[244:245], v[242:243], v[242:243] op_sel:[0,1,1] op_sel_hi:[1,1,1]
    v_pk_fma_f32 v[246:247], v[246:247], v[242:243], v[242:243] op_sel:[0,1,1] op_sel_hi:[1,1,1]
    v_pk_fma_f32 v[248:249], v[248:249], v[242:243], v[242:243] op_sel:[0,1,1] op_sel_hi:[1,1,1]
    v_pk_fma_f32 v[250:251], v[250:251], v[242:243], v[242:243] op_sel:[0,1,1] op_sel_hi:[1,1,1]
    v_rcp_f32 v244, v244
    v_rcp_f32 v245, v245
    v_rcp_f32 v246, v246
    v_rcp_f32 v247, v247
    v_rcp_f32 v248, v248
    v_rcp_f32 v249, v249
    v_rcp_f32 v250, v250
    v_rcp_f32 v251, v251
    s_nop 0
    v_pk_mul_f32 v[112:113], v[112:113], v[244:245]
    v_pk_mul_f32 v[114:115], v[114:115], v[246:247]
    v_pk_mul_f32 v[116:117], v[116:117], v[248:249]
    v_pk_mul_f32 v[118:119], v[118:119], v[250:251]
    v_cvt_pk_bf16_f32 v228, v112, v113
    v_cvt_pk_bf16_f32 v229, v114, v115
    v_cvt_pk_bf16_f32 v230, v116, v117
    v_cvt_pk_bf16_f32 v231, v118, v119
    s_waitcnt lgkmcnt(0)
    v_pk_fma_f32 v[128:129], v[16:17], v[12:13], v[128:129] op_sel_hi:[1,0,1] neg_lo:[0,1,0] neg_hi:[0,1,0]
    v_pk_fma_f32 v[130:131], v[18:19], v[12:13], v[130:131] op_sel_hi:[1,0,1] neg_lo:[0,1,0] neg_hi:[0,1,0]
    v_pk_fma_f32 v[132:133], v[20:21], v[12:13], v[132:133] op_sel_hi:[1,0,1] neg_lo:[0,1,0] neg_hi:[0,1,0]
    v_pk_fma_f32 v[134:135], v[22:23], v[12:13], v[134:135] op_sel_hi:[1,0,1] neg_lo:[0,1,0] neg_hi:[0,1,0]
    v_pk_fma_f32 v[136:137], v[24:25], v[12:13], v[136:137] op_sel_hi:[1,0,1] neg_lo:[0,1,0] neg_hi:[0,1,0]
    v_pk_fma_f32 v[138:139], v[26:27], v[12:13], v[138:139] op_sel_hi:[1,0,1] neg_lo:[0,1,0] neg_hi:[0,1,0]
    v_pk_fma_f32 v[140:141], v[28:29], v[12:13], v[140:141] op_sel_hi:[1,0,1] neg_lo:[0,1,0] neg_hi:[0,1,0]
    v_pk_fma_f32 v[142:143], v[30:31], v[12:13], v[142:143] op_sel_hi:[1,0,1] neg_lo:[0,1,0] neg_hi:[0,1,0]
    v_pk_fma_f32 v[144:145], v[16:17], v[14:15], v[144:145] op_sel_hi:[1,0,1] neg_lo:[0,1,0] neg_hi:[0,1,0]
    v_pk_fma_f32 v[146:147], v[18:19], v[14:15], v[146:147] op_sel_hi:[1,0,1] neg_lo:[0,1,0] neg_hi:[0,1,0]
    v_pk_fma_f32 v[148:149], v[20:21], v[14:15], v[148:149] op_sel_hi:[1,0,1] neg_lo:[0,1,0] neg_hi:[0,1,0]
    v_pk_fma_f32 v[150:151], v[22:23], v[14:15], v[150:151] op_sel_hi:[1,0,1] neg_lo:[0,1,0] neg_hi:[0,1,0]
    v_pk_fma_f32 v[152:153], v[24:25], v[14:15], v[152:153] op_sel_hi:[1,0,1] neg_lo:[0,1,0] neg_hi:[0,1,0]
    v_pk_fma_f32 v[154:155], v[26:27], v[14:15], v[154:155] op_sel_hi:[1,0,1] neg_lo:[0,1,0] neg_hi:[0,1,0]
    v_pk_fma_f32 v[156:157], v[28:29], v[14:15], v[156:157] op_sel_hi:[1,0,1] neg_lo:[0,1,0] neg_hi:[0,1,0]
    v_pk_fma_f32 v[158:159], v[30:31], v[14:15], v[158:159] op_sel_hi:[1,0,1] neg_lo:[0,1,0] neg_hi:[0,1,0]
    ds_read_b128 v[16:19], v9 offset:384
    ds_read_b128 v[20:23], v9 offset:416
    ds_read_b128 v[24:27], v9 offset:448
    ds_read_b128 v[28:31], v9 offset:480
    v_pk_mul_f32 v[244:245], v[128:129], v[240:241] op_sel_hi:[1,0]
    v_pk_mul_f32 v[246:247], v[130:131], v[240:241] op_sel_hi:[1,0]
    v_pk_mul_f32 v[248:249], v[132:133], v[240:241] op_sel_hi:[1,0]
    v_pk_mul_f32 v[250:251], v[134:135], v[240:241] op_sel_hi:[1,0]
    v_exp_f32 v244, v244
    v_exp_f32 v245, v245
    v_exp_f32 v246, v246
    v_exp_f32 v247, v247
    v_exp_f32 v248, v248
    v_exp_f32 v249, v249
    v_exp_f32 v250, v250
    v_exp_f32 v251, v251
    v_pk_mul_f32 v[128:129], v[128:129], v[136:137]
    v_pk_mul_f32 v[130:131], v[130:131], v[138:139]
    v_pk_mul_f32 v[132:133], v[132:133], v[140:141]
    v_pk_mul_f32 v[134:135], v[134:135], v[142:143]
    v_pk_fma_f32 v[244:245], v[244:245], v[240:241], v[240:241] op_sel:[0,1,1] op_sel_hi:[1,1,1]
    v_pk_fma_f32 v[246:247], v[246:247], v[240:241], v[240:241] op_sel:[0,1,1] op_sel_hi:[1,1,1]
    v_pk_fma_f32 v[248:249], v[248:249], v[240:241], v[240:241] op_sel:[0,1,1] op_sel_hi:[1,1,1]
    v_pk_fma_f32 v[250:251], v[250:251], v[240:241], v[240:241] op_sel:[0,1,1] op_sel_hi:[1,1,1]
    v_rcp_f32 v244, v244
    v_rcp_f32 v245, v245
    v_rcp_f32 v246, v246
    v_rcp_f32 v247, v247
    v_rcp_f32 v248, v248
    v_rcp_f32 v249, v249
    v_rcp_f32 v250, v250
    v_rcp_f32 v251, v251
    s_nop 0
    v_pk_mul_f32 v[128:129], v[128:129], v[244:245]
    v_pk_mul_f32 v[130:131], v[130:131], v[246:247]
    v_pk_mul_f32 v[132:133], v[132:133], v[248:249]
    v_pk_mul_f32 v[134:135], v[134:135], v[250:251]
    v_cvt_pk_bf16_f32 v232, v128, v129
    v_cvt_pk_bf16_f32 v233, v130, v131
    v_cvt_pk_bf16_f32 v234, v132, v133
    v_cvt_pk_bf16_f32 v235, v134, v135
    v_pk_mul_f32 v[244:245], v[144:145], v[242:243] op_sel_hi:[1,0]
    v_pk_mul_f32 v[246:247], v[146:147], v[242:243] op_sel_hi:[1,0]
    v_pk_mul_f32 v[248:249], v[148:149], v[242:243] op_sel_hi:[1,0]
    v_pk_mul_f32 v[250:251], v[150:151], v[242:243] op_sel_hi:[1,0]
    v_exp_f32 v244, v244
    v_exp_f32 v245, v245
    v_exp_f32 v246, v246
    v_exp_f32 v247, v247
    v_exp_f32 v248, v248
    v_exp_f32 v249, v249
    v_exp_f32 v250, v250
    v_exp_f32 v251, v251
    v_pk_mul_f32 v[144:145], v[144:145], v[152:153]
    v_pk_mul_f32 v[146:147], v[146:147], v[154:155]
    v_pk_mul_f32 v[148:149], v[148:149], v[156:157]
    v_pk_mul_f32 v[150:151], v[150:151], v[158:159]
    v_pk_fma_f32 v[244:245], v[244:245], v[242:243], v[242:243] op_sel:[0,1,1] op_sel_hi:[1,1,1]
    v_pk_fma_f32 v[246:247], v[246:247], v[242:243], v[242:243] op_sel:[0,1,1] op_sel_hi:[1,1,1]
    v_pk_fma_f32 v[248:249], v[248:249], v[242:243], v[242:243] op_sel:[0,1,1] op_sel_hi:[1,1,1]
    v_pk_fma_f32 v[250:251], v[250:251], v[242:243], v[242:243] op_sel:[0,1,1] op_sel_hi:[1,1,1]
    v_rcp_f32 v244, v244
    v_rcp_f32 v245, v245
    v_rcp_f32 v246, v246
    v_rcp_f32 v247, v247
    v_rcp_f32 v248, v248
    v_rcp_f32 v249, v249
    v_rcp_f32 v250, v250
    v_rcp_f32 v251, v251
    s_nop 0
    v_pk_mul_f32 v[144:145], v[144:145], v[244:245]
    v_pk_mul_f32 v[146:147], v[146:147], v[246:247]
    v_pk_mul_f32 v[148:149], v[148:149], v[248:249]
    v_pk_mul_f32 v[150:151], v[150:151], v[250:251]
    v_cvt_pk_bf16_f32 v236, v144, v145
    v_cvt_pk_bf16_f32 v237, v146, v147
    v_cvt_pk_bf16_f32 v238, v148, v149
    v_cvt_pk_bf16_f32 v239, v150, v151
    s_waitcnt lgkmcnt(0)
    v_pk_fma_f32 v[160:161], v[40:41], v[12:13], v[160:161] op_sel_hi:[1,0,1] neg_lo:[0,1,0] neg_hi:[0,1,0]
    v_pk_fma_f32 v[162:163], v[42:43], v[12:13], v[162:163] op_sel_hi:[1,0,1] neg_lo:[0,1,0] neg_hi:[0,1,0]
    v_pk_fma_f32 v[164:165], v[44:45], v[12:13], v[164:165] op_sel_hi:[1,0,1] neg_lo:[0,1,0] neg_hi:[0,1,0]
    v_pk_fma_f32 v[166:167], v[46:47], v[12:13], v[166:167] op_sel_hi:[1,0,1] neg_lo:[0,1,0] neg_hi:[0,1,0]
    v_pk_fma_f32 v[168:169], v[48:49], v[12:13], v[168:169] op_sel_hi:[1,0,1] neg_lo:[0,1,0] neg_hi:[0,1,0]
    v_pk_fma_f32 v[170:171], v[50:51], v[12:13], v[170:171] op_sel_hi:[1,0,1] neg_lo:[0,1,0] neg_hi:[0,1,0]
    v_pk_fma_f32 v[172:173], v[52:53], v[12:13], v[172:173] op_sel_hi:[1,0,1] neg_lo:[0,1,0] neg_hi:[0,1,0]
    v_pk_fma_f32 v[174:175], v[54:55], v[12:13], v[174:175] op_sel_hi:[1,0,1] neg_lo:[0,1,0] neg_hi:[0,1,0]
    v_pk_fma_f32 v[176:177], v[40:41], v[14:15], v[176:177] op_sel_hi:[1,0,1] neg_lo:[0,1,0] neg_hi:[0,1,0]
    v_pk_fma_f32 v[178:179], v[42:43], v[14:15], v[178:179] op_sel_hi:[1,0,1] neg_lo:[0,1,0] neg_hi:[0,1,0]
    v_pk_fma_f32 v[180:181], v[44:45], v[14:15], v[180:181] op_sel_hi:[1,0,1] neg_lo:[0,1,0] neg_hi:[0,1,0]
    v_pk_fma_f32 v[182:183], v[46:47], v[14:15], v[182:183] op_sel_hi:[1,0,1] neg_lo:[0,1,0] neg_hi:[0,1,0]
    v_pk_fma_f32 v[184:185], v[48:49], v[14:15], v[184:185] op_sel_hi:[1,0,1] neg_lo:[0,1,0] neg_hi:[0,1,0]
    v_pk_fma_f32 v[186:187], v[50:51], v[14:15], v[186:187] op_sel_hi:[1,0,1] neg_lo:[0,1,0] neg_hi:[0,1,0]
    v_pk_fma_f32 v[188:189], v[52:53], v[14:15], v[188:189] op_sel_hi:[1,0,1] neg_lo:[0,1,0] neg_hi:[0,1,0]
    v_pk_fma_f32 v[190:191], v[54:55], v[14:15], v[190:191] op_sel_hi:[1,0,1] neg_lo:[0,1,0] neg_hi:[0,1,0]
    v_pk_mul_f32 v[244:245], v[160:161], v[240:241] op_sel_hi:[1,0]
    v_pk_mul_f32 v[246:247], v[162:163], v[240:241] op_sel_hi:[1,0]
    v_pk_mul_f32 v[248:249], v[164:165], v[240:241] op_sel_hi:[1,0]
    v_pk_mul_f32 v[250:251], v[166:167], v[240:241] op_sel_hi:[1,0]
    v_exp_f32 v244, v244
    v_exp_f32 v245, v245
    v_exp_f32 v246, v246
    v_exp_f32 v247, v247
    v_exp_f32 v248, v248
    v_exp_f32 v249, v249
    v_exp_f32 v250, v250
    v_exp_f32 v251, v251
    v_pk_mul_f32 v[160:161], v[160:161], v[168:169]
    v_pk_mul_f32 v[162:163], v[162:163], v[170:171]
    v_pk_mul_f32 v[164:165], v[164:165], v[172:173]
    v_pk_mul_f32 v[166:167], v[166:167], v[174:175]
    v_pk_fma_f32 v[244:245], v[244:245], v[240:241], v[240:241] op_sel:[0,1,1] op_sel_hi:[1,1,1]
    v_pk_fma_f32 v[246:247], v[246:247], v[240:241], v[240:241] op_sel:[0,1,1] op_sel_hi:[1,1,1]
    v_pk_fma_f32 v[248:249], v[248:249], v[240:241], v[240:241] op_sel:[0,1,1] op_sel_hi:[1,1,1]
    v_pk_fma_f32 v[250:251], v[250:251], v[240:241], v[240:241] op_sel:[0,1,1] op_sel_hi:[1,1,1]
    v_rcp_f32 v244, v244
    v_rcp_f32 v245, v245
    v_rcp_f32 v246, v246
    v_rcp_f32 v247, v247
    v_rcp_f32 v248, v248
    v_rcp_f32 v249, v249
    v_rcp_f32 v250, v250
    v_rcp_f32 v251, v251
    s_nop 0
    v_pk_mul_f32 v[160:161], v[160:161], v[244:245]
    v_pk_mul_f32 v[162:163], v[162:163], v[246:247]
    v_pk_mul_f32 v[164:165], v[164:165], v[248:249]
    v_pk_mul_f32 v[166:167], v[166:167], v[250:251]
    v_cvt_pk_bf16_f32 v160, v160, v161
    v_cvt_pk_bf16_f32 v161, v162, v163
    v_cvt_pk_bf16_f32 v162, v164, v165
    v_cvt_pk_bf16_f32 v163, v166, v167
    ds_write_b128 v8, v[160:163] offset:0
    v_pk_mul_f32 v[244:245], v[176:177], v[242:243] op_sel_hi:[1,0]
    v_pk_mul_f32 v[246:247], v[178:179], v[242:243] op_sel_hi:[1,0]
    v_pk_mul_f32 v[248:249], v[180:181], v[242:243] op_sel_hi:[1,0]
    v_pk_mul_f32 v[250:251], v[182:183], v[242:243] op_sel_hi:[1,0]
    v_exp_f32 v244, v244
    v_exp_f32 v245, v245
    v_exp_f32 v246, v246
    v_exp_f32 v247, v247
    v_exp_f32 v248, v248
    v_exp_f32 v249, v249
    v_exp_f32 v250, v250
    v_exp_f32 v251, v251
    v_pk_mul_f32 v[176:177], v[176:177], v[184:185]
    v_pk_mul_f32 v[178:179], v[178:179], v[186:187]
    v_pk_mul_f32 v[180:181], v[180:181], v[188:189]
    v_pk_mul_f32 v[182:183], v[182:183], v[190:191]
    v_pk_fma_f32 v[244:245], v[244:245], v[242:243], v[242:243] op_sel:[0,1,1] op_sel_hi:[1,1,1]
    v_pk_fma_f32 v[246:247], v[246:247], v[242:243], v[242:243] op_sel:[0,1,1] op_sel_hi:[1,1,1]
    v_pk_fma_f32 v[248:249], v[248:249], v[242:243], v[242:243] op_sel:[0,1,1] op_sel_hi:[1,1,1]
    v_pk_fma_f32 v[250:251], v[250:251], v[242:243], v[242:243] op_sel:[0,1,1] op_sel_hi:[1,1,1]
    v_rcp_f32 v244, v244
    v_rcp_f32 v245, v245
    v_rcp_f32 v246, v246
    v_rcp_f32 v247, v247
    v_rcp_f32 v248, v248
    v_rcp_f32 v249, v249
    v_rcp_f32 v250, v250
    v_rcp_f32 v251, v251
    s_nop 0
    v_pk_mul_f32 v[176:177], v[176:177], v[244:245]
    v_pk_mul_f32 v[178:179], v[178:179], v[246:247]
    v_pk_mul_f32 v[180:181], v[180:181], v[248:249]
    v_pk_mul_f32 v[182:183], v[182:183], v[250:251]
    v_cvt_pk_bf16_f32 v176, v176, v177
    v_cvt_pk_bf16_f32 v177, v178, v179
    v_cvt_pk_bf16_f32 v178, v180, v181
    v_cvt_pk_bf16_f32 v179, v182, v183
    ds_write_b128 v8, v[176:179] offset:1024
    s_waitcnt lgkmcnt(0)
    v_pk_fma_f32 v[192:193], v[16:17], v[12:13], v[192:193] op_sel_hi:[1,0,1] neg_lo:[0,1,0] neg_hi:[0,1,0]
    v_pk_fma_f32 v[194:195], v[18:19], v[12:13], v[194:195] op_sel_hi:[1,0,1] neg_lo:[0,1,0] neg_hi:[0,1,0]
    v_pk_fma_f32 v[196:197], v[20:21], v[12:13], v[196:197] op_sel_hi:[1,0,1] neg_lo:[0,1,0] neg_hi:[0,1,0]
    v_pk_fma_f32 v[198:199], v[22:23], v[12:13], v[198:199] op_sel_hi:[1,0,1] neg_lo:[0,1,0] neg_hi:[0,1,0]
    v_pk_fma_f32 v[200:201], v[24:25], v[12:13], v[200:201] op_sel_hi:[1,0,1] neg_lo:[0,1,0] neg_hi:[0,1,0]
    v_pk_fma_f32 v[202:203], v[26:27], v[12:13], v[202:203] op_sel_hi:[1,0,1] neg_lo:[0,1,0] neg_hi:[0,1,0]
    v_pk_fma_f32 v[204:205], v[28:29], v[12:13], v[204:205] op_sel_hi:[1,0,1] neg_lo:[0,1,0] neg_hi:[0,1,0]
    v_pk_fma_f32 v[206:207], v[30:31], v[12:13], v[206:207] op_sel_hi:[1,0,1] neg_lo:[0,1,0] neg_hi:[0,1,0]
    v_pk_fma_f32 v[208:209], v[16:17], v[14:15], v[208:209] op_sel_hi:[1,0,1] neg_lo:[0,1,0] neg_hi:[0,1,0]
    v_pk_fma_f32 v[210:211], v[18:19], v[14:15], v[210:211] op_sel_hi:[1,0,1] neg_lo:[0,1,0] neg_hi:[0,1,0]
    v_pk_fma_f32 v[212:213], v[20:21], v[14:15], v[212:213] op_sel_hi:[1,0,1] neg_lo:[0,1,0] neg_hi:[0,1,0]
    v_pk_fma_f32 v[214:215], v[22:23], v[14:15], v[214:215] op_sel_hi:[1,0,1] neg_lo:[0,1,0] neg_hi:[0,1,0]
    v_pk_fma_f32 v[216:217], v[24:25], v[14:15], v[216:217] op_sel_hi:[1,0,1] neg_lo:[0,1,0] neg_hi:[0,1,0]
    v_pk_fma_f32 v[218:219], v[26:27], v[14:15], v[218:219] op_sel_hi:[1,0,1] neg_lo:[0,1,0] neg_hi:[0,1,0]
    v_pk_fma_f32 v[220:221], v[28:29], v[14:15], v[220:221] op_sel_hi:[1,0,1] neg_lo:[0,1,0] neg_hi:[0,1,0]
    v_pk_fma_f32 v[222:223], v[30:31], v[14:15], v[222:223] op_sel_hi:[1,0,1] neg_lo:[0,1,0] neg_hi:[0,1,0]
    v_pk_mul_f32 v[244:245], v[192:193], v[240:241] op_sel_hi:[1,0]
    v_pk_mul_f32 v[246:247], v[194:195], v[240:241] op_sel_hi:[1,0]
    v_pk_mul_f32 v[248:249], v[196:197], v[240:241] op_sel_hi:[1,0]
    v_pk_mul_f32 v[250:251], v[198:199], v[240:241] op_sel_hi:[1,0]
    v_exp_f32 v244, v244
    v_exp_f32 v245, v245
    v_exp_f32 v246, v246
    v_exp_f32 v247, v247
    v_exp_f32 v248, v248
    v_exp_f32 v249, v249
    v_exp_f32 v250, v250
    v_exp_f32 v251, v251
    v_pk_mul_f32 v[192:193], v[192:193], v[200:201]
    v_pk_mul_f32 v[194:195], v[194:195], v[202:203]
    v_pk_mul_f32 v[196:197], v[196:197], v[204:205]
    v_pk_mul_f32 v[198:199], v[198:199], v[206:207]
    v_pk_fma_f32 v[244:245], v[244:245], v[240:241], v[240:241] op_sel:[0,1,1] op_sel_hi:[1,1,1]
    v_pk_fma_f32 v[246:247], v[246:247], v[240:241], v[240:241] op_sel:[0,1,1] op_sel_hi:[1,1,1]
    v_pk_fma_f32 v[248:249], v[248:249], v[240:241], v[240:241] op_sel:[0,1,1] op_sel_hi:[1,1,1]
    v_pk_fma_f32 v[250:251], v[250:251], v[240:241], v[240:241] op_sel:[0,1,1] op_sel_hi:[1,1,1]
    v_rcp_f32 v244, v244
    v_rcp_f32 v245, v245
    v_rcp_f32 v246, v246
    v_rcp_f32 v247, v247
    v_rcp_f32 v248, v248
    v_rcp_f32 v249, v249
    v_rcp_f32 v250, v250
    v_rcp_f32 v251, v251
    s_nop 0
    v_pk_mul_f32 v[192:193], v[192:193], v[244:245]
    v_pk_mul_f32 v[194:195], v[194:195], v[246:247]
    v_pk_mul_f32 v[196:197], v[196:197], v[248:249]
    v_pk_mul_f32 v[198:199], v[198:199], v[250:251]
    v_cvt_pk_bf16_f32 v192, v192, v193
    v_cvt_pk_bf16_f32 v193, v194, v195
    v_cvt_pk_bf16_f32 v194, v196, v197
    v_cvt_pk_bf16_f32 v195, v198, v199
    ds_write_b128 v8, v[192:195] offset:2048
    v_pk_mul_f32 v[244:245], v[208:209], v[242:243] op_sel_hi:[1,0]
    v_pk_mul_f32 v[246:247], v[210:211], v[242:243] op_sel_hi:[1,0]
    v_pk_mul_f32 v[248:249], v[212:213], v[242:243] op_sel_hi:[1,0]
    v_pk_mul_f32 v[250:251], v[214:215], v[242:243] op_sel_hi:[1,0]
    v_exp_f32 v244, v244
    v_exp_f32 v245, v245
    v_exp_f32 v246, v246
    v_exp_f32 v247, v247
    v_exp_f32 v248, v248
    v_exp_f32 v249, v249
    v_exp_f32 v250, v250
    v_exp_f32 v251, v251
    v_pk_mul_f32 v[208:209], v[208:209], v[216:217]
    v_pk_mul_f32 v[210:211], v[210:211], v[218:219]
    v_pk_mul_f32 v[212:213], v[212:213], v[220:221]
    v_pk_mul_f32 v[214:215], v[214:215], v[222:223]
    v_pk_fma_f32 v[244:245], v[244:245], v[242:243], v[242:243] op_sel:[0,1,1] op_sel_hi:[1,1,1]
    v_pk_fma_f32 v[246:247], v[246:247], v[242:243], v[242:243] op_sel:[0,1,1] op_sel_hi:[1,1,1]
    v_pk_fma_f32 v[248:249], v[248:249], v[242:243], v[242:243] op_sel:[0,1,1] op_sel_hi:[1,1,1]
    v_pk_fma_f32 v[250:251], v[250:251], v[242:243], v[242:243] op_sel:[0,1,1] op_sel_hi:[1,1,1]
    v_rcp_f32 v244, v244
    v_rcp_f32 v245, v245
    v_rcp_f32 v246, v246
    v_rcp_f32 v247, v247
    v_rcp_f32 v248, v248
    v_rcp_f32 v249, v249
    v_rcp_f32 v250, v250
    v_rcp_f32 v251, v251
    s_nop 0
    v_pk_mul_f32 v[208:209], v[208:209], v[244:245]
    v_pk_mul_f32 v[210:211], v[210:211], v[246:247]
    v_pk_mul_f32 v[212:213], v[212:213], v[248:249]
    v_pk_mul_f32 v[214:215], v[214:215], v[250:251]
    v_cvt_pk_bf16_f32 v208, v208, v209
    v_cvt_pk_bf16_f32 v209, v210, v211
    v_cvt_pk_bf16_f32 v210, v212, v213
    v_cvt_pk_bf16_f32 v211, v214, v215
    ds_write_b128 v8, v[208:211] offset:3072
    s_waitcnt lgkmcnt(0)
    s_branch attn_start
ab_q:
    s_lshr_b32 s36, s30, 1
    s_mul_i32 s36, s36, 640
    s_and_b32 s37, s30, 1
    s_mul_i32 s37, s37, 384
    s_add_u32 s69, s36, s37
    s_cmp_ge_u32 s28, 4
    s_cbranch_scc1 ab_cQ
    s_lshl_b32 s70, s28, 12
    s_lshl_b32 s71, s28, 11
    v_lshrrev_b32 v6, 3, v1
    s_lshl_b32 s36, s28, 5
    s_lshl_b32 s37, s29, 7
    s_add_u32 s36, s36, s37
    v_add_u32 v7, s36, v6
    v_mul_u32_u24 v7, 1280, v7
    v_lshrrev_b32 v6, 4, v1
    v_and_b32 v8, 7, v1
    v_xor_b32 v8, v8, v6
    v_lshl_add_u32 v96, v8, 4, v7
    v_xor_b32 v97, 64, v96
    v_add_u32 v97, 9216, v97
    s_lshl_b32 s36, s28, 4
    s_bitcmp1_b32 s30, 0
    s_mov_b32 s37, 1280
    s_cselect_b32 s66, 40, s37
    s_cselect_b64 s[84:85], -1, 0
    v_lshrrev_b32 v6, 3, v1
    v_add_u32 v6, s36, v6
    v_lshrrev_b32 v7, 2, v1
    v_and_b32 v7, 4, v7
    v_and_b32 v8, 7, v1
    v_xor_b32 v8, v8, v7
    v_mul_u32_u24 v7, 1280, v6
    v_lshl_add_u32 v98, v8, 4, v7
    v_add_u32 v98, s69, v98
    v_add_u32 v99, 256, v98
    v_mul_u32_u24 v7, 40, v6
    v_lshl_add_u32 v7, v8, 4, v7
    v_mov_b32 v9, 1073741824
    v_cmp_gt_u32 vcc, 3, v8
    s_nop 1
    v_cndmask_b32 v7, v9, v7, vcc
    v_cndmask_b32 v99, v99, v7, s[84:85]
    s_waitcnt lgkmcnt(0)
    s_mov_b32 s4, s40
    s_and_b32 s5, s41, 0xffff
    s_mov_b32 s6, 2621440
    s_mov_b32 s7, 0x00020000
    s_mov_b32 s8, s42
    s_and_b32 s9, s43, 0xffff
    s_mov_b32 s10, 819200
    s_mov_b32 s11, 0x00020000
    s_cmp_eq_u32 s30, 1
    s_cselect_b32 s36, s44, s46
    s_cselect_b32 s37, s45, s47
    s_bitcmp1_b32 s30, 0
    s_cselect_b32 s12, s36, s42
    s_cselect_b32 s13, s37, s43
    s_cselect_b32 s14, 25600, s10
    s_and_b32 s13, s13, 0xffff
    s_mov_b32 s15, 0x00020000
    s_add_u32 m0, s70, 0
    s_mov_b32 s32, 0
    buffer_load_dwordx4 v96, s[4:7], s32 offen offset:0 lds
    buffer_load_dwordx4 v97, s[4:7], s32 offen offset:1024 lds
    s_mov_b32 s32, 18432
    buffer_load_dwordx4 v96, s[4:7], s32 offen offset:2048 lds
    buffer_load_dwordx4 v97, s[4:7], s32 offen offset:3072 lds
    s_add_u32 m0, s71, 16384
    s_mov_b32 s33, 0
    buffer_load_dwordx4 v98, s[8:11], s33 offen offset:0 lds
    s_mov_b32 s33, 9216
    buffer_load_dwordx4 v98, s[8:11], s33 offen offset:1024 lds
    s_add_u32 m0, s71, 24576
    s_mov_b32 s33, 128
    buffer_load_dwordx4 v98, s[8:11], s33 offen offset:0 lds
    s_mov_b32 s33, 9344
    buffer_load_dwordx4 v98, s[8:11], s33 offen offset:1024 lds
    s_add_u32 m0, s71, 32768
    s_mul_i32 s35, s66, 0
    buffer_load_dwordx4 v99, s[12:15], s35 offen lds
    s_add_u32 m0, s71, 33792
    s_mul_i32 s35, s66, 8
    buffer_load_dwordx4 v99, s[12:15], s35 offen lds
    s_mov_b32 s16, s62
    s_and_b32 s17, s63, 0xffff
    s_mov_b32 s18, 16777216
    s_mov_b32 s19, 0x00020000
    s_mov_b32 s20, s60
    s_and_b32 s21, s61, 0xffff
    s_mov_b32 s22, 256
    s_mov_b32 s23, 0x00020000
    s_mov_b32 s24, s58
    s_and_b32 s25, s59, 0xffff
    s_mov_b32 s26, 2621440
    s_mov_b32 s27, 0x00020000
    s_bfe_u32 s36, s2, 0x20001
    s_lshl_b32 s67, s2, 7
    s_add_u32 s67, s67, 4063232
    s_lshl_b32 s79, s36, 3
    s_bfe_u32 s37, s2, 0x30003
    s_add_u32 s79, s79, s37
    s_and_b32 s73, s2, 1
    s_lshl_b32 s73, s73, 2
    s_add_u32 s73, s73, s31
    s_lshr_b32 s72, s28, 2
    s_and_b32 s74, s28, 3
    v_mov_b32 v4, 0xdddddddd
    v_and_b32 v5, 3, v1
    v_lshlrev_b32 v5, 6, v5
    v_lshlrev_b32 v102, 2, v1
    s_cmp_eq_u32 s28, 0
    s_cselect_b32 s88, s52, s54
    s_cselect_b32 s89, s53, s55
    s_mov_b32 s90, 1966080
    s_mov_b32 s93, 196608
    s_mul_i32 s36, s2, 768
    s_mul_i32 s37, s2, 5
    s_lshr_b32 s37, s37, 1
    s_lshl_b32 s37, s37, 7
    s_cmp_eq_u32 s28, 2
    s_cselect_b32 s88, s42, s88
    s_cselect_b32 s89, s43, s89
    s_cselect_b32 s90, 819200, s90
    s_cselect_b32 s93, 81920, s93
    s_cselect_b32 s36, s37, s36
    s_cselect_b32 s38, 2, 5
    s_cmp_gt_u32 s28, 2
    s_cselect_b32 s36, 1073741824, s36
    s_and_b32 s89, s89, 0xffff
    s_mov_b32 s91, 0x00020000
    v_mul_u32_u24 v6, 10923, v1
    v_lshrrev_b32 v6, 16, v6
    v_mul_u32_u24 v7, 6, v6
    v_sub_u32 v7, v1, v7
    v_min_u32 v7, s38, v7
    v_mul_lo_u32 v100, v6, s93
    v_lshl_add_u32 v100, v7, 7, v100
    v_add_u32 v100, s36, v100
    s_add_u32 m0, s70, 49152
    s_mov_b32 s32, 128
    buffer_load_dwordx4 v96, s[4:7], s32 offen offset:0 lds
    buffer_load_dwordx4 v97, s[4:7], s32 offen offset:1024 lds
    s_mov_b32 s32, 18560
    buffer_load_dwordx4 v96, s[4:7], s32 offen offset:2048 lds
    buffer_load_dwordx4 v97, s[4:7], s32 offen offset:3072 lds
    s_add_u32 m0, s71, 65536
    s_mov_b32 s33, 81920
    buffer_load_dwordx4 v98, s[8:11], s33 offen offset:0 lds
    s_mov_b32 s33, 91136
    buffer_load_dwordx4 v98, s[8:11], s33 offen offset:1024 lds
    s_add_u32 m0, s71, 73728
    s_mov_b32 s33, 82048
    buffer_load_dwordx4 v98, s[8:11], s33 offen offset:0 lds
    s_mov_b32 s33, 91264
    buffer_load_dwordx4 v98, s[8:11], s33 offen offset:1024 lds
    s_add_u32 m0, s71, 81920
    s_mul_i32 s35, s66, 64
    buffer_load_dwordx4 v99, s[12:15], s35 offen lds
    s_add_u32 m0, s71, 82944
    s_mul_i32 s35, s66, 72
    buffer_load_dwordx4 v99, s[12:15], s35 offen lds
    s_mul_i32 s92, s93, 2
    s_mov_b32 exec_lo, 0x3ffff
    s_mov_b32 exec_hi, 0x0
    buffer_load_dword v101, v100, s[88:91], s92 offen
    s_mov_b64 exec, -1
    s_lshl_b32 s68, s2, 2
    s_add_u32 s68, s68, s28
    s_mul_i32 s36, s68, 2560
    v_lshrrev_b32 v6, 5, v1
    v_lshl_add_u32 v6, v6, 10, v3
    buffer_load_dwordx2 v[104:105], v6, s[4:7], s36 offen offset:0
    buffer_load_dwordx2 v[106:107], v6, s[4:7], s36 offen offset:256
    buffer_load_dwordx2 v[108:109], v6, s[4:7], s36 offen offset:512
    buffer_load_dwordx2 v[110:111], v6, s[4:7], s36 offen offset:768
    buffer_load_dwordx2 v[112:113], v6, s[4:7], s36 offen offset:1024
    s_cmp_lg_u32 s28, 0
    s_cbranch_scc1 w0_5
    v_lshlrev_b32 v8, 15, v1
    v_mov_b32 v9, 0
    s_mov_b64 exec, 3
    buffer_store_dword v9, v8, s[16:19], s67 offen sc1
    s_mov_b64 exec, -1
w0_5:
    s_waitcnt vmcnt(16)
    s_barrier
    s_mul_i32 s92, s93, 5
    s_mov_b32 exec_lo, 0x3fffffff
    s_mov_b32 exec_hi, 0x0
    buffer_load_dword v101, v100, s[88:91], s92 offen
    s_mov_b64 exec, -1
    s_add_u32 m0, s70, 98304
    s_mov_b32 s32, 256
    buffer_load_dwordx4 v96, s[4:7], s32 offen offset:0 lds
    buffer_load_dwordx4 v97, s[4:7], s32 offen offset:1024 lds
    s_mov_b32 s32, 18688
    buffer_load_dwordx4 v96, s[4:7], s32 offen offset:2048 lds
    buffer_load_dwordx4 v97, s[4:7], s32 offen offset:3072 lds
    s_add_u32 m0, s71, 114688
    s_mov_b32 s33, 163840
    buffer_load_dwordx4 v98, s[8:11], s33 offen offset:0 lds
    s_mov_b32 s33, 173056
    buffer_load_dwordx4 v98, s[8:11], s33 offen offset:1024 lds
    s_add_u32 m0, s71, 122880
    s_mov_b32 s33, 163968
    buffer_load_dwordx4 v98, s[8:11], s33 offen offset:0 lds
    s_mov_b32 s33, 173184
    buffer_load_dwordx4 v98, s[8:11], s33 offen offset:1024 lds
    s_add_u32 m0, s71, 131072
    s_mul_i32 s35, s66, 128
    buffer_load_dwordx4 v99, s[12:15], s35 offen lds
    s_add_u32 m0, s71, 132096
    s_mul_i32 s35, s66, 136
    buffer_load_dwordx4 v99, s[12:15], s35 offen lds
    s_waitcnt vmcnt(17)
    s_barrier
    s_add_u32 m0, s70, 0
    s_mov_b32 s32, 384
    buffer_load_dwordx4 v96, s[4:7], s32 offen offset:0 lds
    buffer_load_dwordx4 v97, s[4:7], s32 offen offset:1024 lds
    s_mov_b32 s32, 18816
    buffer_load_dwordx4 v96, s[4:7], s32 offen offset:2048 lds
    buffer_load_dwordx4 v97, s[4:7], s32 offen offset:3072 lds
    s_add_u32 m0, s71, 16384
    s_mov_b32 s33, 245760
    buffer_load_dwordx4 v98, s[8:11], s33 offen offset:0 lds
    s_mov_b32 s33, 254976
    buffer_load_dwordx4 v98, s[8:11], s33 offen offset:1024 lds
    s_add_u32 m0, s71, 24576
    s_mov_b32 s33, 245888
    buffer_load_dwordx4 v98, s[8:11], s33 offen offset:0 lds
    s_mov_b32 s33, 255104
    buffer_load_dwordx4 v98, s[8:11], s33 offen offset:1024 lds
    s_add_u32 m0, s71, 32768
    s_mul_i32 s35, s66, 192
    buffer_load_dwordx4 v99, s[12:15], s35 offen lds
    s_add_u32 m0, s71, 33792
    s_mul_i32 s35, s66, 200
    buffer_load_dwordx4 v99, s[12:15], s35 offen lds
    s_waitcnt vmcnt(21)
    v_lshlrev_b32 v116, 16, v104
    v_and_b32 v117, 0xffff0000, v104
    v_add_f32 v114, v116, v117
    v_mul_f32 v115, v116, v116
    v_fmac_f32 v115, v117, v117
    v_lshlrev_b32 v116, 16, v105
    v_and_b32 v117, 0xffff0000, v105
    v_add_f32 v114, v114, v116
    v_fmac_f32 v115, v116, v116
    v_add_f32 v114, v114, v117
    v_fmac_f32 v115, v117, v117
    v_lshlrev_b32 v116, 16, v106
    v_and_b32 v117, 0xffff0000, v106
    v_add_f32 v114, v114, v116
    v_fmac_f32 v115, v116, v116
    v_add_f32 v114, v114, v117
    v_fmac_f32 v115, v117, v117
    v_lshlrev_b32 v116, 16, v107
    v_and_b32 v117, 0xffff0000, v107
    v_add_f32 v114, v114, v116
    v_fmac_f32 v115, v116, v116
    v_add_f32 v114, v114, v117
    v_fmac_f32 v115, v117, v117
    v_lshlrev_b32 v116, 16, v108
    v_and_b32 v117, 0xffff0000, v108
    v_add_f32 v114, v114, v116
    v_fmac_f32 v115, v116, v116
    v_add_f32 v114, v114, v117
    v_fmac_f32 v115, v117, v117
    v_lshlrev_b32 v116, 16, v109
    v_and_b32 v117, 0xffff0000, v109
    v_add_f32 v114, v114, v116
    v_fmac_f32 v115, v116, v116
    v_add_f32 v114, v114, v117
    v_fmac_f32 v115, v117, v117
    v_lshlrev_b32 v116, 16, v110
    v_and_b32 v117, 0xffff0000, v110
    v_add_f32 v114, v114, v116
    v_fmac_f32 v115, v116, v116
    v_add_f32 v114, v114, v117
    v_fmac_f32 v115, v117, v117
    v_lshlrev_b32 v116, 16, v111
    v_and_b32 v117, 0xffff0000, v111
    v_add_f32 v114, v114, v116
    v_fmac_f32 v115, v116, v116
    v_add_f32 v114, v114, v117
    v_fmac_f32 v115, v117, v117
    v_lshlrev_b32 v116, 16, v112
    v_and_b32 v117, 0xffff0000, v112
    v_add_f32 v114, v114, v116
    v_fmac_f32 v115, v116, v116
    v_add_f32 v114, v114, v117
    v_fmac_f32 v115, v117, v117
    v_lshlrev_b32 v116, 16, v113
    v_and_b32 v117, 0xffff0000, v113
    v_add_f32 v114, v114, v116
    v_fmac_f32 v115, v116, v116
    v_add_f32 v114, v114, v117
    v_fmac_f32 v115, v117, v117
    v_mov_b64 v[116:117], v[114:115]
    s_nop 1
    v_permlane16_swap_b32 v114, v116
    v_permlane16_swap_b32 v115, v117
    s_nop 1
    v_add_f32 v114, v114, v116
    v_add_f32 v115, v115, v117
    s_nop 1
    v_add_f32_dpp v114, v114, v114 row_ror:8 row_mask:0xf bank_mask:0xf
    v_add_f32_dpp v115, v115, v115 row_ror:8 row_mask:0xf bank_mask:0xf
    s_nop 1
    v_add_f32_dpp v114, v114, v114 row_ror:4 row_mask:0xf bank_mask:0xf
    v_add_f32_dpp v115, v115, v115 row_ror:4 row_mask:0xf bank_mask:0xf
    s_nop 1
    v_add_f32_dpp v114, v114, v114 row_ror:2 row_mask:0xf bank_mask:0xf
    v_add_f32_dpp v115, v115, v115 row_ror:2 row_mask:0xf bank_mask:0xf
    s_nop 1
    v_add_f32_dpp v114, v114, v114 row_ror:1 row_mask:0xf bank_mask:0xf
    v_add_f32_dpp v115, v115, v115 row_ror:1 row_mask:0xf bank_mask:0xf
    v_mul_f32 v114, 0x3acccccd, v114
    v_mul_f32 v115, 0x3acccccd, v115
    v_fma_f32 v115, -v114, v114, v115
    v_max_f32 v115, 0, v115
    v_cvt_pk_bf16_f32 v114, v114, v114
    v_and_b32 v114, 0xffff0000, v114
    v_cvt_pk_bf16_f32 v115, v115, v115
    v_and_b32 v115, 0xffff0000, v115
    v_add_f32 v115, 0x3727c5ac, v115
    v_cvt_pk_bf16_f32 v115, v115, v115
    v_and_b32 v115, 0xffff0000, v115
    v_sqrt_f32 v115, v115
    s_nop 0
    v_cvt_pk_bf16_f32 v115, v115, v115
    v_and_b32 v115, 0xffff0000, v115
    s_lshl_b32 s36, s68, 4
    s_add_u32 s36, s36, 3932160
    v_lshrrev_b32 v116, 2, v1
    s_mov_b32 exec_lo, 1
    s_mov_b32 exec_hi, 1
    buffer_store_dwordx2 v[114:115], v116, s[16:19], s36 offen sc1
    s_mov_b64 exec, -1
    s_waitcnt vmcnt(11)
    s_barrier
    s_add_u32 m0, s70, 49152
    s_mov_b32 s32, 512
    buffer_load_dwordx4 v96, s[4:7], s32 offen offset:0 lds
    buffer_load_dwordx4 v97, s[4:7], s32 offen offset:1024 lds
    s_mov_b32 s32, 18944
    buffer_load_dwordx4 v96, s[4:7], s32 offen offset:2048 lds
    buffer_load_dwordx4 v97, s[4:7], s32 offen offset:3072 lds
    s_add_u32 m0, s71, 65536
    s_mov_b32 s33, 327680
    buffer_load_dwordx4 v98, s[8:11], s33 offen offset:0 lds
    s_mov_b32 s33, 336896
    buffer_load_dwordx4 v98, s[8:11], s33 offen offset:1024 lds
    s_add_u32 m0, s71, 73728
    s_mov_b32 s33, 327808
    buffer_load_dwordx4 v98, s[8:11], s33 offen offset:0 lds
    s_mov_b32 s33, 337024
    buffer_load_dwordx4 v98, s[8:11], s33 offen offset:1024 lds
    s_add_u32 m0, s71, 81920
    s_mul_i32 s35, s66, 256
    buffer_load_dwordx4 v99, s[12:15], s35 offen lds
    s_add_u32 m0, s71, 82944
    s_mul_i32 s35, s66, 264
    buffer_load_dwordx4 v99, s[12:15], s35 offen lds
    s_waitcnt vmcnt(11)
    s_barrier
    s_add_u32 m0, s70, 98304
    s_mov_b32 s32, 640
    buffer_load_dwordx4 v96, s[4:7], s32 offen offset:0 lds
    buffer_load_dwordx4 v97, s[4:7], s32 offen offset:1024 lds
    s_mov_b32 s32, 19072
    buffer_load_dwordx4 v96, s[4:7], s32 offen offset:2048 lds
    buffer_load_dwordx4 v97, s[4:7], s32 offen offset:3072 lds
    s_add_u32 m0, s71, 114688
    s_mov_b32 s33, 409600
    buffer_load_dwordx4 v98, s[8:11], s33 offen offset:0 lds
    s_mov_b32 s33, 418816
    buffer_load_dwordx4 v98, s[8:11], s33 offen offset:1024 lds
    s_add_u32 m0, s71, 122880
    s_mov_b32 s33, 409728
    buffer_load_dwordx4 v98, s[8:11], s33 offen offset:0 lds
    s_mov_b32 s33, 418944
    buffer_load_dwordx4 v98, s[8:11], s33 offen offset:1024 lds
    s_add_u32 m0, s71, 131072
    s_mul_i32 s35, s66, 320
    buffer_load_dwordx4 v99, s[12:15], s35 offen lds
    s_add_u32 m0, s71, 132096
    s_mul_i32 s35, s66, 328
    buffer_load_dwordx4 v99, s[12:15], s35 offen lds
    s_waitcnt vmcnt(10)
    s_barrier
    s_cmp_lg_u32 s28, 0
    s_cbranch_scc1 w0_6
    s_bfe_u32 s38, s2, 0x20003
    s_lshl_b32 s38, s38, 6
    v_mov_b32 v8, 0
    v_mov_b32 v9, 1
    s_mov_b64 exec, 1
    buffer_atomic_add v9, v8, s[20:23], s38 offen sc1
    s_mov_b64 exec, -1
w0_6:
    s_add_u32 m0, s70, 0
    s_mov_b32 s32, 768
    buffer_load_dwordx4 v96, s[4:7], s32 offen offset:0 lds
    buffer_load_dwordx4 v97, s[4:7], s32 offen offset:1024 lds
    s_mov_b32 s32, 19200
    buffer_load_dwordx4 v96, s[4:7], s32 offen offset:2048 lds
    buffer_load_dwordx4 v97, s[4:7], s32 offen offset:3072 lds
    s_add_u32 m0, s71, 16384
    s_mov_b32 s33, 491520
    buffer_load_dwordx4 v98, s[8:11], s33 offen offset:0 lds
    s_mov_b32 s33, 500736
    buffer_load_dwordx4 v98, s[8:11], s33 offen offset:1024 lds
    s_add_u32 m0, s71, 24576
    s_mov_b32 s33, 491648
    buffer_load_dwordx4 v98, s[8:11], s33 offen offset:0 lds
    s_mov_b32 s33, 500864
    buffer_load_dwordx4 v98, s[8:11], s33 offen offset:1024 lds
    s_add_u32 m0, s71, 32768
    s_mul_i32 s35, s66, 384
    buffer_load_dwordx4 v99, s[12:15], s35 offen lds
    s_add_u32 m0, s71, 33792
    s_mul_i32 s35, s66, 392
    buffer_load_dwordx4 v99, s[12:15], s35 offen lds
    s_waitcnt vmcnt(10)
    s_barrier
    s_add_u32 m0, s70, 49152
    s_mov_b32 s32, 896
    buffer_load_dwordx4 v96, s[4:7], s32 offen offset:0 lds
    buffer_load_dwordx4 v97, s[4:7], s32 offen offset:1024 lds
    s_mov_b32 s32, 19328
    buffer_load_dwordx4 v96, s[4:7], s32 offen offset:2048 lds
    buffer_load_dwordx4 v97, s[4:7], s32 offen offset:3072 lds
    s_add_u32 m0, s71, 65536
    s_mov_b32 s33, 573440
    buffer_load_dwordx4 v98, s[8:11], s33 offen offset:0 lds
    s_mov_b32 s33, 582656
    buffer_load_dwordx4 v98, s[8:11], s33 offen offset:1024 lds
    s_add_u32 m0, s71, 73728
    s_mov_b32 s33, 573568
    buffer_load_dwordx4 v98, s[8:11], s33 offen offset:0 lds
    s_mov_b32 s33, 582784
    buffer_load_dwordx4 v98, s[8:11], s33 offen offset:1024 lds
    s_add_u32 m0, s71, 81920
    s_mul_i32 s35, s66, 448
    buffer_load_dwordx4 v99, s[12:15], s35 offen lds
    s_add_u32 m0, s71, 82944
    s_mul_i32 s35, s66, 456
    buffer_load_dwordx4 v99, s[12:15], s35 offen lds
    s_cmp_eq_u32 s28, 0
    s_cselect_b32 s88, s56, s48
    s_cselect_b32 s89, s57, s49
    s_mov_b32 s90, 819200
    s_cselect_b32 s90, 1966080, s90
    s_cselect_b32 s36, 60, 25
    s_and_b32 s89, s89, 0xffff
    s_mul_i32 s92, s36, s2
    s_lshl_b32 s92, s92, 7
    s_cmp_gt_u32 s28, 1
    s_cselect_b32 s92, 1073741824, s92
    s_sub_u32 s36, s36, 1
    v_min_u32 v100, s36, v1
    v_lshlrev_b32 v100, 7, v100
    buffer_load_dword v101, v100, s[88:91], s92 offen
    s_waitcnt vmcnt(11)
    s_barrier
    s_add_u32 m0, s70, 98304
    s_mov_b32 s32, 1024
    buffer_load_dwordx4 v96, s[4:7], s32 offen offset:0 lds
    buffer_load_dwordx4 v97, s[4:7], s32 offen offset:1024 lds
    s_mov_b32 s32, 19456
    buffer_load_dwordx4 v96, s[4:7], s32 offen offset:2048 lds
    buffer_load_dwordx4 v97, s[4:7], s32 offen offset:3072 lds
    s_add_u32 m0, s71, 114688
    s_mov_b32 s33, 655360
    buffer_load_dwordx4 v98, s[8:11], s33 offen offset:0 lds
    s_mov_b32 s33, 664576
    buffer_load_dwordx4 v98, s[8:11], s33 offen offset:1024 lds
    s_add_u32 m0, s71, 122880
    s_mov_b32 s33, 655488
    buffer_load_dwordx4 v98, s[8:11], s33 offen offset:0 lds
    s_mov_b32 s33, 664704
    buffer_load_dwordx4 v98, s[8:11], s33 offen offset:1024 lds
    s_add_u32 m0, s71, 131072
    s_mul_i32 s35, s66, 512
    buffer_load_dwordx4 v99, s[12:15], s35 offen lds
    s_add_u32 m0, s71, 132096
    s_mul_i32 s35, s66, 520
    buffer_load_dwordx4 v99, s[12:15], s35 offen lds
    s_waitcnt vmcnt(11)
    s_barrier
    s_add_u32 m0, s70, 0
    s_mov_b32 s32, 1152
    buffer_load_dwordx4 v96, s[4:7], s32 offen offset:0 lds
    buffer_load_dwordx4 v97, s[4:7], s32 offen offset:1024 lds
    s_mov_b32 s32, 19584
    buffer_load_dwordx4 v96, s[4:7], s32 offen offset:2048 lds
    buffer_load_dwordx4 v97, s[4:7], s32 offen offset:3072 lds
    s_add_u32 m0, s71, 16384
    s_mov_b32 s33, 737280
    buffer_load_dwordx4 v98, s[8:11], s33 offen offset:0 lds
    s_mov_b32 s33, 746496
    buffer_load_dwordx4 v98, s[8:11], s33 offen offset:1024 lds
    s_add_u32 m0, s71, 24576
    s_mov_b32 s33, 737408
    buffer_load_dwordx4 v98, s[8:11], s33 offen offset:0 lds
    s_mov_b32 s33, 746624
    buffer_load_dwordx4 v98, s[8:11], s33 offen offset:1024 lds
    s_add_u32 m0, s71, 32768
    s_mul_i32 s35, s66, 576
    buffer_load_dwordx4 v99, s[12:15], s35 offen lds
    s_add_u32 m0, s71, 33792
    s_mul_i32 s35, s66, 584
    buffer_load_dwordx4 v99, s[12:15], s35 offen lds
    s_waitcnt vmcnt(10)
    s_barrier
    buffer_load_dword v11, v5, s[20:23], 0 offen sc1
    s_waitcnt vmcnt(0)
    v_cmp_le_u32 vcc, 64, v11
    s_mov_b32 s78, 0
    s_cmp_eq_u64 vcc, exec
    s_cbranch_scc1 poll_ok_7
poll_lp_8:
    s_sleep 4
    buffer_load_dword v11, v5, s[20:23], 0 offen sc1
    s_add_u32 s78, s78, 1
    s_cmp_gt_u32 s78, 0x8000
    s_cbranch_scc1 poll_ok_7
    s_waitcnt vmcnt(0)
    v_cmp_le_u32 vcc, 64, v11
    s_nop 0
    s_cmp_eq_u64 vcc, exec
    s_cbranch_scc0 poll_lp_8
poll_ok_7:
    s_barrier
    v_lshlrev_b32 v5, 7, v1
    v_add_u32 v5, 4063232, v5
    s_lshl_b32 s36, s28, 8
    s_add_u32 s36, s36, 147456
    v_add_u32 v7, s36, v102
    s_barrier
    ds_read_b32 v118, v7 offset:6144
    ds_read_b32 v119, v7 offset:7168
    s_waitcnt lgkmcnt(0)
    v_add_f32 v118, v118, v119
    ds_write_b32 v7, v118
    s_waitcnt lgkmcnt(0)
    s_barrier
    s_mov_b32 s94, 1023
    s_branch attn_start
ab_cQ:
    s_and_b32 s64, s28, 1
    s_bfe_u32 s65, s28, 0x10001
    v_lshlrev_b32 v85, 2, v1
    v_and_b32 v6, 31, v1
    v_lshrrev_b32 v7, 5, v1
    v_bfe_u32 v8, v1, 1, 3
    v_xor_b32 v8, v8, v7
    v_lshlrev_b32 v8, 4, v8
    v_lshl_add_u32 v16, v6, 7, v8
    s_lshl_b32 s36, s64, 13
    v_add_u32 v16, s36, v16
    s_lshl_b32 s36, s64, 6
    v_xor_b32 v16, s36, v16
    v_xor_b32 v17, 32, v16
    v_xor_b32 v18, 64, v16
    v_xor_b32 v19, 96, v16
    v_bfe_u32 v6, v1, 2, 2
    v_lshl_add_u32 v8, v7, 3, v6
    v_bfe_u32 v9, v1, 4, 1
    v_lshlrev_b32 v8, 7, v8
    v_lshl_add_u32 v8, v9, 5, v8
    v_bfe_u32 v6, v1, 3, 1
    v_lshl_add_u32 v8, v6, 6, v8
    v_and_b32 v6, 3, v1
    v_lshl_add_u32 v8, v6, 3, v8
    s_mul_i32 s36, s65, 3
    s_add_u32 s36, s36, 0
    s_and_b32 s37, s36, 1
    s_lshl_b32 s37, s37, 6
    v_xor_b32 v24, s37, v8
    s_lshr_b32 s36, s36, 1
    s_lshl_b32 s36, s36, 13
    v_add_u32 v24, s36, v24
    s_mul_i32 s36, s65, 3
    s_add_u32 s36, s36, 1
    s_and_b32 s37, s36, 1
    s_lshl_b32 s37, s37, 6
    v_xor_b32 v26, s37, v8
    s_lshr_b32 s36, s36, 1
    s_lshl_b32 s36, s36, 13
    v_add_u32 v26, s36, v26
    s_mul_i32 s36, s65, 3
    s_add_u32 s36, s36, 2
    s_and_b32 s37, s36, 1
    s_lshl_b32 s37, s37, 6
    v_xor_b32 v28, s37, v8
    s_lshr_b32 s36, s36, 1
    s_lshl_b32 s36, s36, 13
    v_add_u32 v28, s36, v28
    s_mul_i32 s36, s64, 4096
    s_add_u32 s36, s36, 16384
    v_add_u32 v24, s36, v24
    v_xor_b32 v25, 4096, v24
    v_add_u32 v26, s36, v26
    v_xor_b32 v27, 4096, v26
    v_add_u32 v28, s36, v28
    v_xor_b32 v29, 4096, v28
    v_add_u32 v20, 98304, v16
    v_add_u32 v21, 98304, v17
    v_add_u32 v22, 98304, v18
    v_add_u32 v23, 98304, v19
    v_add_u32 v30, 98304, v24
    v_add_u32 v31, 98304, v25
    v_add_u32 v32, 98304, v26
    v_add_u32 v33, 98304, v27
    v_add_u32 v34, 98304, v28
    v_add_u32 v35, 98304, v29
    v_bfe_u32 v6, v1, 3, 1
    v_lshrrev_b32 v7, 5, v1
    v_xor_b32 v6, v6, v7
    v_and_b32 v7, 6, v1
    v_or_b32 v6, v6, v7
    v_mov_b32 v7, 0x3f803f80
    v_cmp_eq_u32 vcc, 0, v6
    v_cmp_eq_u32 s[84:85], 4, v6
    v_and_b32 v8, 1, v1
    v_mul_u32_u24 v8, 0xaaaa, v8
    v_cndmask_b32 v224, 0, v7, vcc
    v_cndmask_b32 v225, 0, v7, vcc
    v_cndmask_b32 v226, 0, v7, s[84:85]
    v_cndmask_b32 v227, 0, v7, s[84:85]
    v_add_u32 v84, 0x4444, v8
    v_mov_b64 v[228:229], 0
    v_mov_b64 v[230:231], 0
    v_mov_b64 v[232:233], 0
    v_mov_b64 v[234:235], 0
    v_mov_b64 v[48:49], 0
    v_mov_b64 v[50:51], 0
    v_mov_b64 v[72:73], 0
    v_mov_b64 v[74:75], 0
    v_and_b32 v6, 60, v85
    v_add_u32 v6, 159744, v6
    v_mov_b32 v7, 0
    ds_write_b32 v6, v7
    s_waitcnt lgkmcnt(0)
    s_mov_b32 s4, s40
    s_and_b32 s5, s41, 0xffff
    s_mov_b32 s6, 2621440
    s_mov_b32 s7, 0x00020000
    s_mov_b32 s16, s62
    s_and_b32 s17, s63, 0xffff
    s_mov_b32 s18, 16777216
    s_mov_b32 s19, 0x00020000
    s_mov_b32 s20, s60
    s_and_b32 s21, s61, 0xffff
    s_mov_b32 s22, 256
    s_mov_b32 s23, 0x00020000
    s_mov_b32 s24, s58
    s_and_b32 s25, s59, 0xffff
    s_mov_b32 s26, 2621440
    s_mov_b32 s27, 0x00020000
    s_bfe_u32 s36, s2, 0x20001
    s_lshl_b32 s67, s2, 7
    s_add_u32 s67, s67, 4063232
    s_lshl_b32 s79, s36, 3
    s_bfe_u32 s37, s2, 0x30003
    s_add_u32 s79, s79, s37
    s_and_b32 s73, s2, 1
    s_lshl_b32 s73, s73, 2
    s_add_u32 s73, s73, s31
    s_lshr_b32 s72, s28, 2
    s_and_b32 s74, s28, 3
    v_mov_b32 v4, 0xdddddddd
    v_and_b32 v5, 3, v1
    v_lshlrev_b32 v5, 6, v5
    s_mov_b32 s94, 1023
    s_and_b32 s80, s30, s65
    s_and_b32 s80, s80, 1
    s_barrier
    s_setprio 1
    ds_read_b128 v[52:55], v16 offset:0
    ds_read_b64_tr_b16 v[36:37], v24 offset:0
    ds_read_b64_tr_b16 v[38:39], v24 offset:512
    ds_read_b128 v[56:59], v16 offset:4096
    ds_read_b64_tr_b16 v[40:41], v26 offset:0
    ds_read_b64_tr_b16 v[42:43], v26 offset:512
    ds_read_b64_tr_b16 v[44:45], v28 offset:0
    ds_read_b64_tr_b16 v[46:47], v28 offset:512
    s_waitcnt lgkmcnt(0)
    v_mfma_f32_32x32x16_bf16 v[96:111], v[36:39], v[52:55], 0
    ds_read_b128 v[76:79], v17 offset:0
    ds_read_b64_tr_b16 v[60:61], v24 offset:2048
    v_mfma_f32_32x32x16_bf16 v[112:127], v[36:39], v[56:59], 0
    ds_read_b64_tr_b16 v[62:63], v24 offset:2560
    ds_read_b128 v[80:83], v17 offset:4096
    v_mfma_f32_32x32x16_bf16 v[128:143], v[40:43], v[52:55], 0
    ds_read_b64_tr_b16 v[64:65], v26 offset:2048
    ds_read_b64_tr_b16 v[66:67], v26 offset:2560
    v_mfma_f32_32x32x16_bf16 v[144:159], v[40:43], v[56:59], 0
    ds_read_b64_tr_b16 v[68:69], v28 offset:2048
    ds_read_b64_tr_b16 v[70:71], v28 offset:2560
    s_cmp_lg_u32 s80, 0
    s_cbranch_scc1 kvs_9
    v_mfma_f32_32x32x16_bf16 v[160:175], v[44:47], v[52:55], 0
    v_mfma_f32_32x32x16_bf16 v[176:191], v[44:47], v[56:59], 0
kvs_9:
    v_smfmac_f32_16x16x64_bf16 v[228:231], v[224:227], v[36:43], v84
    v_smfmac_f32_16x16x64_bf16 v[232:235], v[224:227], v[44:51], v84
    s_waitcnt lgkmcnt(0)
    v_mfma_f32_32x32x16_bf16 v[96:111], v[60:63], v[76:79], v[96:111]
    ds_read_b128 v[52:55], v18 offset:0
    ds_read_b64_tr_b16 v[36:37], v25 offset:0
    v_mfma_f32_32x32x16_bf16 v[112:127], v[60:63], v[80:83], v[112:127]
    ds_read_b64_tr_b16 v[38:39], v25 offset:512
    ds_read_b128 v[56:59], v18 offset:4096
    v_mfma_f32_32x32x16_bf16 v[128:143], v[64:67], v[76:79], v[128:143]
    ds_read_b64_tr_b16 v[40:41], v27 offset:0
    ds_read_b64_tr_b16 v[42:43], v27 offset:512
    v_mfma_f32_32x32x16_bf16 v[144:159], v[64:67], v[80:83], v[144:159]
    ds_read_b64_tr_b16 v[44:45], v29 offset:0
    ds_read_b64_tr_b16 v[46:47], v29 offset:512
    s_cmp_lg_u32 s80, 0
    s_cbranch_scc1 kvs_10
    v_mfma_f32_32x32x16_bf16 v[160:175], v[68:71], v[76:79], v[160:175]
    v_mfma_f32_32x32x16_bf16 v[176:191], v[68:71], v[80:83], v[176:191]
kvs_10:
    v_smfmac_f32_16x16x64_bf16 v[228:231], v[224:227], v[60:67], v84
    v_smfmac_f32_16x16x64_bf16 v[232:235], v[224:227], v[68:75], v84
    s_waitcnt lgkmcnt(0)
    v_mfma_f32_32x32x16_bf16 v[96:111], v[36:39], v[52:55], v[96:111]
    ds_read_b128 v[76:79], v19 offset:0
    ds_read_b64_tr_b16 v[60:61], v25 offset:2048
    v_mfma_f32_32x32x16_bf16 v[112:127], v[36:39], v[56:59], v[112:127]
    ds_read_b64_tr_b16 v[62:63], v25 offset:2560
    ds_read_b128 v[80:83], v19 offset:4096
    v_mfma_f32_32x32x16_bf16 v[128:143], v[40:43], v[52:55], v[128:143]
    ds_read_b64_tr_b16 v[64:65], v27 offset:2048
    ds_read_b64_tr_b16 v[66:67], v27 offset:2560
    v_mfma_f32_32x32x16_bf16 v[144:159], v[40:43], v[56:59], v[144:159]
    ds_read_b64_tr_b16 v[68:69], v29 offset:2048
    ds_read_b64_tr_b16 v[70:71], v29 offset:2560
    s_cmp_lg_u32 s80, 0
    s_cbranch_scc1 kvs_11
    v_mfma_f32_32x32x16_bf16 v[160:175], v[44:47], v[52:55], v[160:175]
    v_mfma_f32_32x32x16_bf16 v[176:191], v[44:47], v[56:59], v[176:191]
kvs_11:
    s_waitcnt lgkmcnt(0)
    s_barrier
    v_mfma_f32_32x32x16_bf16 v[96:111], v[60:63], v[76:79], v[96:111]
    ds_read_b128 v[52:55], v16 offset:49152
    ds_read_b64_tr_b16 v[36:37], v24 offset:49152
    v_mfma_f32_32x32x16_bf16 v[112:127], v[60:63], v[80:83], v[112:127]
    ds_read_b64_tr_b16 v[38:39], v24 offset:49664
    ds_read_b128 v[56:59], v16 offset:53248
    v_mfma_f32_32x32x16_bf16 v[128:143], v[64:67], v[76:79], v[128:143]
    ds_read_b64_tr_b16 v[40:41], v26 offset:49152
    ds_read_b64_tr_b16 v[42:43], v26 offset:49664
    v_mfma_f32_32x32x16_bf16 v[144:159], v[64:67], v[80:83], v[144:159]
    ds_read_b64_tr_b16 v[44:45], v28 offset:49152
    ds_read_b64_tr_b16 v[46:47], v28 offset:49664
    s_cmp_lg_u32 s80, 0
    s_cbranch_scc1 kvs_12
    v_mfma_f32_32x32x16_bf16 v[160:175], v[68:71], v[76:79], v[160:175]
    v_mfma_f32_32x32x16_bf16 v[176:191], v[68:71], v[80:83], v[176:191]
kvs_12:
    s_waitcnt lgkmcnt(0)
    v_mfma_f32_32x32x16_bf16 v[96:111], v[36:39], v[52:55], v[96:111]
    ds_read_b128 v[76:79], v17 offset:49152
    ds_read_b64_tr_b16 v[60:61], v24 offset:51200
    v_mfma_f32_32x32x16_bf16 v[112:127], v[36:39], v[56:59], v[112:127]
    ds_read_b64_tr_b16 v[62:63], v24 offset:51712
    ds_read_b128 v[80:83], v17 offset:53248
    v_mfma_f32_32x32x16_bf16 v[128:143], v[40:43], v[52:55], v[128:143]
    ds_read_b64_tr_b16 v[64:65], v26 offset:51200
    ds_read_b64_tr_b16 v[66:67], v26 offset:51712
    v_mfma_f32_32x32x16_bf16 v[144:159], v[40:43], v[56:59], v[144:159]
    ds_read_b64_tr_b16 v[68:69], v28 offset:51200
    ds_read_b64_tr_b16 v[70:71], v28 offset:51712
    s_cmp_lg_u32 s80, 0
    s_cbranch_scc1 kvs_13
    v_mfma_f32_32x32x16_bf16 v[160:175], v[44:47], v[52:55], v[160:175]
    v_mfma_f32_32x32x16_bf16 v[176:191], v[44:47], v[56:59], v[176:191]
kvs_13:
    v_smfmac_f32_16x16x64_bf16 v[228:231], v[224:227], v[36:43], v84
    v_smfmac_f32_16x16x64_bf16 v[232:235], v[224:227], v[44:51], v84
    s_waitcnt lgkmcnt(0)
    v_mfma_f32_32x32x16_bf16 v[96:111], v[60:63], v[76:79], v[96:111]
    ds_read_b128 v[52:55], v18 offset:49152
    ds_read_b64_tr_b16 v[36:37], v25 offset:49152
    v_mfma_f32_32x32x16_bf16 v[112:127], v[60:63], v[80:83], v[112:127]
    ds_read_b64_tr_b16 v[38:39], v25 offset:49664
    ds_read_b128 v[56:59], v18 offset:53248
    v_mfma_f32_32x32x16_bf16 v[128:143], v[64:67], v[76:79], v[128:143]
    ds_read_b64_tr_b16 v[40:41], v27 offset:49152
    ds_read_b64_tr_b16 v[42:43], v27 offset:49664
    v_mfma_f32_32x32x16_bf16 v[144:159], v[64:67], v[80:83], v[144:159]
    ds_read_b64_tr_b16 v[44:45], v29 offset:49152
    ds_read_b64_tr_b16 v[46:47], v29 offset:49664
    s_cmp_lg_u32 s80, 0
    s_cbranch_scc1 kvs_14
    v_mfma_f32_32x32x16_bf16 v[160:175], v[68:71], v[76:79], v[160:175]
    v_mfma_f32_32x32x16_bf16 v[176:191], v[68:71], v[80:83], v[176:191]
kvs_14:
    v_smfmac_f32_16x16x64_bf16 v[228:231], v[224:227], v[60:67], v84
    v_smfmac_f32_16x16x64_bf16 v[232:235], v[224:227], v[68:75], v84
    s_waitcnt lgkmcnt(0)
    v_mfma_f32_32x32x16_bf16 v[96:111], v[36:39], v[52:55], v[96:111]
    ds_read_b128 v[76:79], v19 offset:49152
    ds_read_b64_tr_b16 v[60:61], v25 offset:51200
    v_mfma_f32_32x32x16_bf16 v[112:127], v[36:39], v[56:59], v[112:127]
    ds_read_b64_tr_b16 v[62:63], v25 offset:51712
    ds_read_b128 v[80:83], v19 offset:53248
    v_mfma_f32_32x32x16_bf16 v[128:143], v[40:43], v[52:55], v[128:143]
    ds_read_b64_tr_b16 v[64:65], v27 offset:51200
    ds_read_b64_tr_b16 v[66:67], v27 offset:51712
    v_mfma_f32_32x32x16_bf16 v[144:159], v[40:43], v[56:59], v[144:159]
    ds_read_b64_tr_b16 v[68:69], v29 offset:51200
    ds_read_b64_tr_b16 v[70:71], v29 offset:51712
    s_cmp_lg_u32 s80, 0
    s_cbranch_scc1 kvs_15
    v_mfma_f32_32x32x16_bf16 v[160:175], v[44:47], v[52:55], v[160:175]
    v_mfma_f32_32x32x16_bf16 v[176:191], v[44:47], v[56:59], v[176:191]
kvs_15:
    s_waitcnt lgkmcnt(0)
    s_barrier
    v_mfma_f32_32x32x16_bf16 v[96:111], v[60:63], v[76:79], v[96:111]
    ds_read_b128 v[52:55], v20 offset:0
    ds_read_b64_tr_b16 v[36:37], v30 offset:0
    v_mfma_f32_32x32x16_bf16 v[112:127], v[60:63], v[80:83], v[112:127]
    ds_read_b64_tr_b16 v[38:39], v30 offset:512
    ds_read_b128 v[56:59], v20 offset:4096
    v_mfma_f32_32x32x16_bf16 v[128:143], v[64:67], v[76:79], v[128:143]
    ds_read_b64_tr_b16 v[40:41], v32 offset:0
    ds_read_b64_tr_b16 v[42:43], v32 offset:512
    v_mfma_f32_32x32x16_bf16 v[144:159], v[64:67], v[80:83], v[144:159]
    ds_read_b64_tr_b16 v[44:45], v34 offset:0
    ds_read_b64_tr_b16 v[46:47], v34 offset:512
    s_cmp_lg_u32 s80, 0
    s_cbranch_scc1 kvs_16
    v_mfma_f32_32x32x16_bf16 v[160:175], v[68:71], v[76:79], v[160:175]
    v_mfma_f32_32x32x16_bf16 v[176:191], v[68:71], v[80:83], v[176:191]
kvs_16:
    s_waitcnt lgkmcnt(0)
    v_mfma_f32_32x32x16_bf16 v[96:111], v[36:39], v[52:55], v[96:111]
    ds_read_b128 v[76:79], v21 offset:0
    ds_read_b64_tr_b16 v[60:61], v30 offset:2048
    v_mfma_f32_32x32x16_bf16 v[112:127], v[36:39], v[56:59], v[112:127]
    ds_read_b64_tr_b16 v[62:63], v30 offset:2560
    ds_read_b128 v[80:83], v21 offset:4096
    v_mfma_f32_32x32x16_bf16 v[128:143], v[40:43], v[52:55], v[128:143]
    ds_read_b64_tr_b16 v[64:65], v32 offset:2048
    ds_read_b64_tr_b16 v[66:67], v32 offset:2560
    v_mfma_f32_32x32x16_bf16 v[144:159], v[40:43], v[56:59], v[144:159]
    ds_read_b64_tr_b16 v[68:69], v34 offset:2048
    ds_read_b64_tr_b16 v[70:71], v34 offset:2560
    s_cmp_lg_u32 s80, 0
    s_cbranch_scc1 kvs_17
    v_mfma_f32_32x32x16_bf16 v[160:175], v[44:47], v[52:55], v[160:175]
    v_mfma_f32_32x32x16_bf16 v[176:191], v[44:47], v[56:59], v[176:191]
kvs_17:
    v_smfmac_f32_16x16x64_bf16 v[228:231], v[224:227], v[36:43], v84
    v_smfmac_f32_16x16x64_bf16 v[232:235], v[224:227], v[44:51], v84
    s_waitcnt lgkmcnt(0)
    v_mfma_f32_32x32x16_bf16 v[96:111], v[60:63], v[76:79], v[96:111]
    ds_read_b128 v[52:55], v22 offset:0
    ds_read_b64_tr_b16 v[36:37], v31 offset:0
    v_mfma_f32_32x32x16_bf16 v[112:127], v[60:63], v[80:83], v[112:127]
    ds_read_b64_tr_b16 v[38:39], v31 offset:512
    ds_read_b128 v[56:59], v22 offset:4096
    v_mfma_f32_32x32x16_bf16 v[128:143], v[64:67], v[76:79], v[128:143]
    ds_read_b64_tr_b16 v[40:41], v33 offset:0
    ds_read_b64_tr_b16 v[42:43], v33 offset:512
    v_mfma_f32_32x32x16_bf16 v[144:159], v[64:67], v[80:83], v[144:159]
    ds_read_b64_tr_b16 v[44:45], v35 offset:0
    ds_read_b64_tr_b16 v[46:47], v35 offset:512
    s_cmp_lg_u32 s80, 0
    s_cbranch_scc1 kvs_18
    v_mfma_f32_32x32x16_bf16 v[160:175], v[68:71], v[76:79], v[160:175]
    v_mfma_f32_32x32x16_bf16 v[176:191], v[68:71], v[80:83], v[176:191]
kvs_18:
    v_smfmac_f32_16x16x64_bf16 v[228:231], v[224:227], v[60:67], v84
    v_smfmac_f32_16x16x64_bf16 v[232:235], v[224:227], v[68:75], v84
    s_waitcnt lgkmcnt(0)
    v_mfma_f32_32x32x16_bf16 v[96:111], v[36:39], v[52:55], v[96:111]
    ds_read_b128 v[76:79], v23 offset:0
    ds_read_b64_tr_b16 v[60:61], v31 offset:2048
    v_mfma_f32_32x32x16_bf16 v[112:127], v[36:39], v[56:59], v[112:127]
    ds_read_b64_tr_b16 v[62:63], v31 offset:2560
    ds_read_b128 v[80:83], v23 offset:4096
    v_mfma_f32_32x32x16_bf16 v[128:143], v[40:43], v[52:55], v[128:143]
    ds_read_b64_tr_b16 v[64:65], v33 offset:2048
    ds_read_b64_tr_b16 v[66:67], v33 offset:2560
    v_mfma_f32_32x32x16_bf16 v[144:159], v[40:43], v[56:59], v[144:159]
    ds_read_b64_tr_b16 v[68:69], v35 offset:2048
    ds_read_b64_tr_b16 v[70:71], v35 offset:2560
    s_cmp_lg_u32 s80, 0
    s_cbranch_scc1 kvs_19
    v_mfma_f32_32x32x16_bf16 v[160:175], v[44:47], v[52:55], v[160:175]
    v_mfma_f32_32x32x16_bf16 v[176:191], v[44:47], v[56:59], v[176:191]
kvs_19:
    s_waitcnt lgkmcnt(0)
    s_barrier
    v_mfma_f32_32x32x16_bf16 v[96:111], v[60:63], v[76:79], v[96:111]
    ds_read_b128 v[52:55], v16 offset:0
    ds_read_b64_tr_b16 v[36:37], v24 offset:0
    v_mfma_f32_32x32x16_bf16 v[112:127], v[60:63], v[80:83], v[112:127]
    ds_read_b64_tr_b16 v[38:39], v24 offset:512
    ds_read_b128 v[56:59], v16 offset:4096
    v_mfma_f32_32x32x16_bf16 v[128:143], v[64:67], v[76:79], v[128:143]
    ds_read_b64_tr_b16 v[40:41], v26 offset:0
    ds_read_b64_tr_b16 v[42:43], v26 offset:512
    v_mfma_f32_32x32x16_bf16 v[144:159], v[64:67], v[80:83], v[144:159]
    ds_read_b64_tr_b16 v[44:45], v28 offset:0
    ds_read_b64_tr_b16 v[46:47], v28 offset:512
    s_cmp_lg_u32 s80, 0
    s_cbranch_scc1 kvs_20
    v_mfma_f32_32x32x16_bf16 v[160:175], v[68:71], v[76:79], v[160:175]
    v_mfma_f32_32x32x16_bf16 v[176:191], v[68:71], v[80:83], v[176:191]
kvs_20:
    s_waitcnt lgkmcnt(0)
    v_mfma_f32_32x32x16_bf16 v[96:111], v[36:39], v[52:55], v[96:111]
    ds_read_b128 v[76:79], v17 offset:0
    ds_read_b64_tr_b16 v[60:61], v24 offset:2048
    v_mfma_f32_32x32x16_bf16 v[112:127], v[36:39], v[56:59], v[112:127]
    ds_read_b64_tr_b16 v[62:63], v24 offset:2560
    ds_read_b128 v[80:83], v17 offset:4096
    v_mfma_f32_32x32x16_bf16 v[128:143], v[40:43], v[52:55], v[128:143]
    ds_read_b64_tr_b16 v[64:65], v26 offset:2048
    ds_read_b64_tr_b16 v[66:67], v26 offset:2560
    v_mfma_f32_32x32x16_bf16 v[144:159], v[40:43], v[56:59], v[144:159]
    ds_read_b64_tr_b16 v[68:69], v28 offset:2048
    ds_read_b64_tr_b16 v[70:71], v28 offset:2560
    s_cmp_lg_u32 s80, 0
    s_cbranch_scc1 kvs_21
    v_mfma_f32_32x32x16_bf16 v[160:175], v[44:47], v[52:55], v[160:175]
    v_mfma_f32_32x32x16_bf16 v[176:191], v[44:47], v[56:59], v[176:191]
kvs_21:
    v_smfmac_f32_16x16x64_bf16 v[228:231], v[224:227], v[36:43], v84
    v_smfmac_f32_16x16x64_bf16 v[232:235], v[224:227], v[44:51], v84
    s_waitcnt lgkmcnt(0)
    v_mfma_f32_32x32x16_bf16 v[96:111], v[60:63], v[76:79], v[96:111]
    ds_read_b128 v[52:55], v18 offset:0
    ds_read_b64_tr_b16 v[36:37], v25 offset:0
    v_mfma_f32_32x32x16_bf16 v[112:127], v[60:63], v[80:83], v[112:127]
    ds_read_b64_tr_b16 v[38:39], v25 offset:512
    ds_read_b128 v[56:59], v18 offset:4096
    v_mfma_f32_32x32x16_bf16 v[128:143], v[64:67], v[76:79], v[128:143]
    ds_read_b64_tr_b16 v[40:41], v27 offset:0
    ds_read_b64_tr_b16 v[42:43], v27 offset:512
    v_mfma_f32_32x32x16_bf16 v[144:159], v[64:67], v[80:83], v[144:159]
    ds_read_b64_tr_b16 v[44:45], v29 offset:0
    ds_read_b64_tr_b16 v[46:47], v29 offset:512
    s_cmp_lg_u32 s80, 0
    s_cbranch_scc1 kvs_22
    v_mfma_f32_32x32x16_bf16 v[160:175], v[68:71], v[76:79], v[160:175]
    v_mfma_f32_32x32x16_bf16 v[176:191], v[68:71], v[80:83], v[176:191]
kvs_22:
    v_smfmac_f32_16x16x64_bf16 v[228:231], v[224:227], v[60:67], v84
    v_smfmac_f32_16x16x64_bf16 v[232:235], v[224:227], v[68:75], v84
    s_waitcnt lgkmcnt(0)
    v_mfma_f32_32x32x16_bf16 v[96:111], v[36:39], v[52:55], v[96:111]
    ds_read_b128 v[76:79], v19 offset:0
    ds_read_b64_tr_b16 v[60:61], v25 offset:2048
    v_mfma_f32_32x32x16_bf16 v[112:127], v[36:39], v[56:59], v[112:127]
    ds_read_b64_tr_b16 v[62:63], v25 offset:2560
    ds_read_b128 v[80:83], v19 offset:4096
    v_mfma_f32_32x32x16_bf16 v[128:143], v[40:43], v[52:55], v[128:143]
    ds_read_b64_tr_b16 v[64:65], v27 offset:2048
    ds_read_b64_tr_b16 v[66:67], v27 offset:2560
    v_mfma_f32_32x32x16_bf16 v[144:159], v[40:43], v[56:59], v[144:159]
    ds_read_b64_tr_b16 v[68:69], v29 offset:2048
    ds_read_b64_tr_b16 v[70:71], v29 offset:2560
    s_cmp_lg_u32 s80, 0
    s_cbranch_scc1 kvs_23
    v_mfma_f32_32x32x16_bf16 v[160:175], v[44:47], v[52:55], v[160:175]
    v_mfma_f32_32x32x16_bf16 v[176:191], v[44:47], v[56:59], v[176:191]
kvs_23:
    s_waitcnt lgkmcnt(0)
    s_barrier
    v_mfma_f32_32x32x16_bf16 v[96:111], v[60:63], v[76:79], v[96:111]
    ds_read_b128 v[52:55], v16 offset:49152
    ds_read_b64_tr_b16 v[36:37], v24 offset:49152
    v_mfma_f32_32x32x16_bf16 v[112:127], v[60:63], v[80:83], v[112:127]
    ds_read_b64_tr_b16 v[38:39], v24 offset:49664
    ds_read_b128 v[56:59], v16 offset:53248
    v_mfma_f32_32x32x16_bf16 v[128:143], v[64:67], v[76:79], v[128:143]
    ds_read_b64_tr_b16 v[40:41], v26 offset:49152
    ds_read_b64_tr_b16 v[42:43], v26 offset:49664
    v_mfma_f32_32x32x16_bf16 v[144:159], v[64:67], v[80:83], v[144:159]
    ds_read_b64_tr_b16 v[44:45], v28 offset:49152
    ds_read_b64_tr_b16 v[46:47], v28 offset:49664
    s_cmp_lg_u32 s80, 0
    s_cbranch_scc1 kvs_24
    v_mfma_f32_32x32x16_bf16 v[160:175], v[68:71], v[76:79], v[160:175]
    v_mfma_f32_32x32x16_bf16 v[176:191], v[68:71], v[80:83], v[176:191]
kvs_24:
    s_waitcnt lgkmcnt(0)
    v_mfma_f32_32x32x16_bf16 v[96:111], v[36:39], v[52:55], v[96:111]
    ds_read_b128 v[76:79], v17 offset:49152
    ds_read_b64_tr_b16 v[60:61], v24 offset:51200
    v_mfma_f32_32x32x16_bf16 v[112:127], v[36:39], v[56:59], v[112:127]
    ds_read_b64_tr_b16 v[62:63], v24 offset:51712
    ds_read_b128 v[80:83], v17 offset:53248
    v_mfma_f32_32x32x16_bf16 v[128:143], v[40:43], v[52:55], v[128:143]
    ds_read_b64_tr_b16 v[64:65], v26 offset:51200
    ds_read_b64_tr_b16 v[66:67], v26 offset:51712
    v_mfma_f32_32x32x16_bf16 v[144:159], v[40:43], v[56:59], v[144:159]
    ds_read_b64_tr_b16 v[68:69], v28 offset:51200
    ds_read_b64_tr_b16 v[70:71], v28 offset:51712
    s_cmp_lg_u32 s80, 0
    s_cbranch_scc1 kvs_25
    v_mfma_f32_32x32x16_bf16 v[160:175], v[44:47], v[52:55], v[160:175]
    v_mfma_f32_32x32x16_bf16 v[176:191], v[44:47], v[56:59], v[176:191]
kvs_25:
    v_smfmac_f32_16x16x64_bf16 v[228:231], v[224:227], v[36:43], v84
    v_smfmac_f32_16x16x64_bf16 v[232:235], v[224:227], v[44:51], v84
    s_waitcnt lgkmcnt(0)
    v_mfma_f32_32x32x16_bf16 v[96:111], v[60:63], v[76:79], v[96:111]
    ds_read_b128 v[52:55], v18 offset:49152
    ds_read_b64_tr_b16 v[36:37], v25 offset:49152
    v_mfma_f32_32x32x16_bf16 v[112:127], v[60:63], v[80:83], v[112:127]
    ds_read_b64_tr_b16 v[38:39], v25 offset:49664
    ds_read_b128 v[56:59], v18 offset:53248
    v_mfma_f32_32x32x16_bf16 v[128:143], v[64:67], v[76:79], v[128:143]
    ds_read_b64_tr_b16 v[40:41], v27 offset:49152
    ds_read_b64_tr_b16 v[42:43], v27 offset:49664
    v_mfma_f32_32x32x16_bf16 v[144:159], v[64:67], v[80:83], v[144:159]
    ds_read_b64_tr_b16 v[44:45], v29 offset:49152
    ds_read_b64_tr_b16 v[46:47], v29 offset:49664
    s_cmp_lg_u32 s80, 0
    s_cbranch_scc1 kvs_26
    v_mfma_f32_32x32x16_bf16 v[160:175], v[68:71], v[76:79], v[160:175]
    v_mfma_f32_32x32x16_bf16 v[176:191], v[68:71], v[80:83], v[176:191]
kvs_26:
    v_smfmac_f32_16x16x64_bf16 v[228:231], v[224:227], v[60:67], v84
    v_smfmac_f32_16x16x64_bf16 v[232:235], v[224:227], v[68:75], v84
    s_waitcnt lgkmcnt(0)
    v_mfma_f32_32x32x16_bf16 v[96:111], v[36:39], v[52:55], v[96:111]
    ds_read_b128 v[76:79], v19 offset:49152
    ds_read_b64_tr_b16 v[60:61], v25 offset:51200
    v_mfma_f32_32x32x16_bf16 v[112:127], v[36:39], v[56:59], v[112:127]
    ds_read_b64_tr_b16 v[62:63], v25 offset:51712
    ds_read_b128 v[80:83], v19 offset:53248
    v_mfma_f32_32x32x16_bf16 v[128:143], v[40:43], v[52:55], v[128:143]
    ds_read_b64_tr_b16 v[64:65], v27 offset:51200
    ds_read_b64_tr_b16 v[66:67], v27 offset:51712
    v_mfma_f32_32x32x16_bf16 v[144:159], v[40:43], v[56:59], v[144:159]
    ds_read_b64_tr_b16 v[68:69], v29 offset:51200
    ds_read_b64_tr_b16 v[70:71], v29 offset:51712
    s_cmp_lg_u32 s80, 0
    s_cbranch_scc1 kvs_27
    v_mfma_f32_32x32x16_bf16 v[160:175], v[44:47], v[52:55], v[160:175]
    v_mfma_f32_32x32x16_bf16 v[176:191], v[44:47], v[56:59], v[176:191]
kvs_27:
    s_waitcnt lgkmcnt(0)
    s_barrier
    v_mfma_f32_32x32x16_bf16 v[96:111], v[60:63], v[76:79], v[96:111]
    ds_read_b128 v[52:55], v20 offset:0
    ds_read_b64_tr_b16 v[36:37], v30 offset:0
    v_mfma_f32_32x32x16_bf16 v[112:127], v[60:63], v[80:83], v[112:127]
    ds_read_b64_tr_b16 v[38:39], v30 offset:512
    ds_read_b128 v[56:59], v20 offset:4096
    v_mfma_f32_32x32x16_bf16 v[128:143], v[64:67], v[76:79], v[128:143]
    ds_read_b64_tr_b16 v[40:41], v32 offset:0
    ds_read_b64_tr_b16 v[42:43], v32 offset:512
    v_mfma_f32_32x32x16_bf16 v[144:159], v[64:67], v[80:83], v[144:159]
    ds_read_b64_tr_b16 v[44:45], v34 offset:0
    ds_read_b64_tr_b16 v[46:47], v34 offset:512
    s_cmp_lg_u32 s80, 0
    s_cbranch_scc1 kvs_28
    v_mfma_f32_32x32x16_bf16 v[160:175], v[68:71], v[76:79], v[160:175]
    v_mfma_f32_32x32x16_bf16 v[176:191], v[68:71], v[80:83], v[176:191]
kvs_28:
    s_waitcnt lgkmcnt(0)
    v_mfma_f32_32x32x16_bf16 v[96:111], v[36:39], v[52:55], v[96:111]
    ds_read_b128 v[76:79], v21 offset:0
    ds_read_b64_tr_b16 v[60:61], v30 offset:2048
    v_mfma_f32_32x32x16_bf16 v[112:127], v[36:39], v[56:59], v[112:127]
    ds_read_b64_tr_b16 v[62:63], v30 offset:2560
    ds_read_b128 v[80:83], v21 offset:4096
    v_mfma_f32_32x32x16_bf16 v[128:143], v[40:43], v[52:55], v[128:143]
    ds_read_b64_tr_b16 v[64:65], v32 offset:2048
    ds_read_b64_tr_b16 v[66:67], v32 offset:2560
    v_mfma_f32_32x32x16_bf16 v[144:159], v[40:43], v[56:59], v[144:159]
    ds_read_b64_tr_b16 v[68:69], v34 offset:2048
    ds_read_b64_tr_b16 v[70:71], v34 offset:2560
    s_cmp_lg_u32 s80, 0
    s_cbranch_scc1 kvs_29
    v_mfma_f32_32x32x16_bf16 v[160:175], v[44:47], v[52:55], v[160:175]
    v_mfma_f32_32x32x16_bf16 v[176:191], v[44:47], v[56:59], v[176:191]
kvs_29:
    v_smfmac_f32_16x16x64_bf16 v[228:231], v[224:227], v[36:43], v84
    v_smfmac_f32_16x16x64_bf16 v[232:235], v[224:227], v[44:51], v84
    s_waitcnt lgkmcnt(0)
    v_mfma_f32_32x32x16_bf16 v[96:111], v[60:63], v[76:79], v[96:111]
    ds_read_b128 v[52:55], v22 offset:0
    ds_read_b64_tr_b16 v[36:37], v31 offset:0
    v_mfma_f32_32x32x16_bf16 v[112:127], v[60:63], v[80:83], v[112:127]
    ds_read_b64_tr_b16 v[38:39], v31 offset:512
    ds_read_b128 v[56:59], v22 offset:4096
    v_mfma_f32_32x32x16_bf16 v[128:143], v[64:67], v[76:79], v[128:143]
    ds_read_b64_tr_b16 v[40:41], v33 offset:0
    ds_read_b64_tr_b16 v[42:43], v33 offset:512
    v_mfma_f32_32x32x16_bf16 v[144:159], v[64:67], v[80:83], v[144:159]
    ds_read_b64_tr_b16 v[44:45], v35 offset:0
    ds_read_b64_tr_b16 v[46:47], v35 offset:512
    s_cmp_lg_u32 s80, 0
    s_cbranch_scc1 kvs_30
    v_mfma_f32_32x32x16_bf16 v[160:175], v[68:71], v[76:79], v[160:175]
    v_mfma_f32_32x32x16_bf16 v[176:191], v[68:71], v[80:83], v[176:191]
kvs_30:
    v_smfmac_f32_16x16x64_bf16 v[228:231], v[224:227], v[60:67], v84
    v_smfmac_f32_16x16x64_bf16 v[232:235], v[224:227], v[68:75], v84
    s_waitcnt lgkmcnt(0)
    v_mfma_f32_32x32x16_bf16 v[96:111], v[36:39], v[52:55], v[96:111]
    ds_read_b128 v[76:79], v23 offset:0
    ds_read_b64_tr_b16 v[60:61], v31 offset:2048
    v_mfma_f32_32x32x16_bf16 v[112:127], v[36:39], v[56:59], v[112:127]
    ds_read_b64_tr_b16 v[62:63], v31 offset:2560
    ds_read_b128 v[80:83], v23 offset:4096
    v_mfma_f32_32x32x16_bf16 v[128:143], v[40:43], v[52:55], v[128:143]
    ds_read_b64_tr_b16 v[64:65], v33 offset:2048
    ds_read_b64_tr_b16 v[66:67], v33 offset:2560
    v_mfma_f32_32x32x16_bf16 v[144:159], v[40:43], v[56:59], v[144:159]
    ds_read_b64_tr_b16 v[68:69], v35 offset:2048
    ds_read_b64_tr_b16 v[70:71], v35 offset:2560
    s_cmp_lg_u32 s80, 0
    s_cbranch_scc1 kvs_31
    v_mfma_f32_32x32x16_bf16 v[160:175], v[44:47], v[52:55], v[160:175]
    v_mfma_f32_32x32x16_bf16 v[176:191], v[44:47], v[56:59], v[176:191]
kvs_31:
    s_waitcnt lgkmcnt(0)
    s_barrier
    v_mfma_f32_32x32x16_bf16 v[96:111], v[60:63], v[76:79], v[96:111]
    ds_read_b128 v[52:55], v16 offset:0
    ds_read_b64_tr_b16 v[36:37], v24 offset:0
    v_mfma_f32_32x32x16_bf16 v[112:127], v[60:63], v[80:83], v[112:127]
    ds_read_b64_tr_b16 v[38:39], v24 offset:512
    ds_read_b128 v[56:59], v16 offset:4096
    v_mfma_f32_32x32x16_bf16 v[128:143], v[64:67], v[76:79], v[128:143]
    ds_read_b64_tr_b16 v[40:41], v26 offset:0
    ds_read_b64_tr_b16 v[42:43], v26 offset:512
    v_mfma_f32_32x32x16_bf16 v[144:159], v[64:67], v[80:83], v[144:159]
    ds_read_b64_tr_b16 v[44:45], v28 offset:0
    ds_read_b64_tr_b16 v[46:47], v28 offset:512
    s_cmp_lg_u32 s80, 0
    s_cbranch_scc1 kvs_32
    v_mfma_f32_32x32x16_bf16 v[160:175], v[68:71], v[76:79], v[160:175]
    v_mfma_f32_32x32x16_bf16 v[176:191], v[68:71], v[80:83], v[176:191]
kvs_32:
    s_waitcnt lgkmcnt(0)
    v_mfma_f32_32x32x16_bf16 v[96:111], v[36:39], v[52:55], v[96:111]
    ds_read_b128 v[76:79], v17 offset:0
    ds_read_b64_tr_b16 v[60:61], v24 offset:2048
    v_mfma_f32_32x32x16_bf16 v[112:127], v[36:39], v[56:59], v[112:127]
    ds_read_b64_tr_b16 v[62:63], v24 offset:2560
    ds_read_b128 v[80:83], v17 offset:4096
    v_mfma_f32_32x32x16_bf16 v[128:143], v[40:43], v[52:55], v[128:143]
    ds_read_b64_tr_b16 v[64:65], v26 offset:2048
    ds_read_b64_tr_b16 v[66:67], v26 offset:2560
    v_mfma_f32_32x32x16_bf16 v[144:159], v[40:43], v[56:59], v[144:159]
    ds_read_b64_tr_b16 v[68:69], v28 offset:2048
    ds_read_b64_tr_b16 v[70:71], v28 offset:2560
    s_cmp_lg_u32 s80, 0
    s_cbranch_scc1 kvs_33
    v_mfma_f32_32x32x16_bf16 v[160:175], v[44:47], v[52:55], v[160:175]
    v_mfma_f32_32x32x16_bf16 v[176:191], v[44:47], v[56:59], v[176:191]
kvs_33:
    v_smfmac_f32_16x16x64_bf16 v[228:231], v[224:227], v[36:43], v84
    v_smfmac_f32_16x16x64_bf16 v[232:235], v[224:227], v[44:51], v84
    s_waitcnt lgkmcnt(0)
    v_mfma_f32_32x32x16_bf16 v[96:111], v[60:63], v[76:79], v[96:111]
    ds_read_b128 v[52:55], v18 offset:0
    ds_read_b64_tr_b16 v[36:37], v25 offset:0
    v_mfma_f32_32x32x16_bf16 v[112:127], v[60:63], v[80:83], v[112:127]
    ds_read_b64_tr_b16 v[38:39], v25 offset:512
    ds_read_b128 v[56:59], v18 offset:4096
    v_mfma_f32_32x32x16_bf16 v[128:143], v[64:67], v[76:79], v[128:143]
    ds_read_b64_tr_b16 v[40:41], v27 offset:0
    ds_read_b64_tr_b16 v[42:43], v27 offset:512
    v_mfma_f32_32x32x16_bf16 v[144:159], v[64:67], v[80:83], v[144:159]
    ds_read_b64_tr_b16 v[44:45], v29 offset:0
    ds_read_b64_tr_b16 v[46:47], v29 offset:512
    s_cmp_lg_u32 s80, 0
    s_cbranch_scc1 kvs_34
    v_mfma_f32_32x32x16_bf16 v[160:175], v[68:71], v[76:79], v[160:175]
    v_mfma_f32_32x32x16_bf16 v[176:191], v[68:71], v[80:83], v[176:191]
kvs_34:
    v_smfmac_f32_16x16x64_bf16 v[228:231], v[224:227], v[60:67], v84
    v_smfmac_f32_16x16x64_bf16 v[232:235], v[224:227], v[68:75], v84
    s_waitcnt lgkmcnt(0)
    v_mfma_f32_32x32x16_bf16 v[96:111], v[36:39], v[52:55], v[96:111]
    ds_read_b128 v[76:79], v19 offset:0
    ds_read_b64_tr_b16 v[60:61], v25 offset:2048
    v_mfma_f32_32x32x16_bf16 v[112:127], v[36:39], v[56:59], v[112:127]
    ds_read_b64_tr_b16 v[62:63], v25 offset:2560
    ds_read_b128 v[80:83], v19 offset:4096
    v_mfma_f32_32x32x16_bf16 v[128:143], v[40:43], v[52:55], v[128:143]
    ds_read_b64_tr_b16 v[64:65], v27 offset:2048
    ds_read_b64_tr_b16 v[66:67], v27 offset:2560
    v_mfma_f32_32x32x16_bf16 v[144:159], v[40:43], v[56:59], v[144:159]
    ds_read_b64_tr_b16 v[68:69], v29 offset:2048
    ds_read_b64_tr_b16 v[70:71], v29 offset:2560
    s_cmp_lg_u32 s80, 0
    s_cbranch_scc1 kvs_35
    v_mfma_f32_32x32x16_bf16 v[160:175], v[44:47], v[52:55], v[160:175]
    v_mfma_f32_32x32x16_bf16 v[176:191], v[44:47], v[56:59], v[176:191]
kvs_35:
    s_waitcnt lgkmcnt(0)
    s_barrier
    v_mfma_f32_32x32x16_bf16 v[96:111], v[60:63], v[76:79], v[96:111]
    ds_read_b128 v[52:55], v16 offset:49152
    ds_read_b64_tr_b16 v[36:37], v24 offset:49152
    v_mfma_f32_32x32x16_bf16 v[112:127], v[60:63], v[80:83], v[112:127]
    ds_read_b64_tr_b16 v[38:39], v24 offset:49664
    ds_read_b128 v[56:59], v16 offset:53248
    v_mfma_f32_32x32x16_bf16 v[128:143], v[64:67], v[76:79], v[128:143]
    ds_read_b64_tr_b16 v[40:41], v26 offset:49152
    ds_read_b64_tr_b16 v[42:43], v26 offset:49664
    v_mfma_f32_32x32x16_bf16 v[144:159], v[64:67], v[80:83], v[144:159]
    ds_read_b64_tr_b16 v[44:45], v28 offset:49152
    ds_read_b64_tr_b16 v[46:47], v28 offset:49664
    s_cmp_lg_u32 s80, 0
    s_cbranch_scc1 kvs_36
    v_mfma_f32_32x32x16_bf16 v[160:175], v[68:71], v[76:79], v[160:175]
    v_mfma_f32_32x32x16_bf16 v[176:191], v[68:71], v[80:83], v[176:191]
kvs_36:
    s_waitcnt lgkmcnt(0)
    v_mfma_f32_32x32x16_bf16 v[96:111], v[36:39], v[52:55], v[96:111]
    ds_read_b128 v[76:79], v17 offset:49152
    ds_read_b64_tr_b16 v[60:61], v24 offset:51200
    v_mfma_f32_32x32x16_bf16 v[112:127], v[36:39], v[56:59], v[112:127]
    ds_read_b64_tr_b16 v[62:63], v24 offset:51712
    ds_read_b128 v[80:83], v17 offset:53248
    v_mfma_f32_32x32x16_bf16 v[128:143], v[40:43], v[52:55], v[128:143]
    ds_read_b64_tr_b16 v[64:65], v26 offset:51200
    ds_read_b64_tr_b16 v[66:67], v26 offset:51712
    v_mfma_f32_32x32x16_bf16 v[144:159], v[40:43], v[56:59], v[144:159]
    ds_read_b64_tr_b16 v[68:69], v28 offset:51200
    ds_read_b64_tr_b16 v[70:71], v28 offset:51712
    s_cmp_lg_u32 s80, 0
    s_cbranch_scc1 kvs_37
    v_mfma_f32_32x32x16_bf16 v[160:175], v[44:47], v[52:55], v[160:175]
    v_mfma_f32_32x32x16_bf16 v[176:191], v[44:47], v[56:59], v[176:191]
kvs_37:
    v_smfmac_f32_16x16x64_bf16 v[228:231], v[224:227], v[36:43], v84
    v_smfmac_f32_16x16x64_bf16 v[232:235], v[224:227], v[44:51], v84
    s_waitcnt lgkmcnt(0)
    v_mfma_f32_32x32x16_bf16 v[96:111], v[60:63], v[76:79], v[96:111]
    ds_read_b128 v[52:55], v18 offset:49152
    ds_read_b64_tr_b16 v[36:37], v25 offset:49152
    v_mfma_f32_32x32x16_bf16 v[112:127], v[60:63], v[80:83], v[112:127]
    ds_read_b64_tr_b16 v[38:39], v25 offset:49664
    ds_read_b128 v[56:59], v18 offset:53248
    v_mfma_f32_32x32x16_bf16 v[128:143], v[64:67], v[76:79], v[128:143]
    ds_read_b64_tr_b16 v[40:41], v27 offset:49152
    ds_read_b64_tr_b16 v[42:43], v27 offset:49664
    v_mfma_f32_32x32x16_bf16 v[144:159], v[64:67], v[80:83], v[144:159]
    ds_read_b64_tr_b16 v[44:45], v29 offset:49152
    ds_read_b64_tr_b16 v[46:47], v29 offset:49664
    s_cmp_lg_u32 s80, 0
    s_cbranch_scc1 kvs_38
    v_mfma_f32_32x32x16_bf16 v[160:175], v[68:71], v[76:79], v[160:175]
    v_mfma_f32_32x32x16_bf16 v[176:191], v[68:71], v[80:83], v[176:191]
kvs_38:
    v_smfmac_f32_16x16x64_bf16 v[228:231], v[224:227], v[60:67], v84
    v_smfmac_f32_16x16x64_bf16 v[232:235], v[224:227], v[68:75], v84
    s_waitcnt lgkmcnt(0)
    v_mfma_f32_32x32x16_bf16 v[96:111], v[36:39], v[52:55], v[96:111]
    ds_read_b128 v[76:79], v19 offset:49152
    ds_read_b64_tr_b16 v[60:61], v25 offset:51200
    v_mfma_f32_32x32x16_bf16 v[112:127], v[36:39], v[56:59], v[112:127]
    ds_read_b64_tr_b16 v[62:63], v25 offset:51712
    ds_read_b128 v[80:83], v19 offset:53248
    v_mfma_f32_32x32x16_bf16 v[128:143], v[40:43], v[52:55], v[128:143]
    ds_read_b64_tr_b16 v[64:65], v27 offset:51200
    ds_read_b64_tr_b16 v[66:67], v27 offset:51712
    v_mfma_f32_32x32x16_bf16 v[144:159], v[40:43], v[56:59], v[144:159]
    ds_read_b64_tr_b16 v[68:69], v29 offset:51200
    ds_read_b64_tr_b16 v[70:71], v29 offset:51712
    s_cmp_lg_u32 s80, 0
    s_cbranch_scc1 kvs_39
    v_mfma_f32_32x32x16_bf16 v[160:175], v[44:47], v[52:55], v[160:175]
    v_mfma_f32_32x32x16_bf16 v[176:191], v[44:47], v[56:59], v[176:191]
kvs_39:
    s_waitcnt lgkmcnt(0)
    s_barrier
    v_mfma_f32_32x32x16_bf16 v[96:111], v[60:63], v[76:79], v[96:111]
    ds_read_b128 v[52:55], v20 offset:0
    ds_read_b64_tr_b16 v[36:37], v30 offset:0
    v_mfma_f32_32x32x16_bf16 v[112:127], v[60:63], v[80:83], v[112:127]
    ds_read_b64_tr_b16 v[38:39], v30 offset:512
    ds_read_b128 v[56:59], v20 offset:4096
    v_mfma_f32_32x32x16_bf16 v[128:143], v[64:67], v[76:79], v[128:143]
    ds_read_b64_tr_b16 v[40:41], v32 offset:0
    ds_read_b64_tr_b16 v[42:43], v32 offset:512
    v_mfma_f32_32x32x16_bf16 v[144:159], v[64:67], v[80:83], v[144:159]
    ds_read_b64_tr_b16 v[44:45], v34 offset:0
    ds_read_b64_tr_b16 v[46:47], v34 offset:512
    s_cmp_lg_u32 s80, 0
    s_cbranch_scc1 kvs_40
    v_mfma_f32_32x32x16_bf16 v[160:175], v[68:71], v[76:79], v[160:175]
    v_mfma_f32_32x32x16_bf16 v[176:191], v[68:71], v[80:83], v[176:191]
kvs_40:
    s_waitcnt lgkmcnt(0)
    v_mfma_f32_32x32x16_bf16 v[96:111], v[36:39], v[52:55], v[96:111]
    ds_read_b128 v[76:79], v21 offset:0
    ds_read_b64_tr_b16 v[60:61], v30 offset:2048
    v_mfma_f32_32x32x16_bf16 v[112:127], v[36:39], v[56:59], v[112:127]
    ds_read_b64_tr_b16 v[62:63], v30 offset:2560
    ds_read_b128 v[80:83], v21 offset:4096
    v_mfma_f32_32x32x16_bf16 v[128:143], v[40:43], v[52:55], v[128:143]
    ds_read_b64_tr_b16 v[64:65], v32 offset:2048
    ds_read_b64_tr_b16 v[66:67], v32 offset:2560
    v_mfma_f32_32x32x16_bf16 v[144:159], v[40:43], v[56:59], v[144:159]
    ds_read_b64_tr_b16 v[68:69], v34 offset:2048
    ds_read_b64_tr_b16 v[70:71], v34 offset:2560
    s_cmp_lg_u32 s80, 0
    s_cbranch_scc1 kvs_41
    v_mfma_f32_32x32x16_bf16 v[160:175], v[44:47], v[52:55], v[160:175]
    v_mfma_f32_32x32x16_bf16 v[176:191], v[44:47], v[56:59], v[176:191]
kvs_41:
    v_smfmac_f32_16x16x64_bf16 v[228:231], v[224:227], v[36:43], v84
    v_smfmac_f32_16x16x64_bf16 v[232:235], v[224:227], v[44:51], v84
    s_waitcnt lgkmcnt(0)
    v_mfma_f32_32x32x16_bf16 v[96:111], v[60:63], v[76:79], v[96:111]
    ds_read_b128 v[52:55], v22 offset:0
    ds_read_b64_tr_b16 v[36:37], v31 offset:0
    v_mfma_f32_32x32x16_bf16 v[112:127], v[60:63], v[80:83], v[112:127]
    ds_read_b64_tr_b16 v[38:39], v31 offset:512
    ds_read_b128 v[56:59], v22 offset:4096
    v_mfma_f32_32x32x16_bf16 v[128:143], v[64:67], v[76:79], v[128:143]
    ds_read_b64_tr_b16 v[40:41], v33 offset:0
    ds_read_b64_tr_b16 v[42:43], v33 offset:512
    v_mfma_f32_32x32x16_bf16 v[144:159], v[64:67], v[80:83], v[144:159]
    ds_read_b64_tr_b16 v[44:45], v35 offset:0
    ds_read_b64_tr_b16 v[46:47], v35 offset:512
    s_cmp_lg_u32 s80, 0
    s_cbranch_scc1 kvs_42
    v_mfma_f32_32x32x16_bf16 v[160:175], v[68:71], v[76:79], v[160:175]
    v_mfma_f32_32x32x16_bf16 v[176:191], v[68:71], v[80:83], v[176:191]
kvs_42:
    v_smfmac_f32_16x16x64_bf16 v[228:231], v[224:227], v[60:67], v84
    v_smfmac_f32_16x16x64_bf16 v[232:235], v[224:227], v[68:75], v84
    s_waitcnt lgkmcnt(0)
    v_mfma_f32_32x32x16_bf16 v[96:111], v[36:39], v[52:55], v[96:111]
    ds_read_b128 v[76:79], v23 offset:0
    ds_read_b64_tr_b16 v[60:61], v31 offset:2048
    v_mfma_f32_32x32x16_bf16 v[112:127], v[36:39], v[56:59], v[112:127]
    ds_read_b64_tr_b16 v[62:63], v31 offset:2560
    ds_read_b128 v[80:83], v23 offset:4096
    v_mfma_f32_32x32x16_bf16 v[128:143], v[40:43], v[52:55], v[128:143]
    ds_read_b64_tr_b16 v[64:65], v33 offset:2048
    ds_read_b64_tr_b16 v[66:67], v33 offset:2560
    v_mfma_f32_32x32x16_bf16 v[144:159], v[40:43], v[56:59], v[144:159]
    ds_read_b64_tr_b16 v[68:69], v35 offset:2048
    ds_read_b64_tr_b16 v[70:71], v35 offset:2560
    s_cmp_lg_u32 s80, 0
    s_cbranch_scc1 kvs_43
    v_mfma_f32_32x32x16_bf16 v[160:175], v[44:47], v[52:55], v[160:175]
    v_mfma_f32_32x32x16_bf16 v[176:191], v[44:47], v[56:59], v[176:191]
kvs_43:
    s_waitcnt lgkmcnt(0)
    s_barrier
    v_mfma_f32_32x32x16_bf16 v[96:111], v[60:63], v[76:79], v[96:111]
    ds_read_b128 v[52:55], v16 offset:0
    ds_read_b64_tr_b16 v[36:37], v24 offset:0
    v_mfma_f32_32x32x16_bf16 v[112:127], v[60:63], v[80:83], v[112:127]
    ds_read_b64_tr_b16 v[38:39], v24 offset:512
    ds_read_b128 v[56:59], v16 offset:4096
    v_mfma_f32_32x32x16_bf16 v[128:143], v[64:67], v[76:79], v[128:143]
    ds_read_b64_tr_b16 v[40:41], v26 offset:0
    ds_read_b64_tr_b16 v[42:43], v26 offset:512
    v_mfma_f32_32x32x16_bf16 v[144:159], v[64:67], v[80:83], v[144:159]
    ds_read_b64_tr_b16 v[44:45], v28 offset:0
    ds_read_b64_tr_b16 v[46:47], v28 offset:512
    s_cmp_lg_u32 s80, 0
    s_cbranch_scc1 kvs_44
    v_mfma_f32_32x32x16_bf16 v[160:175], v[68:71], v[76:79], v[160:175]
    v_mfma_f32_32x32x16_bf16 v[176:191], v[68:71], v[80:83], v[176:191]
kvs_44:
    s_lshl_b32 s36, s29, 10
    s_lshl_b32 s37, s64, 9
    s_add_u32 s36, s36, s37
    s_add_u32 s36, s36, 3932160
    v_and_b32 v7, 0xff, v3
    buffer_load_dwordx2 v[12:13], v7, s[16:19], s36 offen sc1
    buffer_load_dwordx2 v[14:15], v7, s[16:19], s36 offen offset:256 sc1
    s_waitcnt lgkmcnt(0)
    v_mfma_f32_32x32x16_bf16 v[96:111], v[36:39], v[52:55], v[96:111]
    ds_read_b128 v[76:79], v17 offset:0
    ds_read_b64_tr_b16 v[60:61], v24 offset:2048
    v_mfma_f32_32x32x16_bf16 v[112:127], v[36:39], v[56:59], v[112:127]
    ds_read_b64_tr_b16 v[62:63], v24 offset:2560
    ds_read_b128 v[80:83], v17 offset:4096
    v_mfma_f32_32x32x16_bf16 v[128:143], v[40:43], v[52:55], v[128:143]
    ds_read_b64_tr_b16 v[64:65], v26 offset:2048
    ds_read_b64_tr_b16 v[66:67], v26 offset:2560
    v_mfma_f32_32x32x16_bf16 v[144:159], v[40:43], v[56:59], v[144:159]
    ds_read_b64_tr_b16 v[68:69], v28 offset:2048
    ds_read_b64_tr_b16 v[70:71], v28 offset:2560
    s_cmp_lg_u32 s80, 0
    s_cbranch_scc1 kvs_45
    v_mfma_f32_32x32x16_bf16 v[160:175], v[44:47], v[52:55], v[160:175]
    v_mfma_f32_32x32x16_bf16 v[176:191], v[44:47], v[56:59], v[176:191]
kvs_45:
    v_smfmac_f32_16x16x64_bf16 v[228:231], v[224:227], v[36:43], v84
    v_smfmac_f32_16x16x64_bf16 v[232:235], v[224:227], v[44:51], v84
    s_waitcnt lgkmcnt(0)
    v_smfmac_f32_16x16x64_bf16 v[228:231], v[224:227], v[60:67], v84
    v_smfmac_f32_16x16x64_bf16 v[232:235], v[224:227], v[68:75], v84
    v_mfma_f32_32x32x16_bf16 v[96:111], v[60:63], v[76:79], v[96:111]
    ds_read_b128 v[52:55], v18 offset:0
    ds_read_b64_tr_b16 v[36:37], v25 offset:0
    v_mfma_f32_32x32x16_bf16 v[112:127], v[60:63], v[80:83], v[112:127]
    ds_read_b64_tr_b16 v[38:39], v25 offset:512
    ds_read_b128 v[56:59], v18 offset:4096
    v_mfma_f32_32x32x16_bf16 v[128:143], v[64:67], v[76:79], v[128:143]
    ds_read_b64_tr_b16 v[40:41], v27 offset:0
    ds_read_b64_tr_b16 v[42:43], v27 offset:512
    v_mfma_f32_32x32x16_bf16 v[144:159], v[64:67], v[80:83], v[144:159]
    ds_read_b64_tr_b16 v[44:45], v29 offset:0
    ds_read_b64_tr_b16 v[46:47], v29 offset:512
    s_cmp_lg_u32 s80, 0
    s_cbranch_scc1 kvs_46
    v_mfma_f32_32x32x16_bf16 v[160:175], v[68:71], v[76:79], v[160:175]
    v_mfma_f32_32x32x16_bf16 v[176:191], v[68:71], v[80:83], v[176:191]
kvs_46:
    s_lshl_b32 s36, s64, 10
    s_mul_i32 s37, s65, 384
    s_add_u32 s36, s36, s37
    s_add_u32 s36, s36, 153600
    v_add_u32 v6, s36, v85
    v_add_f32 v228, v228, v229
    v_add_f32 v232, v232, v233
    ds_write_b32 v6, v228
    s_mov_b32 exec_hi, 0
    ds_write_b32 v6, v232 offset:256
    s_mov_b32 exec_hi, -1
    s_waitcnt lgkmcnt(0)
    s_barrier
    v_mfma_f32_32x32x16_bf16 v[96:111], v[36:39], v[52:55], v[96:111]
    ds_read_b128 v[76:79], v19 offset:0
    ds_read_b64_tr_b16 v[60:61], v25 offset:2048
    v_mfma_f32_32x32x16_bf16 v[112:127], v[36:39], v[56:59], v[112:127]
    ds_read_b64_tr_b16 v[62:63], v25 offset:2560
    ds_read_b128 v[80:83], v19 offset:4096
    v_mfma_f32_32x32x16_bf16 v[128:143], v[40:43], v[52:55], v[128:143]
    ds_read_b64_tr_b16 v[64:65], v27 offset:2048
    ds_read_b64_tr_b16 v[66:67], v27 offset:2560
    v_mfma_f32_32x32x16_bf16 v[144:159], v[40:43], v[56:59], v[144:159]
    ds_read_b64_tr_b16 v[68:69], v29 offset:2048
    ds_read_b64_tr_b16 v[70:71], v29 offset:2560
    s_cmp_lg_u32 s80, 0
    s_cbranch_scc1 kvs_47
    v_mfma_f32_32x32x16_bf16 v[160:175], v[44:47], v[52:55], v[160:175]
    v_mfma_f32_32x32x16_bf16 v[176:191], v[44:47], v[56:59], v[176:191]
kvs_47:
    s_waitcnt lgkmcnt(0)
    s_barrier
    v_mfma_f32_32x32x16_bf16 v[96:111], v[60:63], v[76:79], v[96:111]
    v_lshrrev_b32 v9, 5, v1
    s_mul_i32 s36, s65, 384
    s_add_u32 s36, s36, 147456
    v_lshl_add_u32 v9, v9, 4, s36
    ds_read_b128 v[36:39], v9 offset:0
    ds_read_b128 v[40:43], v9 offset:32
    ds_read_b128 v[44:47], v9 offset:64
    ds_read_b128 v[48:51], v9 offset:96
    v_mfma_f32_32x32x16_bf16 v[112:127], v[60:63], v[80:83], v[112:127]
    ds_read_b128 v[16:19], v9 offset:128
    ds_read_b128 v[20:23], v9 offset:160
    ds_read_b128 v[24:27], v9 offset:192
    ds_read_b128 v[28:31], v9 offset:224
    v_mfma_f32_32x32x16_bf16 v[128:143], v[64:67], v[76:79], v[128:143]
    v_mfma_f32_32x32x16_bf16 v[144:159], v[64:67], v[80:83], v[144:159]
    s_cmp_lg_u32 s80, 0
    s_cbranch_scc1 kvs_48
    v_mfma_f32_32x32x16_bf16 v[160:175], v[68:71], v[76:79], v[160:175]
    v_mfma_f32_32x32x16_bf16 v[176:191], v[68:71], v[80:83], v[176:191]
kvs_48:
    s_setprio 2
    s_waitcnt vmcnt(0)
    v_rcp_f32 v241, v13
    v_rcp_f32 v243, v15
    s_nop 0
    v_mul_f32 v240, 0x3ea52b5c, v241
    v_mul_f32 v242, 0x3ea52b5c, v243
    s_lshl_b32 s77, s29, 1
    s_add_u32 s77, s77, s64
    s_mul_i32 s36, s77, 81920
    s_lshl_b32 s37, s69, 6
    s_add_u32 s36, s36, s37
    s_mul_i32 s37, s65, 12288
    s_add_u32 s36, s36, s37
    s_waitcnt lgkmcnt(0)
    v_pk_fma_f32 v[96:97], v[36:37], v[12:13], v[96:97] op_sel_hi:[1,0,1] neg_lo:[0,1,0] neg_hi:[0,1,0]
    v_pk_fma_f32 v[98:99], v[38:39], v[12:13], v[98:99] op_sel_hi:[1,0,1] neg_lo:[0,1,0] neg_hi:[0,1,0]
    v_pk_fma_f32 v[100:101], v[40:41], v[12:13], v[100:101] op_sel_hi:[1,0,1] neg_lo:[0,1,0] neg_hi:[0,1,0]
    v_pk_fma_f32 v[102:103], v[42:43], v[12:13], v[102:103] op_sel_hi:[1,0,1] neg_lo:[0,1,0] neg_hi:[0,1,0]
    v_pk_fma_f32 v[104:105], v[44:45], v[12:13], v[104:105] op_sel_hi:[1,0,1] neg_lo:[0,1,0] neg_hi:[0,1,0]
    v_pk_fma_f32 v[106:107], v[46:47], v[12:13], v[106:107] op_sel_hi:[1,0,1] neg_lo:[0,1,0] neg_hi:[0,1,0]
    v_pk_fma_f32 v[108:109], v[48:49], v[12:13], v[108:109] op_sel_hi:[1,0,1] neg_lo:[0,1,0] neg_hi:[0,1,0]
    v_pk_fma_f32 v[110:111], v[50:51], v[12:13], v[110:111] op_sel_hi:[1,0,1] neg_lo:[0,1,0] neg_hi:[0,1,0]
    v_pk_mul_f32 v[96:97], v[96:97], v[240:241] op_sel:[0,0] op_sel_hi:[1,0]
    v_pk_mul_f32 v[98:99], v[98:99], v[240:241] op_sel:[0,0] op_sel_hi:[1,0]
    v_pk_mul_f32 v[100:101], v[100:101], v[240:241] op_sel:[0,0] op_sel_hi:[1,0]
    v_pk_mul_f32 v[102:103], v[102:103], v[240:241] op_sel:[0,0] op_sel_hi:[1,0]
    v_pk_mul_f32 v[104:105], v[104:105], v[240:241] op_sel:[0,0] op_sel_hi:[1,0]
    v_pk_mul_f32 v[106:107], v[106:107], v[240:241] op_sel:[0,0] op_sel_hi:[1,0]
    v_pk_mul_f32 v[108:109], v[108:109], v[240:241] op_sel:[0,0] op_sel_hi:[1,0]
    v_pk_mul_f32 v[110:111], v[110:111], v[240:241] op_sel:[0,0] op_sel_hi:[1,0]
    v_pk_fma_f32 v[112:113], v[36:37], v[14:15], v[112:113] op_sel_hi:[1,0,1] neg_lo:[0,1,0] neg_hi:[0,1,0]
    v_pk_fma_f32 v[114:115], v[38:39], v[14:15], v[114:115] op_sel_hi:[1,0,1] neg_lo:[0,1,0] neg_hi:[0,1,0]
    v_pk_fma_f32 v[116:117], v[40:41], v[14:15], v[116:117] op_sel_hi:[1,0,1] neg_lo:[0,1,0] neg_hi:[0,1,0]
    v_pk_fma_f32 v[118:119], v[42:43], v[14:15], v[118:119] op_sel_hi:[1,0,1] neg_lo:[0,1,0] neg_hi:[0,1,0]
    v_pk_fma_f32 v[120:121], v[44:45], v[14:15], v[120:121] op_sel_hi:[1,0,1] neg_lo:[0,1,0] neg_hi:[0,1,0]
    v_pk_fma_f32 v[122:123], v[46:47], v[14:15], v[122:123] op_sel_hi:[1,0,1] neg_lo:[0,1,0] neg_hi:[0,1,0]
    v_pk_fma_f32 v[124:125], v[48:49], v[14:15], v[124:125] op_sel_hi:[1,0,1] neg_lo:[0,1,0] neg_hi:[0,1,0]
    v_pk_fma_f32 v[126:127], v[50:51], v[14:15], v[126:127] op_sel_hi:[1,0,1] neg_lo:[0,1,0] neg_hi:[0,1,0]
    v_pk_mul_f32 v[112:113], v[112:113], v[242:243] op_sel:[0,0] op_sel_hi:[1,0]
    v_pk_mul_f32 v[114:115], v[114:115], v[242:243] op_sel:[0,0] op_sel_hi:[1,0]
    v_pk_mul_f32 v[116:117], v[116:117], v[242:243] op_sel:[0,0] op_sel_hi:[1,0]
    v_pk_mul_f32 v[118:119], v[118:119], v[242:243] op_sel:[0,0] op_sel_hi:[1,0]
    v_pk_mul_f32 v[120:121], v[120:121], v[242:243] op_sel:[0,0] op_sel_hi:[1,0]
    v_pk_mul_f32 v[122:123], v[122:123], v[242:243] op_sel:[0,0] op_sel_hi:[1,0]
    v_pk_mul_f32 v[124:125], v[124:125], v[242:243] op_sel:[0,0] op_sel_hi:[1,0]
    v_pk_mul_f32 v[126:127], v[126:127], v[242:243] op_sel:[0,0] op_sel_hi:[1,0]
    v_cvt_pk_bf16_f32 v96, v96, v97
    v_cvt_pk_bf16_f32 v97, v98, v99
    v_cvt_pk_bf16_f32 v98, v112, v113
    v_cvt_pk_bf16_f32 v99, v114, v115
    buffer_store_dwordx4 v[96:99], v2, s[16:19], s36 offen offset:0 sc1
    v_cvt_pk_bf16_f32 v100, v100, v101
    v_cvt_pk_bf16_f32 v101, v102, v103
    v_cvt_pk_bf16_f32 v102, v116, v117
    v_cvt_pk_bf16_f32 v103, v118, v119
    buffer_store_dwordx4 v[100:103], v2, s[16:19], s36 offen offset:1024 sc1
    v_cvt_pk_bf16_f32 v104, v104, v105
    v_cvt_pk_bf16_f32 v105, v106, v107
    v_cvt_pk_bf16_f32 v106, v120, v121
    v_cvt_pk_bf16_f32 v107, v122, v123
    buffer_store_dwordx4 v[104:107], v2, s[16:19], s36 offen offset:2048 sc1
    v_cvt_pk_bf16_f32 v108, v108, v109
    v_cvt_pk_bf16_f32 v109, v110, v111
    v_cvt_pk_bf16_f32 v110, v124, v125
    v_cvt_pk_bf16_f32 v111, v126, v127
    buffer_store_dwordx4 v[108:111], v2, s[16:19], s36 offen offset:3072 sc1
    s_add_u32 s36, s36, 4096
    s_cmp_lg_u32 s80, 0
    s_cbranch_scc1 q_kv
    ds_read_b128 v[36:39], v9 offset:256
    ds_read_b128 v[40:43], v9 offset:288
    ds_read_b128 v[44:47], v9 offset:320
    ds_read_b128 v[48:51], v9 offset:352
    v_pk_fma_f32 v[128:129], v[16:17], v[12:13], v[128:129] op_sel_hi:[1,0,1] neg_lo:[0,1,0] neg_hi:[0,1,0]
    v_pk_fma_f32 v[130:131], v[18:19], v[12:13], v[130:131] op_sel_hi:[1,0,1] neg_lo:[0,1,0] neg_hi:[0,1,0]
    v_pk_fma_f32 v[132:133], v[20:21], v[12:13], v[132:133] op_sel_hi:[1,0,1] neg_lo:[0,1,0] neg_hi:[0,1,0]
    v_pk_fma_f32 v[134:135], v[22:23], v[12:13], v[134:135] op_sel_hi:[1,0,1] neg_lo:[0,1,0] neg_hi:[0,1,0]
    v_pk_fma_f32 v[136:137], v[24:25], v[12:13], v[136:137] op_sel_hi:[1,0,1] neg_lo:[0,1,0] neg_hi:[0,1,0]
    v_pk_fma_f32 v[138:139], v[26:27], v[12:13], v[138:139] op_sel_hi:[1,0,1] neg_lo:[0,1,0] neg_hi:[0,1,0]
    v_pk_fma_f32 v[140:141], v[28:29], v[12:13], v[140:141] op_sel_hi:[1,0,1] neg_lo:[0,1,0] neg_hi:[0,1,0]
    v_pk_fma_f32 v[142:143], v[30:31], v[12:13], v[142:143] op_sel_hi:[1,0,1] neg_lo:[0,1,0] neg_hi:[0,1,0]
    v_pk_mul_f32 v[128:129], v[128:129], v[240:241] op_sel:[0,0] op_sel_hi:[1,0]
    v_pk_mul_f32 v[130:131], v[130:131], v[240:241] op_sel:[0,0] op_sel_hi:[1,0]
    v_pk_mul_f32 v[132:133], v[132:133], v[240:241] op_sel:[0,0] op_sel_hi:[1,0]
    v_pk_mul_f32 v[134:135], v[134:135], v[240:241] op_sel:[0,0] op_sel_hi:[1,0]
    v_pk_mul_f32 v[136:137], v[136:137], v[240:241] op_sel:[0,0] op_sel_hi:[1,0]
    v_pk_mul_f32 v[138:139], v[138:139], v[240:241] op_sel:[0,0] op_sel_hi:[1,0]
    v_pk_mul_f32 v[140:141], v[140:141], v[240:241] op_sel:[0,0] op_sel_hi:[1,0]
    v_pk_mul_f32 v[142:143], v[142:143], v[240:241] op_sel:[0,0] op_sel_hi:[1,0]
    v_pk_fma_f32 v[144:145], v[16:17], v[14:15], v[144:145] op_sel_hi:[1,0,1] neg_lo:[0,1,0] neg_hi:[0,1,0]
    v_pk_fma_f32 v[146:147], v[18:19], v[14:15], v[146:147] op_sel_hi:[1,0,1] neg_lo:[0,1,0] neg_hi:[0,1,0]
    v_pk_fma_f32 v[148:149], v[20:21], v[14:15], v[148:149] op_sel_hi:[1,0,1] neg_lo:[0,1,0] neg_hi:[0,1,0]
    v_pk_fma_f32 v[150:151], v[22:23], v[14:15], v[150:151] op_sel_hi:[1,0,1] neg_lo:[0,1,0] neg_hi:[0,1,0]
    v_pk_fma_f32 v[152:153], v[24:25], v[14:15], v[152:153] op_sel_hi:[1,0,1] neg_lo:[0,1,0] neg_hi:[0,1,0]
    v_pk_fma_f32 v[154:155], v[26:27], v[14:15], v[154:155] op_sel_hi:[1,0,1] neg_lo:[0,1,0] neg_hi:[0,1,0]
    v_pk_fma_f32 v[156:157], v[28:29], v[14:15], v[156:157] op_sel_hi:[1,0,1] neg_lo:[0,1,0] neg_hi:[0,1,0]
    v_pk_fma_f32 v[158:159], v[30:31], v[14:15], v[158:159] op_sel_hi:[1,0,1] neg_lo:[0,1,0] neg_hi:[0,1,0]
    v_pk_mul_f32 v[144:145], v[144:145], v[242:243] op_sel:[0,0] op_sel_hi:[1,0]
    v_pk_mul_f32 v[146:147], v[146:147], v[242:243] op_sel:[0,0] op_sel_hi:[1,0]
    v_pk_mul_f32 v[148:149], v[148:149], v[242:243] op_sel:[0,0] op_sel_hi:[1,0]
    v_pk_mul_f32 v[150:151], v[150:151], v[242:243] op_sel:[0,0] op_sel_hi:[1,0]
    v_pk_mul_f32 v[152:153], v[152:153], v[242:243] op_sel:[0,0] op_sel_hi:[1,0]
    v_pk_mul_f32 v[154:155], v[154:155], v[242:243] op_sel:[0,0] op_sel_hi:[1,0]
    v_pk_mul_f32 v[156:157], v[156:157], v[242:243] op_sel:[0,0] op_sel_hi:[1,0]
    v_pk_mul_f32 v[158:159], v[158:159], v[242:243] op_sel:[0,0] op_sel_hi:[1,0]
    v_cvt_pk_bf16_f32 v128, v128, v129
    v_cvt_pk_bf16_f32 v129, v130, v131
    v_cvt_pk_bf16_f32 v130, v144, v145
    v_cvt_pk_bf16_f32 v131, v146, v147
    buffer_store_dwordx4 v[128:131], v2, s[16:19], s36 offen offset:0 sc1
    v_cvt_pk_bf16_f32 v132, v132, v133
    v_cvt_pk_bf16_f32 v133, v134, v135
    v_cvt_pk_bf16_f32 v134, v148, v149
    v_cvt_pk_bf16_f32 v135, v150, v151
    buffer_store_dwordx4 v[132:135], v2, s[16:19], s36 offen offset:1024 sc1
    v_cvt_pk_bf16_f32 v136, v136, v137
    v_cvt_pk_bf16_f32 v137, v138, v139
    v_cvt_pk_bf16_f32 v138, v152, v153
    v_cvt_pk_bf16_f32 v139, v154, v155
    buffer_store_dwordx4 v[136:139], v2, s[16:19], s36 offen offset:2048 sc1
    v_cvt_pk_bf16_f32 v140, v140, v141
    v_cvt_pk_bf16_f32 v141, v142, v143
    v_cvt_pk_bf16_f32 v142, v156, v157
    v_cvt_pk_bf16_f32 v143, v158, v159
    buffer_store_dwordx4 v[140:143], v2, s[16:19], s36 offen offset:3072 sc1
    s_add_u32 s36, s36, 4096
    s_waitcnt lgkmcnt(0)
    v_pk_fma_f32 v[160:161], v[36:37], v[12:13], v[160:161] op_sel_hi:[1,0,1] neg_lo:[0,1,0] neg_hi:[0,1,0]
    v_pk_fma_f32 v[162:163], v[38:39], v[12:13], v[162:163] op_sel_hi:[1,0,1] neg_lo:[0,1,0] neg_hi:[0,1,0]
    v_pk_fma_f32 v[164:165], v[40:41], v[12:13], v[164:165] op_sel_hi:[1,0,1] neg_lo:[0,1,0] neg_hi:[0,1,0]
    v_pk_fma_f32 v[166:167], v[42:43], v[12:13], v[166:167] op_sel_hi:[1,0,1] neg_lo:[0,1,0] neg_hi:[0,1,0]
    v_pk_fma_f32 v[168:169], v[44:45], v[12:13], v[168:169] op_sel_hi:[1,0,1] neg_lo:[0,1,0] neg_hi:[0,1,0]
    v_pk_fma_f32 v[170:171], v[46:47], v[12:13], v[170:171] op_sel_hi:[1,0,1] neg_lo:[0,1,0] neg_hi:[0,1,0]
    v_pk_fma_f32 v[172:173], v[48:49], v[12:13], v[172:173] op_sel_hi:[1,0,1] neg_lo:[0,1,0] neg_hi:[0,1,0]
    v_pk_fma_f32 v[174:175], v[50:51], v[12:13], v[174:175] op_sel_hi:[1,0,1] neg_lo:[0,1,0] neg_hi:[0,1,0]
    v_pk_mul_f32 v[160:161], v[160:161], v[240:241] op_sel:[0,0] op_sel_hi:[1,0]
    v_pk_mul_f32 v[162:163], v[162:163], v[240:241] op_sel:[0,0] op_sel_hi:[1,0]
    v_pk_mul_f32 v[164:165], v[164:165], v[240:241] op_sel:[0,0] op_sel_hi:[1,0]
    v_pk_mul_f32 v[166:167], v[166:167], v[240:241] op_sel:[0,0] op_sel_hi:[1,0]
    v_pk_mul_f32 v[168:169], v[168:169], v[240:241] op_sel:[0,0] op_sel_hi:[1,0]
    v_pk_mul_f32 v[170:171], v[170:171], v[240:241] op_sel:[0,0] op_sel_hi:[1,0]
    v_pk_mul_f32 v[172:173], v[172:173], v[240:241] op_sel:[0,0] op_sel_hi:[1,0]
    v_pk_mul_f32 v[174:175], v[174:175], v[240:241] op_sel:[0,0] op_sel_hi:[1,0]
    v_pk_fma_f32 v[176:177], v[36:37], v[14:15], v[176:177] op_sel_hi:[1,0,1] neg_lo:[0,1,0] neg_hi:[0,1,0]
    v_pk_fma_f32 v[178:179], v[38:39], v[14:15], v[178:179] op_sel_hi:[1,0,1] neg_lo:[0,1,0] neg_hi:[0,1,0]
    v_pk_fma_f32 v[180:181], v[40:41], v[14:15], v[180:181] op_sel_hi:[1,0,1] neg_lo:[0,1,0] neg_hi:[0,1,0]
    v_pk_fma_f32 v[182:183], v[42:43], v[14:15], v[182:183] op_sel_hi:[1,0,1] neg_lo:[0,1,0] neg_hi:[0,1,0]
    v_pk_fma_f32 v[184:185], v[44:45], v[14:15], v[184:185] op_sel_hi:[1,0,1] neg_lo:[0,1,0] neg_hi:[0,1,0]
    v_pk_fma_f32 v[186:187], v[46:47], v[14:15], v[186:187] op_sel_hi:[1,0,1] neg_lo:[0,1,0] neg_hi:[0,1,0]
    v_pk_fma_f32 v[188:189], v[48:49], v[14:15], v[188:189] op_sel_hi:[1,0,1] neg_lo:[0,1,0] neg_hi:[0,1,0]
    v_pk_fma_f32 v[190:191], v[50:51], v[14:15], v[190:191] op_sel_hi:[1,0,1] neg_lo:[0,1,0] neg_hi:[0,1,0]
    v_pk_mul_f32 v[176:177], v[176:177], v[242:243] op_sel:[0,0] op_sel_hi:[1,0]
    v_pk_mul_f32 v[178:179], v[178:179], v[242:243] op_sel:[0,0] op_sel_hi:[1,0]
    v_pk_mul_f32 v[180:181], v[180:181], v[242:243] op_sel:[0,0] op_sel_hi:[1,0]
    v_pk_mul_f32 v[182:183], v[182:183], v[242:243] op_sel:[0,0] op_sel_hi:[1,0]
    v_pk_mul_f32 v[184:185], v[184:185], v[242:243] op_sel:[0,0] op_sel_hi:[1,0]
    v_pk_mul_f32 v[186:187], v[186:187], v[242:243] op_sel:[0,0] op_sel_hi:[1,0]
    v_pk_mul_f32 v[188:189], v[188:189], v[242:243] op_sel:[0,0] op_sel_hi:[1,0]
    v_pk_mul_f32 v[190:191], v[190:191], v[242:243] op_sel:[0,0] op_sel_hi:[1,0]
    v_cvt_pk_bf16_f32 v160, v160, v161
    v_cvt_pk_bf16_f32 v161, v162, v163
    v_cvt_pk_bf16_f32 v162, v176, v177
    v_cvt_pk_bf16_f32 v163, v178, v179
    buffer_store_dwordx4 v[160:163], v2, s[16:19], s36 offen offset:0 sc1
    v_cvt_pk_bf16_f32 v164, v164, v165
    v_cvt_pk_bf16_f32 v165, v166, v167
    v_cvt_pk_bf16_f32 v166, v180, v181
    v_cvt_pk_bf16_f32 v167, v182, v183
    buffer_store_dwordx4 v[164:167], v2, s[16:19], s36 offen offset:1024 sc1
    v_cvt_pk_bf16_f32 v168, v168, v169
    v_cvt_pk_bf16_f32 v169, v170, v171
    v_cvt_pk_bf16_f32 v170, v184, v185
    v_cvt_pk_bf16_f32 v171, v186, v187
    buffer_store_dwordx4 v[168:171], v2, s[16:19], s36 offen offset:2048 sc1
    v_cvt_pk_bf16_f32 v172, v172, v173
    v_cvt_pk_bf16_f32 v173, v174, v175
    v_cvt_pk_bf16_f32 v174, v188, v189
    v_cvt_pk_bf16_f32 v175, v190, v191
    buffer_store_dwordx4 v[172:175], v2, s[16:19], s36 offen offset:3072 sc1
    s_add_u32 s36, s36, 4096
    s_branch q_done
q_kv:
    v_pk_fma_f32 v[128:129], v[16:17], v[12:13], v[128:129] op_sel_hi:[1,0,1] neg_lo:[0,1,0] neg_hi:[0,1,0]
    v_pk_fma_f32 v[130:131], v[18:19], v[12:13], v[130:131] op_sel_hi:[1,0,1] neg_lo:[0,1,0] neg_hi:[0,1,0]
    v_pk_fma_f32 v[132:133], v[20:21], v[12:13], v[132:133] op_sel_hi:[1,0,1] neg_lo:[0,1,0] neg_hi:[0,1,0]
    v_pk_fma_f32 v[134:135], v[22:23], v[12:13], v[134:135] op_sel_hi:[1,0,1] neg_lo:[0,1,0] neg_hi:[0,1,0]
    v_pk_fma_f32 v[136:137], v[24:25], v[12:13], v[136:137] op_sel_hi:[1,0,1] neg_lo:[0,1,0] neg_hi:[0,1,0]
    v_pk_fma_f32 v[138:139], v[26:27], v[12:13], v[138:139] op_sel_hi:[1,0,1] neg_lo:[0,1,0] neg_hi:[0,1,0]
    v_pk_fma_f32 v[140:141], v[28:29], v[12:13], v[140:141] op_sel_hi:[1,0,1] neg_lo:[0,1,0] neg_hi:[0,1,0]
    v_pk_fma_f32 v[142:143], v[30:31], v[12:13], v[142:143] op_sel_hi:[1,0,1] neg_lo:[0,1,0] neg_hi:[0,1,0]
    v_pk_mul_f32 v[128:129], v[128:129], v[240:241] op_sel:[0,1] op_sel_hi:[1,1]
    v_pk_mul_f32 v[130:131], v[130:131], v[240:241] op_sel:[0,1] op_sel_hi:[1,1]
    v_pk_mul_f32 v[132:133], v[132:133], v[240:241] op_sel:[0,1] op_sel_hi:[1,1]
    v_pk_mul_f32 v[134:135], v[134:135], v[240:241] op_sel:[0,1] op_sel_hi:[1,1]
    v_pk_mul_f32 v[136:137], v[136:137], v[240:241] op_sel:[0,1] op_sel_hi:[1,1]
    v_pk_mul_f32 v[138:139], v[138:139], v[240:241] op_sel:[0,1] op_sel_hi:[1,1]
    v_pk_mul_f32 v[140:141], v[140:141], v[240:241] op_sel:[0,1] op_sel_hi:[1,1]
    v_pk_mul_f32 v[142:143], v[142:143], v[240:241] op_sel:[0,1] op_sel_hi:[1,1]
    v_pk_fma_f32 v[144:145], v[16:17], v[14:15], v[144:145] op_sel_hi:[1,0,1] neg_lo:[0,1,0] neg_hi:[0,1,0]
    v_pk_fma_f32 v[146:147], v[18:19], v[14:15], v[146:147] op_sel_hi:[1,0,1] neg_lo:[0,1,0] neg_hi:[0,1,0]
    v_pk_fma_f32 v[148:149], v[20:21], v[14:15], v[148:149] op_sel_hi:[1,0,1] neg_lo:[0,1,0] neg_hi:[0,1,0]
    v_pk_fma_f32 v[150:151], v[22:23], v[14:15], v[150:151] op_sel_hi:[1,0,1] neg_lo:[0,1,0] neg_hi:[0,1,0]
    v_pk_fma_f32 v[152:153], v[24:25], v[14:15], v[152:153] op_sel_hi:[1,0,1] neg_lo:[0,1,0] neg_hi:[0,1,0]
    v_pk_fma_f32 v[154:155], v[26:27], v[14:15], v[154:155] op_sel_hi:[1,0,1] neg_lo:[0,1,0] neg_hi:[0,1,0]
    v_pk_fma_f32 v[156:157], v[28:29], v[14:15], v[156:157] op_sel_hi:[1,0,1] neg_lo:[0,1,0] neg_hi:[0,1,0]
    v_pk_fma_f32 v[158:159], v[30:31], v[14:15], v[158:159] op_sel_hi:[1,0,1] neg_lo:[0,1,0] neg_hi:[0,1,0]
    v_pk_mul_f32 v[144:145], v[144:145], v[242:243] op_sel:[0,1] op_sel_hi:[1,1]
    v_pk_mul_f32 v[146:147], v[146:147], v[242:243] op_sel:[0,1] op_sel_hi:[1,1]
    v_pk_mul_f32 v[148:149], v[148:149], v[242:243] op_sel:[0,1] op_sel_hi:[1,1]
    v_pk_mul_f32 v[150:151], v[150:151], v[242:243] op_sel:[0,1] op_sel_hi:[1,1]
    v_pk_mul_f32 v[152:153], v[152:153], v[242:243] op_sel:[0,1] op_sel_hi:[1,1]
    v_pk_mul_f32 v[154:155], v[154:155], v[242:243] op_sel:[0,1] op_sel_hi:[1,1]
    v_pk_mul_f32 v[156:157], v[156:157], v[242:243] op_sel:[0,1] op_sel_hi:[1,1]
    v_pk_mul_f32 v[158:159], v[158:159], v[242:243] op_sel:[0,1] op_sel_hi:[1,1]
    v_cvt_pk_bf16_f32 v128, v128, v129
    v_cvt_pk_bf16_f32 v129, v130, v131
    v_cvt_pk_bf16_f32 v130, v132, v133
    v_cvt_pk_bf16_f32 v131, v134, v135
    v_cvt_pk_bf16_f32 v132, v136, v137
    v_cvt_pk_bf16_f32 v133, v138, v139
    v_cvt_pk_bf16_f32 v134, v140, v141
    v_cvt_pk_bf16_f32 v135, v142, v143
    v_cvt_pk_bf16_f32 v144, v144, v145
    v_cvt_pk_bf16_f32 v145, v146, v147
    v_cvt_pk_bf16_f32 v146, v148, v149
    v_cvt_pk_bf16_f32 v147, v150, v151
    v_cvt_pk_bf16_f32 v148, v152, v153
    v_cvt_pk_bf16_f32 v149, v154, v155
    v_cvt_pk_bf16_f32 v150, v156, v157
    v_cvt_pk_bf16_f32 v151, v158, v159
    v_cmp_gt_u32 vcc, 32, v1
    s_cmp_eq_u32 s30, 3
    s_cbranch_scc1 q_v
    v_mov_b32 v6, 0x3f803f80
    v_mov_b32 v7, 0x00003f80
    s_mul_i32 s36, s77, 3072
    s_add_u32 s36, s36, 3145728
    v_cndmask_b32 v132, v6, v132, vcc
    v_cndmask_b32 v133, v7, v133, vcc
    buffer_store_dwordx4 v[128:131], v2, s[16:19], s36 offen offset:0 sc1
    buffer_store_dwordx2 v[132:133], v3, s[16:19], s36 offen offset:1024 sc1
    v_cndmask_b32 v148, v6, v148, vcc
    v_cndmask_b32 v149, v7, v149, vcc
    buffer_store_dwordx4 v[144:147], v2, s[16:19], s36 offen offset:1536 sc1
    buffer_store_dwordx2 v[148:149], v3, s[16:19], s36 offen offset:2560 sc1
    s_branch q_done
q_v:
    v_mov_b32 v8, 0x00003f80
    s_lshl_b32 s36, s64, 12
    s_add_u32 s36, s36, 149504
    v_and_b32 v6, 31, v1
    v_lshlrev_b32 v6, 6, v6
    v_lshrrev_b32 v7, 5, v1
    v_lshl_add_u32 v6, v7, 3, v6
    v_add_u32 v6, s36, v6
    v_cndmask_b32 v132, v8, v132, vcc
    v_cndmask_b32 v133, 0, v133, vcc
    v_mov_b64 v[134:135], 0
    ds_write_b64 v6, v[128:129] offset:0
    ds_write_b64 v6, v[130:131] offset:16
    ds_write_b64 v6, v[132:133] offset:32
    ds_write_b64 v6, v[134:135] offset:48
    v_cndmask_b32 v148, v8, v148, vcc
    v_cndmask_b32 v149, 0, v149, vcc
    v_mov_b64 v[150:151], 0
    ds_write_b64 v6, v[144:145] offset:2048
    ds_write_b64 v6, v[146:147] offset:2064
    ds_write_b64 v6, v[148:149] offset:2080
    ds_write_b64 v6, v[150:151] offset:2096
    v_bfe_u32 v6, v1, 2, 2
    v_lshl_add_u32 v6, v7, 3, v6
    v_lshlrev_b32 v6, 6, v6
    v_bfe_u32 v7, v1, 4, 1
    v_lshl_add_u32 v6, v7, 5, v6
    v_and_b32 v7, 3, v1
    v_lshl_add_u32 v6, v7, 3, v6
    v_add_u32 v6, s36, v6
    s_waitcnt lgkmcnt(0)
    ds_read_b64_tr_b16 v[160:161], v6 offset:0
    ds_read_b64_tr_b16 v[162:163], v6 offset:256
    ds_read_b64_tr_b16 v[164:165], v6 offset:1024
    ds_read_b64_tr_b16 v[166:167], v6 offset:1280
    ds_read_b64_tr_b16 v[168:169], v6 offset:2048
    ds_read_b64_tr_b16 v[170:171], v6 offset:2304
    ds_read_b64_tr_b16 v[172:173], v6 offset:3072
    ds_read_b64_tr_b16 v[174:175], v6 offset:3328
    s_lshl_b32 s36, s77, 12
    s_add_u32 s36, s36, 3276800
    s_waitcnt lgkmcnt(0)
    buffer_store_dwordx4 v[160:163], v2, s[16:19], s36 offen offset:0 sc1
    buffer_store_dwordx4 v[164:167], v2, s[16:19], s36 offen offset:1024 sc1
    buffer_store_dwordx4 v[168:171], v2, s[16:19], s36 offen offset:2048 sc1
    buffer_store_dwordx4 v[172:175], v2, s[16:19], s36 offen offset:3072 sc1
q_done:
    v_mov_b32 v6, 159752
    v_mov_b32 v7, 1
    s_waitcnt vmcnt(0)
    s_mov_b64 exec, 1
    ds_add_rtn_u32 v7, v6, v7
    s_waitcnt lgkmcnt(0)
    v_readfirstlane_b32 s36, v7
    s_mov_b64 exec, -1
    s_nop 3
    s_cmp_lg_u32 s36, 3
    s_cbranch_scc1 q_nosig
    v_mov_b32 v8, 0
    v_mov_b32 v9, 1
    s_mov_b64 exec, 1
    buffer_store_dword v9, v8, s[16:19], s67 offen sc1
    s_mov_b64 exec, -1
q_nosig:
    s_mov_b32 s33, 1073741824
    s_mov_b32 s34, 1073741824
attn_start:
    s_mul_i32 s38, s79, 81920
    s_lshl_b32 s39, s73, 1
    s_add_u32 s39, s39, s72
    s_mul_i32 s39, s39, 5120
    s_add_u32 s38, s38, s39
    s_lshl_b32 s39, s74, 1
    s_add_u32 s39, s39, 1
    s_sub_u32 s39, s39, s72
    s_mul_i32 s75, s39, 12288
    s_add_u32 s75, s75, 3145728
    s_add_u32 s81, s75, 3072
    s_lshl_b32 s76, s39, 14
    s_add_u32 s76, s76, 3276800
    s_add_u32 s82, s76, 4096
    s_add_u32 s39, s74, 0
    s_and_b32 s83, s39, 1
    s_lshl_b32 s83, s83, 3
    s_bfe_u32 s39, s39, 0x10001
    s_mul_i32 s39, s39, 2560
    s_add_u32 s39, s39, s83
    s_add_u32 s88, s39, s38
    s_add_u32 s39, s74, 1
    s_and_b32 s83, s39, 1
    s_lshl_b32 s83, s83, 3
    s_bfe_u32 s39, s39, 0x10001
    s_mul_i32 s39, s39, 2560
    s_add_u32 s39, s39, s83
    s_add_u32 s89, s39, s38
    s_add_u32 s39, s74, 2
    s_and_b32 s83, s39, 1
    s_lshl_b32 s83, s83, 3
    s_bfe_u32 s39, s39, 0x10001
    s_mul_i32 s39, s39, 2560
    s_add_u32 s39, s39, s83
    s_add_u32 s90, s39, s38
    s_add_u32 s39, s74, 3
    s_and_b32 s83, s39, 1
    s_lshl_b32 s83, s83, 3
    s_bfe_u32 s39, s39, 0x10001
    s_mul_i32 s39, s39, 2560
    s_add_u32 s39, s39, s83
    s_add_u32 s91, s39, s38
    s_lshl_b32 s36, s79, 1
    s_and_b32 s37, s74, 1
    s_add_u32 s36, s36, s37
    s_mul_i32 s36, s36, 136
    s_mul_i32 s37, s72, 20
    s_add_u32 s36, s36, s37
    s_lshl_b32 s36, s36, 10
    s_add_u32 s36, s36, 4292608
    s_lshr_b32 s39, s74, 1
    s_lshl_b32 s37, s73, 1
    s_add_u32 s37, s37, s39
    s_lshl_b32 s37, s37, 10
    s_add_u32 s37, s37, s36
    s_lshl_b32 s83, s73, 9
    s_add_u32 s36, s36, s83
    s_lshl_b32 s39, s39, 3
    s_add_u32 s36, s36, s39
    s_add_u32 s36, s36, 16384
    v_mov_b64 v[248:249], -1
    v_mov_b64 v[250:251], -1
    s_mov_b32 s92, s36
    s_mov_b32 s93, s37
    v_mov_b64 v[160:161], 0
    v_mov_b64 v[162:163], 0
    v_mov_b64 v[164:165], 0
    v_mov_b64 v[166:167], 0
    v_mov_b64 v[168:169], 0
    v_mov_b64 v[170:171], 0
    v_mov_b64 v[172:173], 0
    v_mov_b64 v[174:175], 0
    v_mov_b64 v[176:177], 0
    v_mov_b64 v[178:179], 0
    v_mov_b64 v[180:181], 0
    v_mov_b64 v[182:183], 0
    v_mov_b64 v[184:185], 0
    v_mov_b64 v[186:187], 0
    v_mov_b64 v[188:189], 0
    v_mov_b64 v[190:191], 0
    v_mov_b64 v[192:193], 0
    v_mov_b64 v[194:195], 0
    v_mov_b64 v[196:197], 0
    v_mov_b64 v[198:199], 0
    v_mov_b64 v[200:201], 0
    v_mov_b64 v[202:203], 0
    v_mov_b64 v[204:205], 0
    v_mov_b64 v[206:207], 0
    v_mov_b64 v[208:209], 0
    v_mov_b64 v[210:211], 0
    v_mov_b64 v[212:213], 0
    v_mov_b64 v[214:215], 0
    v_mov_b64 v[216:217], 0
    v_mov_b64 v[218:219], 0
    v_mov_b64 v[220:221], 0
    v_mov_b64 v[222:223], 0
    v_mov_b64 v[32:33], 0
    s_lshl_b32 s80, s74, 2
    s_add_u32 s80, s80, 159776
    s_mul_i32 s36, s74, 28672
    v_add_u32 v240, s36, v2
    v_add_u32 v241, s36, v3
    v_and_b32 v9, 0xff, v3
    s_lshl_b32 s36, s72, 10
    s_add_u32 s36, s36, 157696
    s_add_u32 s37, s74, 0
    s_and_b32 s37, s37, 3
    s_lshl_b32 s37, s37, 8
    s_add_u32 s37, s37, s36
    v_add_u32 v244, s37, v9
    s_add_u32 s37, s74, 1
    s_and_b32 s37, s37, 3
    s_lshl_b32 s37, s37, 8
    s_add_u32 s37, s37, s36
    v_add_u32 v245, s37, v9
    s_add_u32 s37, s74, 2
    s_and_b32 s37, s37, 3
    s_lshl_b32 s37, s37, 8
    s_add_u32 s37, s37, s36
    v_add_u32 v246, s37, v9
    s_add_u32 s37, s74, 3
    s_and_b32 s37, s37, 3
    s_lshl_b32 s37, s37, 8
    s_add_u32 s37, s37, s36
    v_add_u32 v247, s37, v9
    v_lshrrev_b32 v242, 5, v1
    v_lshlrev_b32 v242, 4, v242
    v_bfe_u32 v7, v1, 2, 3
    v_add_u32 v242, v242, v7
    v_lshlrev_b32 v242, 7, v242
    v_and_b32 v7, 3, v1
    v_lshl_add_u32 v242, v7, 3, v242
    s_lshl_b32 s83, s74, 12
    s_add_u32 s83, s83, 114688
    v_add_u32 v242, s83, v242
    s_mul_i32 s36, s94, 6554
    s_lshr_b32 s36, s36, 16
    s_mul_i32 s37, s36, 10
    s_sub_u32 s37, s94, s37
    s_lshl_b32 s37, s37, 2
    s_mul_i32 s36, s36, 5
    s_add_u32 s38, s37, 0
    s_mul_i32 s39, s38, 13108
    s_lshr_b32 s39, s39, 16
    s_mul_i32 s39, s39, 335
    s_add_u32 s39, s39, s38
    s_add_u32 s39, s39, s36
    s_lshl_b32 s39, s39, 10
    s_add_u32 s39, s39, 13631488
    s_cmp_ge_u32 s94, 680
    s_cselect_b32 s64, 1073741824, s39
    s_add_u32 s38, s37, 1
    s_mul_i32 s39, s38, 13108
    s_lshr_b32 s39, s39, 16
    s_mul_i32 s39, s39, 335
    s_add_u32 s39, s39, s38
    s_add_u32 s39, s39, s36
    s_lshl_b32 s39, s39, 10
    s_add_u32 s39, s39, 13631488
    s_cmp_ge_u32 s94, 680
    s_cselect_b32 s65, 1073741824, s39
    s_add_u32 s38, s37, 2
    s_mul_i32 s39, s38, 13108
    s_lshr_b32 s39, s39, 16
    s_mul_i32 s39, s39, 335
    s_add_u32 s39, s39, s38
    s_add_u32 s39, s39, s36
    s_lshl_b32 s39, s39, 10
    s_add_u32 s39, s39, 13631488
    s_cmp_ge_u32 s94, 680
    s_cselect_b32 s66, 1073741824, s39
    s_add_u32 s38, s37, 3
    s_mul_i32 s39, s38, 13108
    s_lshr_b32 s39, s39, 16
    s_mul_i32 s39, s39, 335
    s_add_u32 s39, s39, s38
    s_add_u32 s39, s39, s36
    s_lshl_b32 s39, s39, 10
    s_add_u32 s39, s39, 13631488
    s_cmp_ge_u32 s94, 680
    s_cselect_b32 s69, 1073741824, s39
    s_lshl_b32 s77, s72, 2
    s_add_u32 s77, s77, 159760
    s_cmp_lg_u32 s28, 0
    s_cbranch_scc1 w0_49
    buffer_load_dword v11, v5, s[16:19], 0 offen sc1
    s_waitcnt vmcnt(0)
    v_cmp_le_u32 vcc, 1, v11
    s_mov_b32 s78, 0
    s_cmp_eq_u64 vcc, exec
    s_cbranch_scc1 poll_ok_50
poll_lp_51:
    s_sleep 4
    buffer_load_dword v11, v5, s[16:19], 0 offen sc1
    s_add_u32 s78, s78, 1
    s_cmp_gt_u32 s78, 0x8000
    s_cbranch_scc1 poll_ok_50
    s_waitcnt vmcnt(0)
    v_cmp_le_u32 vcc, 1, v11
    s_nop 0
    s_cmp_eq_u64 vcc, exec
    s_cbranch_scc0 poll_lp_51
poll_ok_50:
    v_mov_b32 v6, 159792
    v_mov_b32 v7, 1
    ds_write_b32 v6, v7
w0_49:
    s_mov_b32 s38, 159792
    v_mov_b32 v6, s38
    s_mov_b32 s78, 0
lsp_52:
    ds_read_b32 v7, v6
    s_add_u32 s78, s78, 1
    s_waitcnt lgkmcnt(0)
    v_readfirstlane_b32 s83, v7
    s_cmp_gt_u32 s78, 0x40000
    s_cbranch_scc1 lso_53
    s_cmp_ge_u32 s83, 1
    s_cbranch_scc1 lso_53
    s_sleep 1
    s_branch lsp_52
lso_53:
    s_setprio 3
    s_cmp_lt_u32 s28, 4
    s_cbranch_scc1 a_nodel
    s_setprio 2
    s_mov_b32 s38, 159760
    v_mov_b32 v6, s38
    s_mov_b32 s78, 0
lsp_54:
    ds_read_b32 v7, v6
    s_add_u32 s78, s78, 1
    s_waitcnt lgkmcnt(0)
    v_readfirstlane_b32 s83, v7
    s_cmp_gt_u32 s78, 0x40000
    s_cbranch_scc1 lso_55
    s_cmp_ge_u32 s83, 1
    s_cbranch_scc1 lso_55
    s_sleep 1
    s_branch lsp_54
lso_55:
a_nodel:
    buffer_load_dwordx2 v[16:17], v2, s[16:19], s88 offen sc1
    buffer_load_dwordx2 v[18:19], v2, s[16:19], s88 offen offset:1024 sc1
    s_mov_b32 exec_hi, 0
    buffer_load_dwordx2 v[32:33], v2, s[16:19], s88 offen offset:2048 sc1
    buffer_load_dwordx2 v[34:35], v2, s[16:19], s89 offen offset:2048 sc1
    buffer_load_dwordx2 v[36:37], v2, s[16:19], s90 offen offset:2048 sc1
    buffer_load_dwordx2 v[38:39], v2, s[16:19], s91 offen offset:2048 sc1
    s_mov_b32 exec_hi, -1
    buffer_load_dwordx4 v[40:43], v2, s[16:19], s75 offen offset:0 sc1
    buffer_load_dwordx2 v[56:57], v3, s[16:19], s75 offen offset:1024 sc1
    buffer_load_dwordx4 v[44:47], v2, s[16:19], s75 offen offset:1536 sc1
    buffer_load_dwordx2 v[58:59], v3, s[16:19], s75 offen offset:2560 sc1
    buffer_load_dwordx4 v[48:51], v2, s[16:19], s81 offen offset:0 sc1
    buffer_load_dwordx2 v[60:61], v3, s[16:19], s81 offen offset:1024 sc1
    buffer_load_dwordx4 v[52:55], v2, s[16:19], s81 offen offset:1536 sc1
    buffer_load_dwordx2 v[62:63], v3, s[16:19], s81 offen offset:2560 sc1
    buffer_load_dwordx2 v[20:21], v2, s[16:19], s89 offen sc1
    buffer_load_dwordx2 v[22:23], v2, s[16:19], s89 offen offset:1024 sc1
    buffer_load_dwordx4 v[64:67], v2, s[16:19], s76 offen offset:0 sc1
    buffer_load_dwordx4 v[68:71], v2, s[16:19], s76 offen offset:1024 sc1
    buffer_load_dwordx2 v[24:25], v2, s[16:19], s90 offen sc1
    buffer_load_dwordx2 v[26:27], v2, s[16:19], s90 offen offset:1024 sc1
    buffer_load_dwordx2 v[28:29], v2, s[16:19], s91 offen sc1
    buffer_load_dwordx2 v[30:31], v2, s[16:19], s91 offen offset:1024 sc1
    buffer_load_dwordx4 v[72:75], v2, s[16:19], s76 offen offset:2048 sc1
    buffer_load_dwordx4 v[76:79], v2, s[16:19], s76 offen offset:3072 sc1
    buffer_load_dwordx4 v[80:83], v2, s[16:19], s82 offen offset:0 sc1
    buffer_load_dwordx4 v[84:87], v2, s[16:19], s82 offen offset:1024 sc1
    s_waitcnt vmcnt(18)
    v_mfma_f32_32x32x16_bf16 v[96:111], v[40:43], v[16:19], 0
    v_mfma_f32_32x32x8_bf16 v[96:111], v[56:57], v[32:33], v[96:111]
    s_waitcnt vmcnt(16)
    v_mfma_f32_32x32x16_bf16 v[112:127], v[44:47], v[16:19], 0
    v_mfma_f32_32x32x8_bf16 v[112:127], v[58:59], v[32:33], v[112:127]
    s_waitcnt vmcnt(14)
    v_mfma_f32_32x32x16_bf16 v[128:143], v[48:51], v[16:19], 0
    v_mfma_f32_32x32x8_bf16 v[128:143], v[60:61], v[32:33], v[128:143]
    s_nop 5
    v_max_f32 v10, v96, v97
    v_max3_f32 v10, v98, v99, v10
    v_max3_f32 v10, v100, v101, v10
    v_max3_f32 v10, v102, v103, v10
    v_max3_f32 v10, v104, v105, v10
    v_max3_f32 v10, v106, v107, v10
    v_max3_f32 v10, v108, v109, v10
    v_max3_f32 v10, v110, v111, v10
    s_waitcnt vmcnt(12)
    v_mfma_f32_32x32x16_bf16 v[144:159], v[52:55], v[16:19], 0
    v_mfma_f32_32x32x8_bf16 v[144:159], v[62:63], v[32:33], v[144:159]
    v_max3_f32 v10, v112, v113, v10
    v_max3_f32 v10, v114, v115, v10
    v_max3_f32 v10, v116, v117, v10
    v_max3_f32 v10, v118, v119, v10
    v_max3_f32 v10, v120, v121, v10
    v_max3_f32 v10, v122, v123, v10
    v_max3_f32 v10, v124, v125, v10
    v_max3_f32 v10, v126, v127, v10
    v_max3_f32 v10, v128, v129, v10
    v_max3_f32 v10, v130, v131, v10
    v_max3_f32 v10, v132, v133, v10
    v_max3_f32 v10, v134, v135, v10
    v_max3_f32 v10, v136, v137, v10
    v_max3_f32 v10, v138, v139, v10
    v_max3_f32 v10, v140, v141, v10
    v_max3_f32 v10, v142, v143, v10
    v_max3_f32 v10, v144, v145, v10
    v_max3_f32 v10, v146, v147, v10
    v_max3_f32 v10, v148, v149, v10
    v_max3_f32 v10, v150, v151, v10
    v_max3_f32 v10, v152, v153, v10
    v_max3_f32 v10, v154, v155, v10
    v_max3_f32 v10, v156, v157, v10
    v_max3_f32 v10, v158, v159, v10
    v_mov_b32 v6, v10
    s_nop 1
    v_permlane32_swap_b32 v10, v6
    s_nop 1
    v_max_f32 v10, v10, v6
    v_add_f32 v10, 0x42a80000, v10
    v_xor_b32 v10, 0x80000000, v10
    v_and_b32 v6, 0xffff0000, v10
    v_sub_f32 v7, v10, v6
    v_and_b32 v8, 0xffff0000, v7
    v_sub_f32 v7, v7, v8
    v_lshrrev_b32 v6, 16, v6
    v_or_b32 v12, v6, v8
    v_lshrrev_b32 v13, 16, v7
    ds_write_b64 v244, v[12:13]
    v_mov_b32 v6, s77
    v_mov_b32 v7, 1
    s_mov_b64 exec, 1
    ds_add_u32 v6, v7
    s_mov_b32 exec_lo, 0
    s_mov_b32 exec_hi, -1
    v_mov_b64 v[32:33], v[12:13]
    s_mov_b32 exec_lo, -1
    s_nop 0
    v_mfma_f32_32x32x16_bf16 v[96:111], v[40:43], v[16:19], 0
    v_mfma_f32_32x32x8_bf16 v[96:111], v[56:57], v[32:33], v[96:111]
    v_mov_b32 v6, s77
    s_mov_b32 s78, 0
lsp_56:
    ds_read_b32 v7, v6
    s_add_u32 s78, s78, 1
    s_waitcnt lgkmcnt(0)
    v_readfirstlane_b32 s83, v7
    s_cmp_gt_u32 s78, 0x40000
    s_cbranch_scc1 lso_57
    s_cmp_ge_u32 s83, 4
    s_cbranch_scc1 lso_57
    s_branch lsp_56
lso_57:
    s_mov_b32 exec_lo, 0
    ds_read_b64 v[34:35], v245
    ds_read_b64 v[36:37], v246
    ds_read_b64 v[38:39], v247
    s_mov_b32 exec_lo, -1
    s_cmp_ge_u32 s28, 4
    s_cbranch_scc1 a_lpre
    s_setprio 1
    s_waitcnt lgkmcnt(0)
    s_waitcnt vmcnt(10)
    v_mfma_f32_32x32x16_bf16 v[112:127], v[40:43], v[20:23], 0
    v_exp_f32 v96, v96
    v_exp_f32 v97, v97
    v_exp_f32 v98, v98
    v_exp_f32 v99, v99
    v_mfma_f32_32x32x8_bf16 v[112:127], v[56:57], v[34:35], v[112:127]
    ds_read_b64_tr_b16 v[244:245], v242 offset:0
    ds_read_b64_tr_b16 v[246:247], v242 offset:1024
    v_exp_f32 v100, v100
    v_exp_f32 v101, v101
    v_exp_f32 v102, v102
    v_exp_f32 v103, v103
    buffer_load_dwordx4 v[88:91], v2, s[16:19], s82 offen offset:2048 sc1
    buffer_load_dwordx4 v[92:95], v2, s[16:19], s82 offen offset:3072 sc1
    v_exp_f32 v104, v104
    v_exp_f32 v105, v105
    v_exp_f32 v106, v106
    v_exp_f32 v107, v107
    s_waitcnt vmcnt(10)
    v_smfmac_f32_32x32x32_bf16 v[160:175], v[64:67], v[96:103], v4
    v_exp_f32 v108, v108
    v_exp_f32 v109, v109
    v_exp_f32 v110, v110
    v_exp_f32 v111, v111
    s_waitcnt vmcnt(8)
    v_mfma_f32_32x32x16_bf16 v[128:143], v[40:43], v[24:27], 0
    v_exp_f32 v112, v112
    v_exp_f32 v113, v113
    v_exp_f32 v114, v114
    v_exp_f32 v115, v115
    v_mfma_f32_32x32x8_bf16 v[128:143], v[56:57], v[36:37], v[128:143]
    ds_write_b128 v240, v[40:43] offset:0
    ds_write_b64 v241, v[56:57] offset:1024
    s_waitcnt lgkmcnt(0)
    buffer_store_dwordx4 v[244:247], v2, s[16:19], s64 offen sc1
    v_exp_f32 v116, v116
    v_exp_f32 v117, v117
    v_exp_f32 v118, v118
    v_exp_f32 v119, v119
    v_smfmac_f32_32x32x32_bf16 v[160:175], v[68:71], v[104:111], v4
    v_exp_f32 v120, v120
    v_exp_f32 v121, v121
    v_exp_f32 v122, v122
    v_exp_f32 v123, v123
    v_smfmac_f32_32x32x32_bf16 v[176:191], v[64:67], v[112:119], v4
    v_exp_f32 v124, v124
    v_exp_f32 v125, v125
    v_exp_f32 v126, v126
    v_exp_f32 v127, v127
    s_waitcnt vmcnt(7)
    v_mfma_f32_32x32x16_bf16 v[144:159], v[40:43], v[28:31], 0
    v_exp_f32 v128, v128
    v_exp_f32 v129, v129
    v_exp_f32 v130, v130
    v_exp_f32 v131, v131
    v_mfma_f32_32x32x8_bf16 v[144:159], v[56:57], v[38:39], v[144:159]
    ds_read_b64_tr_b16 v[244:245], v242 offset:32
    ds_read_b64_tr_b16 v[246:247], v242 offset:1056
    v_exp_f32 v132, v132
    v_exp_f32 v133, v133
    v_exp_f32 v134, v134
    v_exp_f32 v135, v135
    v_smfmac_f32_32x32x32_bf16 v[176:191], v[68:71], v[120:127], v4
    ds_write_b128 v240, v[64:67] offset:1536
    ds_write_b128 v240, v[68:71] offset:2560
    v_exp_f32 v136, v136
    v_exp_f32 v137, v137
    v_exp_f32 v138, v138
    v_exp_f32 v139, v139
    v_smfmac_f32_32x32x32_bf16 v[192:207], v[64:67], v[128:135], v4
    v_exp_f32 v140, v140
    v_exp_f32 v141, v141
    v_exp_f32 v142, v142
    v_exp_f32 v143, v143
    s_waitcnt vmcnt(5)
    v_mfma_f32_32x32x16_bf16 v[96:111], v[44:47], v[16:19], 0
    v_exp_f32 v144, v144
    v_exp_f32 v145, v145
    v_exp_f32 v146, v146
    v_exp_f32 v147, v147
    v_mfma_f32_32x32x8_bf16 v[96:111], v[58:59], v[32:33], v[96:111]
    s_add_u32 s75, s75, 6144
    s_add_u32 s81, s75, 3072
    buffer_load_dwordx4 v[40:43], v2, s[16:19], s75 offen offset:0 sc1
    buffer_load_dwordx2 v[56:57], v3, s[16:19], s75 offen offset:1024 sc1
    s_waitcnt lgkmcnt(0)
    buffer_store_dwordx4 v[244:247], v2, s[16:19], s65 offen sc1
    v_exp_f32 v148, v148
    v_exp_f32 v149, v149
    v_exp_f32 v150, v150
    v_exp_f32 v151, v151
    v_smfmac_f32_32x32x32_bf16 v[192:207], v[68:71], v[136:143], v4
    v_exp_f32 v152, v152
    v_exp_f32 v153, v153
    v_exp_f32 v154, v154
    v_exp_f32 v155, v155
    v_smfmac_f32_32x32x32_bf16 v[208:223], v[64:67], v[144:151], v4
    v_exp_f32 v156, v156
    v_exp_f32 v157, v157
    v_exp_f32 v158, v158
    v_exp_f32 v159, v159
    v_mfma_f32_32x32x16_bf16 v[112:127], v[44:47], v[20:23], 0
    v_exp_f32 v96, v96
    v_exp_f32 v97, v97
    v_exp_f32 v98, v98
    v_exp_f32 v99, v99
    v_mfma_f32_32x32x8_bf16 v[112:127], v[58:59], v[34:35], v[112:127]
    ds_read_b64_tr_b16 v[244:245], v242 offset:64
    ds_read_b64_tr_b16 v[246:247], v242 offset:1088
    v_exp_f32 v100, v100
    v_exp_f32 v101, v101
    v_exp_f32 v102, v102
    v_exp_f32 v103, v103
    v_smfmac_f32_32x32x32_bf16 v[208:223], v[68:71], v[152:159], v4
    s_add_u32 s76, s76, 8192
    s_add_u32 s82, s76, 4096
    buffer_load_dwordx4 v[64:67], v2, s[16:19], s76 offen offset:0 sc1
    buffer_load_dwordx4 v[68:71], v2, s[16:19], s76 offen offset:1024 sc1
    v_exp_f32 v104, v104
    v_exp_f32 v105, v105
    v_exp_f32 v106, v106
    v_exp_f32 v107, v107
    v_smfmac_f32_32x32x32_bf16 v[160:175], v[72:75], v[96:103], v4
    v_exp_f32 v108, v108
    v_exp_f32 v109, v109
    v_exp_f32 v110, v110
    v_exp_f32 v111, v111
    v_mfma_f32_32x32x16_bf16 v[128:143], v[44:47], v[24:27], 0
    v_exp_f32 v112, v112
    v_exp_f32 v113, v113
    v_exp_f32 v114, v114
    v_exp_f32 v115, v115
    v_mfma_f32_32x32x8_bf16 v[128:143], v[58:59], v[36:37], v[128:143]
    ds_write_b128 v240, v[44:47] offset:3584
    ds_write_b64 v241, v[58:59] offset:4608
    s_waitcnt lgkmcnt(0)
    buffer_store_dwordx4 v[244:247], v2, s[16:19], s66 offen sc1
    v_exp_f32 v116, v116
    v_exp_f32 v117, v117
    v_exp_f32 v118, v118
    v_exp_f32 v119, v119
    v_smfmac_f32_32x32x32_bf16 v[160:175], v[76:79], v[104:111], v4
    v_exp_f32 v120, v120
    v_exp_f32 v121, v121
    v_exp_f32 v122, v122
    v_exp_f32 v123, v123
    v_smfmac_f32_32x32x32_bf16 v[176:191], v[72:75], v[112:119], v4
    v_exp_f32 v124, v124
    v_exp_f32 v125, v125
    v_exp_f32 v126, v126
    v_exp_f32 v127, v127
    v_mfma_f32_32x32x16_bf16 v[144:159], v[44:47], v[28:31], 0
    v_exp_f32 v128, v128
    v_exp_f32 v129, v129
    v_exp_f32 v130, v130
    v_exp_f32 v131, v131
    v_mfma_f32_32x32x8_bf16 v[144:159], v[58:59], v[38:39], v[144:159]
    ds_read_b64_tr_b16 v[244:245], v242 offset:96
    ds_read_b64_tr_b16 v[246:247], v242 offset:1120
    v_exp_f32 v132, v132
    v_exp_f32 v133, v133
    v_exp_f32 v134, v134
    v_exp_f32 v135, v135
    v_smfmac_f32_32x32x32_bf16 v[176:191], v[76:79], v[120:127], v4
    ds_write_b128 v240, v[72:75] offset:5120
    ds_write_b128 v240, v[76:79] offset:6144
    v_exp_f32 v136, v136
    v_exp_f32 v137, v137
    v_exp_f32 v138, v138
    v_exp_f32 v139, v139
    v_smfmac_f32_32x32x32_bf16 v[192:207], v[72:75], v[128:135], v4
    v_exp_f32 v140, v140
    v_exp_f32 v141, v141
    v_exp_f32 v142, v142
    v_exp_f32 v143, v143
    s_waitcnt vmcnt(9)
    v_mfma_f32_32x32x16_bf16 v[96:111], v[48:51], v[16:19], 0
    v_exp_f32 v144, v144
    v_exp_f32 v145, v145
    v_exp_f32 v146, v146
    v_exp_f32 v147, v147
    v_mfma_f32_32x32x8_bf16 v[96:111], v[60:61], v[32:33], v[96:111]
    buffer_load_dwordx4 v[44:47], v2, s[16:19], s75 offen offset:1536 sc1
    buffer_load_dwordx2 v[58:59], v3, s[16:19], s75 offen offset:2560 sc1
    s_waitcnt lgkmcnt(0)
    buffer_store_dwordx4 v[244:247], v2, s[16:19], s69 offen sc1
    v_exp_f32 v148, v148
    v_exp_f32 v149, v149
    v_exp_f32 v150, v150
    v_exp_f32 v151, v151
    v_smfmac_f32_32x32x32_bf16 v[192:207], v[76:79], v[136:143], v4
    v_exp_f32 v152, v152
    v_exp_f32 v153, v153
    v_exp_f32 v154, v154
    v_exp_f32 v155, v155
    v_smfmac_f32_32x32x32_bf16 v[208:223], v[72:75], v[144:151], v4
    v_exp_f32 v156, v156
    v_exp_f32 v157, v157
    v_exp_f32 v158, v158
    v_exp_f32 v159, v159
    v_mfma_f32_32x32x16_bf16 v[112:127], v[48:51], v[20:23], 0
    v_exp_f32 v96, v96
    v_exp_f32 v97, v97
    v_exp_f32 v98, v98
    v_exp_f32 v99, v99
    v_mfma_f32_32x32x8_bf16 v[112:127], v[60:61], v[34:35], v[112:127]
    buffer_store_dwordx4 v[248:251], v2, s[16:19], s93 offen sc1
    s_mov_b32 exec_hi, 0
    buffer_store_dwordx2 v[248:249], v2, s[16:19], s92 offen sc1
    s_mov_b32 exec_hi, -1
    v_exp_f32 v100, v100
    v_exp_f32 v101, v101
    v_exp_f32 v102, v102
    v_exp_f32 v103, v103
    v_smfmac_f32_32x32x32_bf16 v[208:223], v[76:79], v[152:159], v4
    buffer_load_dwordx4 v[72:75], v2, s[16:19], s76 offen offset:2048 sc1
    buffer_load_dwordx4 v[76:79], v2, s[16:19], s76 offen offset:3072 sc1
    v_exp_f32 v104, v104
    v_exp_f32 v105, v105
    v_exp_f32 v106, v106
    v_exp_f32 v107, v107
    v_smfmac_f32_32x32x32_bf16 v[160:175], v[80:83], v[96:103], v4
    v_exp_f32 v108, v108
    v_exp_f32 v109, v109
    v_exp_f32 v110, v110
    v_exp_f32 v111, v111
    v_mfma_f32_32x32x16_bf16 v[128:143], v[48:51], v[24:27], 0
    v_exp_f32 v112, v112
    v_exp_f32 v113, v113
    v_exp_f32 v114, v114
    v_exp_f32 v115, v115
    v_mfma_f32_32x32x8_bf16 v[128:143], v[60:61], v[36:37], v[128:143]
    ds_write_b128 v240, v[48:51] offset:7168
    ds_write_b64 v241, v[60:61] offset:8192
    v_exp_f32 v116, v116
    v_exp_f32 v117, v117
    v_exp_f32 v118, v118
    v_exp_f32 v119, v119
    v_smfmac_f32_32x32x32_bf16 v[160:175], v[84:87], v[104:111], v4
    v_exp_f32 v120, v120
    v_exp_f32 v121, v121
    v_exp_f32 v122, v122
    v_exp_f32 v123, v123
    v_smfmac_f32_32x32x32_bf16 v[176:191], v[80:83], v[112:119], v4
    v_exp_f32 v124, v124
    v_exp_f32 v125, v125
    v_exp_f32 v126, v126
    v_exp_f32 v127, v127
    v_mfma_f32_32x32x16_bf16 v[144:159], v[48:51], v[28:31], 0
    v_exp_f32 v128, v128
    v_exp_f32 v129, v129
    v_exp_f32 v130, v130
    v_exp_f32 v131, v131
    v_mfma_f32_32x32x8_bf16 v[144:159], v[60:61], v[38:39], v[144:159]
    v_exp_f32 v132, v132
    v_exp_f32 v133, v133
    v_exp_f32 v134, v134
    v_exp_f32 v135, v135
    v_smfmac_f32_32x32x32_bf16 v[176:191], v[84:87], v[120:127], v4
    ds_write_b128 v240, v[80:83] offset:8704
    ds_write_b128 v240, v[84:87] offset:9728
    v_exp_f32 v136, v136
    v_exp_f32 v137, v137
    v_exp_f32 v138, v138
    v_exp_f32 v139, v139
    v_smfmac_f32_32x32x32_bf16 v[192:207], v[80:83], v[128:135], v4
    v_exp_f32 v140, v140
    v_exp_f32 v141, v141
    v_exp_f32 v142, v142
    v_exp_f32 v143, v143
    s_waitcnt vmcnt(14)
    v_mfma_f32_32x32x16_bf16 v[96:111], v[52:55], v[16:19], 0
    v_exp_f32 v144, v144
    v_exp_f32 v145, v145
    v_exp_f32 v146, v146
    v_exp_f32 v147, v147
    v_mfma_f32_32x32x8_bf16 v[96:111], v[62:63], v[32:33], v[96:111]
    buffer_load_dwordx4 v[48:51], v2, s[16:19], s81 offen offset:0 sc1
    buffer_load_dwordx2 v[60:61], v3, s[16:19], s81 offen offset:1024 sc1
    v_exp_f32 v148, v148
    v_exp_f32 v149, v149
    v_exp_f32 v150, v150
    v_exp_f32 v151, v151
    v_smfmac_f32_32x32x32_bf16 v[192:207], v[84:87], v[136:143], v4
    v_exp_f32 v152, v152
    v_exp_f32 v153, v153
    v_exp_f32 v154, v154
    v_exp_f32 v155, v155
    v_smfmac_f32_32x32x32_bf16 v[208:223], v[80:83], v[144:151], v4
    v_exp_f32 v156, v156
    v_exp_f32 v157, v157
    v_exp_f32 v158, v158
    v_exp_f32 v159, v159
    v_mfma_f32_32x32x16_bf16 v[112:127], v[52:55], v[20:23], 0
    v_exp_f32 v96, v96
    v_exp_f32 v97, v97
    v_exp_f32 v98, v98
    v_exp_f32 v99, v99
    v_mfma_f32_32x32x8_bf16 v[112:127], v[62:63], v[34:35], v[112:127]
    v_exp_f32 v100, v100
    v_exp_f32 v101, v101
    v_exp_f32 v102, v102
    v_exp_f32 v103, v103
    v_smfmac_f32_32x32x32_bf16 v[208:223], v[84:87], v[152:159], v4
    buffer_load_dwordx4 v[80:83], v2, s[16:19], s82 offen offset:0 sc1
    buffer_load_dwordx4 v[84:87], v2, s[16:19], s82 offen offset:1024 sc1
    v_exp_f32 v104, v104
    v_exp_f32 v105, v105
    v_exp_f32 v106, v106
    v_exp_f32 v107, v107
    v_smfmac_f32_32x32x32_bf16 v[160:175], v[88:91], v[96:103], v4
    v_exp_f32 v108, v108
    v_exp_f32 v109, v109
    v_exp_f32 v110, v110
    v_exp_f32 v111, v111
    v_mfma_f32_32x32x16_bf16 v[128:143], v[52:55], v[24:27], 0
    v_exp_f32 v112, v112
    v_exp_f32 v113, v113
    v_exp_f32 v114, v114
    v_exp_f32 v115, v115
    v_mfma_f32_32x32x8_bf16 v[128:143], v[62:63], v[36:37], v[128:143]
    ds_write_b128 v240, v[52:55] offset:10752
    ds_write_b64 v241, v[62:63] offset:11776
    v_exp_f32 v116, v116
    v_exp_f32 v117, v117
    v_exp_f32 v118, v118
    v_exp_f32 v119, v119
    v_smfmac_f32_32x32x32_bf16 v[160:175], v[92:95], v[104:111], v4
    v_exp_f32 v120, v120
    v_exp_f32 v121, v121
    v_exp_f32 v122, v122
    v_exp_f32 v123, v123
    v_smfmac_f32_32x32x32_bf16 v[176:191], v[88:91], v[112:119], v4
    v_exp_f32 v124, v124
    v_exp_f32 v125, v125
    v_exp_f32 v126, v126
    v_exp_f32 v127, v127
    v_mfma_f32_32x32x16_bf16 v[144:159], v[52:55], v[28:31], 0
    v_exp_f32 v128, v128
    v_exp_f32 v129, v129
    v_exp_f32 v130, v130
    v_exp_f32 v131, v131
    v_mfma_f32_32x32x8_bf16 v[144:159], v[62:63], v[38:39], v[144:159]
    v_exp_f32 v132, v132
    v_exp_f32 v133, v133
    v_exp_f32 v134, v134
    v_exp_f32 v135, v135
    v_smfmac_f32_32x32x32_bf16 v[176:191], v[92:95], v[120:127], v4
    ds_write_b128 v240, v[88:91] offset:12288
    ds_write_b128 v240, v[92:95] offset:13312
    v_mov_b32 v6, s80
    v_mov_b32 v7, 1
    ds_write_b32 v6, v7
    v_exp_f32 v136, v136
    v_exp_f32 v137, v137
    v_exp_f32 v138, v138
    v_exp_f32 v139, v139
    v_smfmac_f32_32x32x32_bf16 v[192:207], v[88:91], v[128:135], v4
    v_exp_f32 v140, v140
    v_exp_f32 v141, v141
    v_exp_f32 v142, v142
    v_exp_f32 v143, v143
    s_waitcnt vmcnt(12)
    v_mfma_f32_32x32x16_bf16 v[96:111], v[40:43], v[16:19], 0
    v_exp_f32 v144, v144
    v_exp_f32 v145, v145
    v_exp_f32 v146, v146
    v_exp_f32 v147, v147
    v_mfma_f32_32x32x8_bf16 v[96:111], v[56:57], v[32:33], v[96:111]
    buffer_load_dwordx4 v[52:55], v2, s[16:19], s81 offen offset:1536 sc1
    buffer_load_dwordx2 v[62:63], v3, s[16:19], s81 offen offset:2560 sc1
    v_exp_f32 v148, v148
    v_exp_f32 v149, v149
    v_exp_f32 v150, v150
    v_exp_f32 v151, v151
    v_smfmac_f32_32x32x32_bf16 v[192:207], v[92:95], v[136:143], v4
    v_exp_f32 v152, v152
    v_exp_f32 v153, v153
    v_exp_f32 v154, v154
    v_exp_f32 v155, v155
    v_smfmac_f32_32x32x32_bf16 v[208:223], v[88:91], v[144:151], v4
    v_exp_f32 v156, v156
    v_exp_f32 v157, v157
    v_exp_f32 v158, v158
    v_exp_f32 v159, v159
    s_waitcnt vmcnt(8)
    v_mov_b32 v6, 159768
    v_mov_b32 v7, 1
    s_mov_b64 exec, 1
    ds_add_rtn_u32 v7, v6, v7
    s_waitcnt lgkmcnt(0)
    v_readfirstlane_b32 s36, v7
    s_mov_b64 exec, -1
    s_nop 3
    s_cmp_lg_u32 s36, 7
    s_cbranch_scc1 arr_58
    s_and_b32 s36, s2, 15
    s_lshl_b32 s36, s36, 7
    v_mov_b32 v8, 4096000
    v_mov_b32 v9, 1
    s_mov_b64 exec, 1
    buffer_atomic_add v9, v8, s[16:19], s36 offen sc1
    s_mov_b64 exec, -1
arr_58:
    v_mfma_f32_32x32x16_bf16 v[112:127], v[40:43], v[20:23], 0
    v_exp_f32 v96, v96
    v_exp_f32 v97, v97
    v_exp_f32 v98, v98
    v_exp_f32 v99, v99
    v_mfma_f32_32x32x8_bf16 v[112:127], v[56:57], v[34:35], v[112:127]
    v_exp_f32 v100, v100
    v_exp_f32 v101, v101
    v_exp_f32 v102, v102
    v_exp_f32 v103, v103
    v_smfmac_f32_32x32x32_bf16 v[208:223], v[92:95], v[152:159], v4
    buffer_load_dwordx4 v[88:91], v2, s[16:19], s82 offen offset:2048 sc1
    buffer_load_dwordx4 v[92:95], v2, s[16:19], s82 offen offset:3072 sc1
    v_exp_f32 v104, v104
    v_exp_f32 v105, v105
    v_exp_f32 v106, v106
    v_exp_f32 v107, v107
    v_smfmac_f32_32x32x32_bf16 v[160:175], v[64:67], v[96:103], v4
    v_exp_f32 v108, v108
    v_exp_f32 v109, v109
    v_exp_f32 v110, v110
    v_exp_f32 v111, v111
    v_mfma_f32_32x32x16_bf16 v[128:143], v[40:43], v[24:27], 0
    v_exp_f32 v112, v112
    v_exp_f32 v113, v113
    v_exp_f32 v114, v114
    v_exp_f32 v115, v115
    v_mfma_f32_32x32x8_bf16 v[128:143], v[56:57], v[36:37], v[128:143]
    ds_write_b128 v240, v[40:43] offset:14336
    ds_write_b64 v241, v[56:57] offset:15360
    v_exp_f32 v116, v116
    v_exp_f32 v117, v117
    v_exp_f32 v118, v118
    v_exp_f32 v119, v119
    v_smfmac_f32_32x32x32_bf16 v[160:175], v[68:71], v[104:111], v4
    v_exp_f32 v120, v120
    v_exp_f32 v121, v121
    v_exp_f32 v122, v122
    v_exp_f32 v123, v123
    v_smfmac_f32_32x32x32_bf16 v[176:191], v[64:67], v[112:119], v4
    v_exp_f32 v124, v124
    v_exp_f32 v125, v125
    v_exp_f32 v126, v126
    v_exp_f32 v127, v127
    v_mfma_f32_32x32x16_bf16 v[144:159], v[40:43], v[28:31], 0
    v_exp_f32 v128, v128
    v_exp_f32 v129, v129
    v_exp_f32 v130, v130
    v_exp_f32 v131, v131
    v_mfma_f32_32x32x8_bf16 v[144:159], v[56:57], v[38:39], v[144:159]
    v_exp_f32 v132, v132
    v_exp_f32 v133, v133
    v_exp_f32 v134, v134
    v_exp_f32 v135, v135
    v_smfmac_f32_32x32x32_bf16 v[176:191], v[68:71], v[120:127], v4
    ds_write_b128 v240, v[64:67] offset:15872
    ds_write_b128 v240, v[68:71] offset:16896
    v_exp_f32 v136, v136
    v_exp_f32 v137, v137
    v_exp_f32 v138, v138
    v_exp_f32 v139, v139
    v_smfmac_f32_32x32x32_bf16 v[192:207], v[64:67], v[128:135], v4
    v_exp_f32 v140, v140
    v_exp_f32 v141, v141
    v_exp_f32 v142, v142
    v_exp_f32 v143, v143
    s_waitcnt vmcnt(8)
    v_mfma_f32_32x32x16_bf16 v[96:111], v[44:47], v[16:19], 0
    v_exp_f32 v144, v144
    v_exp_f32 v145, v145
    v_exp_f32 v146, v146
    v_exp_f32 v147, v147
    v_mfma_f32_32x32x8_bf16 v[96:111], v[58:59], v[32:33], v[96:111]
    s_add_u32 s75, s75, 4294948864
    s_add_u32 s81, s75, 3072
    buffer_load_dwordx4 v[40:43], v2, s[16:19], s75 offen offset:0 sc1
    buffer_load_dwordx2 v[56:57], v3, s[16:19], s75 offen offset:1024 sc1
    v_exp_f32 v148, v148
    v_exp_f32 v149, v149
    v_exp_f32 v150, v150
    v_exp_f32 v151, v151
    v_smfmac_f32_32x32x32_bf16 v[192:207], v[68:71], v[136:143], v4
    v_exp_f32 v152, v152
    v_exp_f32 v153, v153
    v_exp_f32 v154, v154
    v_exp_f32 v155, v155
    v_smfmac_f32_32x32x32_bf16 v[208:223], v[64:67], v[144:151], v4
    v_exp_f32 v156, v156
    v_exp_f32 v157, v157
    v_exp_f32 v158, v158
    v_exp_f32 v159, v159
    v_mfma_f32_32x32x16_bf16 v[112:127], v[44:47], v[20:23], 0
    v_exp_f32 v96, v96
    v_exp_f32 v97, v97
    v_exp_f32 v98, v98
    v_exp_f32 v99, v99
    v_mfma_f32_32x32x8_bf16 v[112:127], v[58:59], v[34:35], v[112:127]
    v_exp_f32 v100, v100
    v_exp_f32 v101, v101
    v_exp_f32 v102, v102
    v_exp_f32 v103, v103
    v_smfmac_f32_32x32x32_bf16 v[208:223], v[68:71], v[152:159], v4
    s_add_u32 s76, s76, 4294942720
    s_add_u32 s82, s76, 4096
    buffer_load_dwordx4 v[64:67], v2, s[16:19], s76 offen offset:0 sc1
    buffer_load_dwordx4 v[68:71], v2, s[16:19], s76 offen offset:1024 sc1
    v_exp_f32 v104, v104
    v_exp_f32 v105, v105
    v_exp_f32 v106, v106
    v_exp_f32 v107, v107
    v_smfmac_f32_32x32x32_bf16 v[160:175], v[72:75], v[96:103], v4
    v_exp_f32 v108, v108
    v_exp_f32 v109, v109
    v_exp_f32 v110, v110
    v_exp_f32 v111, v111
    v_mfma_f32_32x32x16_bf16 v[128:143], v[44:47], v[24:27], 0
    v_exp_f32 v112, v112
    v_exp_f32 v113, v113
    v_exp_f32 v114, v114
    v_exp_f32 v115, v115
    v_mfma_f32_32x32x8_bf16 v[128:143], v[58:59], v[36:37], v[128:143]
    ds_write_b128 v240, v[44:47] offset:17920
    ds_write_b64 v241, v[58:59] offset:18944
    v_exp_f32 v116, v116
    v_exp_f32 v117, v117
    v_exp_f32 v118, v118
    v_exp_f32 v119, v119
    v_smfmac_f32_32x32x32_bf16 v[160:175], v[76:79], v[104:111], v4
    v_exp_f32 v120, v120
    v_exp_f32 v121, v121
    v_exp_f32 v122, v122
    v_exp_f32 v123, v123
    v_smfmac_f32_32x32x32_bf16 v[176:191], v[72:75], v[112:119], v4
    v_exp_f32 v124, v124
    v_exp_f32 v125, v125
    v_exp_f32 v126, v126
    v_exp_f32 v127, v127
    v_mfma_f32_32x32x16_bf16 v[144:159], v[44:47], v[28:31], 0
    v_exp_f32 v128, v128
    v_exp_f32 v129, v129
    v_exp_f32 v130, v130
    v_exp_f32 v131, v131
    v_mfma_f32_32x32x8_bf16 v[144:159], v[58:59], v[38:39], v[144:159]
    v_exp_f32 v132, v132
    v_exp_f32 v133, v133
    v_exp_f32 v134, v134
    v_exp_f32 v135, v135
    v_smfmac_f32_32x32x32_bf16 v[176:191], v[76:79], v[120:127], v4
    ds_write_b128 v240, v[72:75] offset:19456
    ds_write_b128 v240, v[76:79] offset:20480
    v_exp_f32 v136, v136
    v_exp_f32 v137, v137
    v_exp_f32 v138, v138
    v_exp_f32 v139, v139
    v_smfmac_f32_32x32x32_bf16 v[192:207], v[72:75], v[128:135], v4
    v_exp_f32 v140, v140
    v_exp_f32 v141, v141
    v_exp_f32 v142, v142
    v_exp_f32 v143, v143
    s_waitcnt vmcnt(8)
    v_mfma_f32_32x32x16_bf16 v[96:111], v[48:51], v[16:19], 0
    v_exp_f32 v144, v144
    v_exp_f32 v145, v145
    v_exp_f32 v146, v146
    v_exp_f32 v147, v147
    v_mfma_f32_32x32x8_bf16 v[96:111], v[60:61], v[32:33], v[96:111]
    buffer_load_dwordx4 v[44:47], v2, s[16:19], s75 offen offset:1536 sc1
    buffer_load_dwordx2 v[58:59], v3, s[16:19], s75 offen offset:2560 sc1
    v_exp_f32 v148, v148
    v_exp_f32 v149, v149
    v_exp_f32 v150, v150
    v_exp_f32 v151, v151
    v_smfmac_f32_32x32x32_bf16 v[192:207], v[76:79], v[136:143], v4
    v_exp_f32 v152, v152
    v_exp_f32 v153, v153
    v_exp_f32 v154, v154
    v_exp_f32 v155, v155
    v_smfmac_f32_32x32x32_bf16 v[208:223], v[72:75], v[144:151], v4
    v_exp_f32 v156, v156
    v_exp_f32 v157, v157
    v_exp_f32 v158, v158
    v_exp_f32 v159, v159
    v_mfma_f32_32x32x16_bf16 v[112:127], v[48:51], v[20:23], 0
    v_exp_f32 v96, v96
    v_exp_f32 v97, v97
    v_exp_f32 v98, v98
    v_exp_f32 v99, v99
    v_mfma_f32_32x32x8_bf16 v[112:127], v[60:61], v[34:35], v[112:127]
    v_exp_f32 v100, v100
    v_exp_f32 v101, v101
    v_exp_f32 v102, v102
    v_exp_f32 v103, v103
    v_smfmac_f32_32x32x32_bf16 v[208:223], v[76:79], v[152:159], v4
    buffer_load_dwordx4 v[72:75], v2, s[16:19], s76 offen offset:2048 sc1
    buffer_load_dwordx4 v[76:79], v2, s[16:19], s76 offen offset:3072 sc1
    v_exp_f32 v104, v104
    v_exp_f32 v105, v105
    v_exp_f32 v106, v106
    v_exp_f32 v107, v107
    v_smfmac_f32_32x32x32_bf16 v[160:175], v[80:83], v[96:103], v4
    v_exp_f32 v108, v108
    v_exp_f32 v109, v109
    v_exp_f32 v110, v110
    v_exp_f32 v111, v111
    v_mfma_f32_32x32x16_bf16 v[128:143], v[48:51], v[24:27], 0
    v_exp_f32 v112, v112
    v_exp_f32 v113, v113
    v_exp_f32 v114, v114
    v_exp_f32 v115, v115
    v_mfma_f32_32x32x8_bf16 v[128:143], v[60:61], v[36:37], v[128:143]
    ds_write_b128 v240, v[48:51] offset:21504
    ds_write_b64 v241, v[60:61] offset:22528
    v_exp_f32 v116, v116
    v_exp_f32 v117, v117
    v_exp_f32 v118, v118
    v_exp_f32 v119, v119
    v_smfmac_f32_32x32x32_bf16 v[160:175], v[84:87], v[104:111], v4
    v_exp_f32 v120, v120
    v_exp_f32 v121, v121
    v_exp_f32 v122, v122
    v_exp_f32 v123, v123
    v_smfmac_f32_32x32x32_bf16 v[176:191], v[80:83], v[112:119], v4
    v_exp_f32 v124, v124
    v_exp_f32 v125, v125
    v_exp_f32 v126, v126
    v_exp_f32 v127, v127
    v_mfma_f32_32x32x16_bf16 v[144:159], v[48:51], v[28:31], 0
    v_exp_f32 v128, v128
    v_exp_f32 v129, v129
    v_exp_f32 v130, v130
    v_exp_f32 v131, v131
    v_mfma_f32_32x32x8_bf16 v[144:159], v[60:61], v[38:39], v[144:159]
    v_exp_f32 v132, v132
    v_exp_f32 v133, v133
    v_exp_f32 v134, v134
    v_exp_f32 v135, v135
    v_smfmac_f32_32x32x32_bf16 v[176:191], v[84:87], v[120:127], v4
    ds_write_b128 v240, v[80:83] offset:23040
    ds_write_b128 v240, v[84:87] offset:24064
    v_exp_f32 v136, v136
    v_exp_f32 v137, v137
    v_exp_f32 v138, v138
    v_exp_f32 v139, v139
    v_smfmac_f32_32x32x32_bf16 v[192:207], v[80:83], v[128:135], v4
    v_exp_f32 v140, v140
    v_exp_f32 v141, v141
    v_exp_f32 v142, v142
    v_exp_f32 v143, v143
    s_waitcnt vmcnt(8)
    v_mfma_f32_32x32x16_bf16 v[96:111], v[52:55], v[16:19], 0
    v_exp_f32 v144, v144
    v_exp_f32 v145, v145
    v_exp_f32 v146, v146
    v_exp_f32 v147, v147
    v_mfma_f32_32x32x8_bf16 v[96:111], v[62:63], v[32:33], v[96:111]
    buffer_load_dwordx4 v[48:51], v2, s[16:19], s81 offen offset:0 sc1
    buffer_load_dwordx2 v[60:61], v3, s[16:19], s81 offen offset:1024 sc1
    v_exp_f32 v148, v148
    v_exp_f32 v149, v149
    v_exp_f32 v150, v150
    v_exp_f32 v151, v151
    v_smfmac_f32_32x32x32_bf16 v[192:207], v[84:87], v[136:143], v4
    v_exp_f32 v152, v152
    v_exp_f32 v153, v153
    v_exp_f32 v154, v154
    v_exp_f32 v155, v155
    v_smfmac_f32_32x32x32_bf16 v[208:223], v[80:83], v[144:151], v4
    v_exp_f32 v156, v156
    v_exp_f32 v157, v157
    v_exp_f32 v158, v158
    v_exp_f32 v159, v159
    v_mfma_f32_32x32x16_bf16 v[112:127], v[52:55], v[20:23], 0
    v_exp_f32 v96, v96
    v_exp_f32 v97, v97
    v_exp_f32 v98, v98
    v_exp_f32 v99, v99
    v_mfma_f32_32x32x8_bf16 v[112:127], v[62:63], v[34:35], v[112:127]
    v_exp_f32 v100, v100
    v_exp_f32 v101, v101
    v_exp_f32 v102, v102
    v_exp_f32 v103, v103
    v_smfmac_f32_32x32x32_bf16 v[208:223], v[84:87], v[152:159], v4
    buffer_load_dwordx4 v[80:83], v2, s[16:19], s82 offen offset:0 sc1
    buffer_load_dwordx4 v[84:87], v2, s[16:19], s82 offen offset:1024 sc1
    v_exp_f32 v104, v104
    v_exp_f32 v105, v105
    v_exp_f32 v106, v106
    v_exp_f32 v107, v107
    v_smfmac_f32_32x32x32_bf16 v[160:175], v[88:91], v[96:103], v4
    v_exp_f32 v108, v108
    v_exp_f32 v109, v109
    v_exp_f32 v110, v110
    v_exp_f32 v111, v111
    v_mfma_f32_32x32x16_bf16 v[128:143], v[52:55], v[24:27], 0
    v_exp_f32 v112, v112
    v_exp_f32 v113, v113
    v_exp_f32 v114, v114
    v_exp_f32 v115, v115
    v_mfma_f32_32x32x8_bf16 v[128:143], v[62:63], v[36:37], v[128:143]
    ds_write_b128 v240, v[52:55] offset:25088
    ds_write_b64 v241, v[62:63] offset:26112
    v_exp_f32 v116, v116
    v_exp_f32 v117, v117
    v_exp_f32 v118, v118
    v_exp_f32 v119, v119
    v_smfmac_f32_32x32x32_bf16 v[160:175], v[92:95], v[104:111], v4
    v_exp_f32 v120, v120
    v_exp_f32 v121, v121
    v_exp_f32 v122, v122
    v_exp_f32 v123, v123
    v_smfmac_f32_32x32x32_bf16 v[176:191], v[88:91], v[112:119], v4
    v_exp_f32 v124, v124
    v_exp_f32 v125, v125
    v_exp_f32 v126, v126
    v_exp_f32 v127, v127
    v_mfma_f32_32x32x16_bf16 v[144:159], v[52:55], v[28:31], 0
    v_exp_f32 v128, v128
    v_exp_f32 v129, v129
    v_exp_f32 v130, v130
    v_exp_f32 v131, v131
    v_mfma_f32_32x32x8_bf16 v[144:159], v[62:63], v[38:39], v[144:159]
    v_exp_f32 v132, v132
    v_exp_f32 v133, v133
    v_exp_f32 v134, v134
    v_exp_f32 v135, v135
    v_smfmac_f32_32x32x32_bf16 v[176:191], v[92:95], v[120:127], v4
    ds_write_b128 v240, v[88:91] offset:26624
    ds_write_b128 v240, v[92:95] offset:27648
    v_mov_b32 v6, s80
    v_mov_b32 v7, 2
    ds_write_b32 v6, v7
    v_exp_f32 v136, v136
    v_exp_f32 v137, v137
    v_exp_f32 v138, v138
    v_exp_f32 v139, v139
    v_smfmac_f32_32x32x32_bf16 v[192:207], v[88:91], v[128:135], v4
    v_exp_f32 v140, v140
    v_exp_f32 v141, v141
    v_exp_f32 v142, v142
    v_exp_f32 v143, v143
    s_waitcnt vmcnt(8)
    v_mfma_f32_32x32x16_bf16 v[96:111], v[40:43], v[16:19], 0
    v_exp_f32 v144, v144
    v_exp_f32 v145, v145
    v_exp_f32 v146, v146
    v_exp_f32 v147, v147
    v_mfma_f32_32x32x8_bf16 v[96:111], v[56:57], v[32:33], v[96:111]
    buffer_load_dwordx4 v[52:55], v2, s[16:19], s81 offen offset:1536 sc1
    buffer_load_dwordx2 v[62:63], v3, s[16:19], s81 offen offset:2560 sc1
    v_exp_f32 v148, v148
    v_exp_f32 v149, v149
    v_exp_f32 v150, v150
    v_exp_f32 v151, v151
    v_smfmac_f32_32x32x32_bf16 v[192:207], v[92:95], v[136:143], v4
    v_exp_f32 v152, v152
    v_exp_f32 v153, v153
    v_exp_f32 v154, v154
    v_exp_f32 v155, v155
    v_smfmac_f32_32x32x32_bf16 v[208:223], v[88:91], v[144:151], v4
    v_exp_f32 v156, v156
    v_exp_f32 v157, v157
    v_exp_f32 v158, v158
    v_exp_f32 v159, v159
    v_mfma_f32_32x32x16_bf16 v[112:127], v[40:43], v[20:23], 0
    v_exp_f32 v96, v96
    v_exp_f32 v97, v97
    v_exp_f32 v98, v98
    v_exp_f32 v99, v99
    v_mfma_f32_32x32x8_bf16 v[112:127], v[56:57], v[34:35], v[112:127]
    v_exp_f32 v100, v100
    v_exp_f32 v101, v101
    v_exp_f32 v102, v102
    v_exp_f32 v103, v103
    v_smfmac_f32_32x32x32_bf16 v[208:223], v[92:95], v[152:159], v4
    buffer_load_dwordx4 v[88:91], v2, s[16:19], s82 offen offset:2048 sc1
    buffer_load_dwordx4 v[92:95], v2, s[16:19], s82 offen offset:3072 sc1
    v_exp_f32 v104, v104
    v_exp_f32 v105, v105
    v_exp_f32 v106, v106
    v_exp_f32 v107, v107
    v_smfmac_f32_32x32x32_bf16 v[160:175], v[64:67], v[96:103], v4
    v_exp_f32 v108, v108
    v_exp_f32 v109, v109
    v_exp_f32 v110, v110
    v_exp_f32 v111, v111
    v_mfma_f32_32x32x16_bf16 v[128:143], v[40:43], v[24:27], 0
    v_exp_f32 v112, v112
    v_exp_f32 v113, v113
    v_exp_f32 v114, v114
    v_exp_f32 v115, v115
    v_mfma_f32_32x32x8_bf16 v[128:143], v[56:57], v[36:37], v[128:143]
    v_exp_f32 v116, v116
    v_exp_f32 v117, v117
    v_exp_f32 v118, v118
    v_exp_f32 v119, v119
    v_smfmac_f32_32x32x32_bf16 v[160:175], v[68:71], v[104:111], v4
    v_exp_f32 v120, v120
    v_exp_f32 v121, v121
    v_exp_f32 v122, v122
    v_exp_f32 v123, v123
    v_smfmac_f32_32x32x32_bf16 v[176:191], v[64:67], v[112:119], v4
    v_exp_f32 v124, v124
    v_exp_f32 v125, v125
    v_exp_f32 v126, v126
    v_exp_f32 v127, v127
    v_mfma_f32_32x32x16_bf16 v[144:159], v[40:43], v[28:31], 0
    v_exp_f32 v128, v128
    v_exp_f32 v129, v129
    v_exp_f32 v130, v130
    v_exp_f32 v131, v131
    v_mfma_f32_32x32x8_bf16 v[144:159], v[56:57], v[38:39], v[144:159]
    v_exp_f32 v132, v132
    v_exp_f32 v133, v133
    v_exp_f32 v134, v134
    v_exp_f32 v135, v135
    v_smfmac_f32_32x32x32_bf16 v[176:191], v[68:71], v[120:127], v4
    v_exp_f32 v136, v136
    v_exp_f32 v137, v137
    v_exp_f32 v138, v138
    v_exp_f32 v139, v139
    v_smfmac_f32_32x32x32_bf16 v[192:207], v[64:67], v[128:135], v4
    v_exp_f32 v140, v140
    v_exp_f32 v141, v141
    v_exp_f32 v142, v142
    v_exp_f32 v143, v143
    s_waitcnt vmcnt(8)
    v_mfma_f32_32x32x16_bf16 v[96:111], v[44:47], v[16:19], 0
    v_exp_f32 v144, v144
    v_exp_f32 v145, v145
    v_exp_f32 v146, v146
    v_exp_f32 v147, v147
    v_mfma_f32_32x32x8_bf16 v[96:111], v[58:59], v[32:33], v[96:111]
    s_add_u32 s75, s75, 6144
    s_add_u32 s81, s75, 3072
    buffer_load_dwordx4 v[40:43], v2, s[16:19], s75 offen offset:0 sc1
    buffer_load_dwordx2 v[56:57], v3, s[16:19], s75 offen offset:1024 sc1
    v_exp_f32 v148, v148
    v_exp_f32 v149, v149
    v_exp_f32 v150, v150
    v_exp_f32 v151, v151
    v_smfmac_f32_32x32x32_bf16 v[192:207], v[68:71], v[136:143], v4
    v_exp_f32 v152, v152
    v_exp_f32 v153, v153
    v_exp_f32 v154, v154
    v_exp_f32 v155, v155
    v_smfmac_f32_32x32x32_bf16 v[208:223], v[64:67], v[144:151], v4
    v_exp_f32 v156, v156
    v_exp_f32 v157, v157
    v_exp_f32 v158, v158
    v_exp_f32 v159, v159
    v_mfma_f32_32x32x16_bf16 v[112:127], v[44:47], v[20:23], 0
    v_exp_f32 v96, v96
    v_exp_f32 v97, v97
    v_exp_f32 v98, v98
    v_exp_f32 v99, v99
    v_mfma_f32_32x32x8_bf16 v[112:127], v[58:59], v[34:35], v[112:127]
    v_exp_f32 v100, v100
    v_exp_f32 v101, v101
    v_exp_f32 v102, v102
    v_exp_f32 v103, v103
    v_smfmac_f32_32x32x32_bf16 v[208:223], v[68:71], v[152:159], v4
    s_add_u32 s76, s76, 8192
    s_add_u32 s82, s76, 4096
    buffer_load_dwordx4 v[64:67], v2, s[16:19], s76 offen offset:0 sc1
    buffer_load_dwordx4 v[68:71], v2, s[16:19], s76 offen offset:1024 sc1
    v_exp_f32 v104, v104
    v_exp_f32 v105, v105
    v_exp_f32 v106, v106
    v_exp_f32 v107, v107
    v_smfmac_f32_32x32x32_bf16 v[160:175], v[72:75], v[96:103], v4
    v_exp_f32 v108, v108
    v_exp_f32 v109, v109
    v_exp_f32 v110, v110
    v_exp_f32 v111, v111
    v_mfma_f32_32x32x16_bf16 v[128:143], v[44:47], v[24:27], 0
    v_exp_f32 v112, v112
    v_exp_f32 v113, v113
    v_exp_f32 v114, v114
    v_exp_f32 v115, v115
    v_mfma_f32_32x32x8_bf16 v[128:143], v[58:59], v[36:37], v[128:143]
    v_exp_f32 v116, v116
    v_exp_f32 v117, v117
    v_exp_f32 v118, v118
    v_exp_f32 v119, v119
    v_smfmac_f32_32x32x32_bf16 v[160:175], v[76:79], v[104:111], v4
    v_exp_f32 v120, v120
    v_exp_f32 v121, v121
    v_exp_f32 v122, v122
    v_exp_f32 v123, v123
    v_smfmac_f32_32x32x32_bf16 v[176:191], v[72:75], v[112:119], v4
    v_exp_f32 v124, v124
    v_exp_f32 v125, v125
    v_exp_f32 v126, v126
    v_exp_f32 v127, v127
    v_mfma_f32_32x32x16_bf16 v[144:159], v[44:47], v[28:31], 0
    v_exp_f32 v128, v128
    v_exp_f32 v129, v129
    v_exp_f32 v130, v130
    v_exp_f32 v131, v131
    v_mfma_f32_32x32x8_bf16 v[144:159], v[58:59], v[38:39], v[144:159]
    v_exp_f32 v132, v132
    v_exp_f32 v133, v133
    v_exp_f32 v134, v134
    v_exp_f32 v135, v135
    v_smfmac_f32_32x32x32_bf16 v[176:191], v[76:79], v[120:127], v4
    v_exp_f32 v136, v136
    v_exp_f32 v137, v137
    v_exp_f32 v138, v138
    v_exp_f32 v139, v139
    v_smfmac_f32_32x32x32_bf16 v[192:207], v[72:75], v[128:135], v4
    v_exp_f32 v140, v140
    v_exp_f32 v141, v141
    v_exp_f32 v142, v142
    v_exp_f32 v143, v143
    s_waitcnt vmcnt(8)
    v_mfma_f32_32x32x16_bf16 v[96:111], v[48:51], v[16:19], 0
    v_exp_f32 v144, v144
    v_exp_f32 v145, v145
    v_exp_f32 v146, v146
    v_exp_f32 v147, v147
    v_mfma_f32_32x32x8_bf16 v[96:111], v[60:61], v[32:33], v[96:111]
    buffer_load_dwordx4 v[44:47], v2, s[16:19], s75 offen offset:1536 sc1
    buffer_load_dwordx2 v[58:59], v3, s[16:19], s75 offen offset:2560 sc1
    v_exp_f32 v148, v148
    v_exp_f32 v149, v149
    v_exp_f32 v150, v150
    v_exp_f32 v151, v151
    v_smfmac_f32_32x32x32_bf16 v[192:207], v[76:79], v[136:143], v4
    v_exp_f32 v152, v152
    v_exp_f32 v153, v153
    v_exp_f32 v154, v154
    v_exp_f32 v155, v155
    v_smfmac_f32_32x32x32_bf16 v[208:223], v[72:75], v[144:151], v4
    v_exp_f32 v156, v156
    v_exp_f32 v157, v157
    v_exp_f32 v158, v158
    v_exp_f32 v159, v159
    v_mfma_f32_32x32x16_bf16 v[112:127], v[48:51], v[20:23], 0
    v_exp_f32 v96, v96
    v_exp_f32 v97, v97
    v_exp_f32 v98, v98
    v_exp_f32 v99, v99
    v_mfma_f32_32x32x8_bf16 v[112:127], v[60:61], v[34:35], v[112:127]
    v_exp_f32 v100, v100
    v_exp_f32 v101, v101
    v_exp_f32 v102, v102
    v_exp_f32 v103, v103
    v_smfmac_f32_32x32x32_bf16 v[208:223], v[76:79], v[152:159], v4
    buffer_load_dwordx4 v[72:75], v2, s[16:19], s76 offen offset:2048 sc1
    buffer_load_dwordx4 v[76:79], v2, s[16:19], s76 offen offset:3072 sc1
    v_exp_f32 v104, v104
    v_exp_f32 v105, v105
    v_exp_f32 v106, v106
    v_exp_f32 v107, v107
    v_smfmac_f32_32x32x32_bf16 v[160:175], v[80:83], v[96:103], v4
    v_exp_f32 v108, v108
    v_exp_f32 v109, v109
    v_exp_f32 v110, v110
    v_exp_f32 v111, v111
    v_mfma_f32_32x32x16_bf16 v[128:143], v[48:51], v[24:27], 0
    v_exp_f32 v112, v112
    v_exp_f32 v113, v113
    v_exp_f32 v114, v114
    v_exp_f32 v115, v115
    v_mfma_f32_32x32x8_bf16 v[128:143], v[60:61], v[36:37], v[128:143]
    v_exp_f32 v116, v116
    v_exp_f32 v117, v117
    v_exp_f32 v118, v118
    v_exp_f32 v119, v119
    v_smfmac_f32_32x32x32_bf16 v[160:175], v[84:87], v[104:111], v4
    v_exp_f32 v120, v120
    v_exp_f32 v121, v121
    v_exp_f32 v122, v122
    v_exp_f32 v123, v123
    v_smfmac_f32_32x32x32_bf16 v[176:191], v[80:83], v[112:119], v4
    v_exp_f32 v124, v124
    v_exp_f32 v125, v125
    v_exp_f32 v126, v126
    v_exp_f32 v127, v127
    v_mfma_f32_32x32x16_bf16 v[144:159], v[48:51], v[28:31], 0
    v_exp_f32 v128, v128
    v_exp_f32 v129, v129
    v_exp_f32 v130, v130
    v_exp_f32 v131, v131
    v_mfma_f32_32x32x8_bf16 v[144:159], v[60:61], v[38:39], v[144:159]
    v_exp_f32 v132, v132
    v_exp_f32 v133, v133
    v_exp_f32 v134, v134
    v_exp_f32 v135, v135
    v_smfmac_f32_32x32x32_bf16 v[176:191], v[84:87], v[120:127], v4
    v_exp_f32 v136, v136
    v_exp_f32 v137, v137
    v_exp_f32 v138, v138
    v_exp_f32 v139, v139
    v_smfmac_f32_32x32x32_bf16 v[192:207], v[80:83], v[128:135], v4
    v_exp_f32 v140, v140
    v_exp_f32 v141, v141
    v_exp_f32 v142, v142
    v_exp_f32 v143, v143
    s_waitcnt vmcnt(8)
    v_mfma_f32_32x32x16_bf16 v[96:111], v[52:55], v[16:19], 0
    v_exp_f32 v144, v144
    v_exp_f32 v145, v145
    v_exp_f32 v146, v146
    v_exp_f32 v147, v147
    v_mfma_f32_32x32x8_bf16 v[96:111], v[62:63], v[32:33], v[96:111]
    buffer_load_dwordx4 v[48:51], v2, s[16:19], s81 offen offset:0 sc1
    buffer_load_dwordx2 v[60:61], v3, s[16:19], s81 offen offset:1024 sc1
    v_exp_f32 v148, v148
    v_exp_f32 v149, v149
    v_exp_f32 v150, v150
    v_exp_f32 v151, v151
    v_smfmac_f32_32x32x32_bf16 v[192:207], v[84:87], v[136:143], v4
    v_exp_f32 v152, v152
    v_exp_f32 v153, v153
    v_exp_f32 v154, v154
    v_exp_f32 v155, v155
    v_smfmac_f32_32x32x32_bf16 v[208:223], v[80:83], v[144:151], v4
    v_exp_f32 v156, v156
    v_exp_f32 v157, v157
    v_exp_f32 v158, v158
    v_exp_f32 v159, v159
    s_cmp_lg_u32 s28, 0
    s_cbranch_scc1 w0_59
    v_and_b32 v5, 15, v1
    v_lshlrev_b32 v5, 7, v5
    v_add_u32 v5, 4096000, v5
    buffer_load_dword v11, v5, s[16:19], 0 offen sc1
w0_59:
    v_mfma_f32_32x32x16_bf16 v[112:127], v[52:55], v[20:23], 0
    v_exp_f32 v96, v96
    v_exp_f32 v97, v97
    v_exp_f32 v98, v98
    v_exp_f32 v99, v99
    v_mfma_f32_32x32x8_bf16 v[112:127], v[62:63], v[34:35], v[112:127]
    v_exp_f32 v100, v100
    v_exp_f32 v101, v101
    v_exp_f32 v102, v102
    v_exp_f32 v103, v103
    v_smfmac_f32_32x32x32_bf16 v[208:223], v[84:87], v[152:159], v4
    buffer_load_dwordx4 v[80:83], v2, s[16:19], s82 offen offset:0 sc1
    buffer_load_dwordx4 v[84:87], v2, s[16:19], s82 offen offset:1024 sc1
    v_exp_f32 v104, v104
    v_exp_f32 v105, v105
    v_exp_f32 v106, v106
    v_exp_f32 v107, v107
    v_smfmac_f32_32x32x32_bf16 v[160:175], v[88:91], v[96:103], v4
    v_exp_f32 v108, v108
    v_exp_f32 v109, v109
    v_exp_f32 v110, v110
    v_exp_f32 v111, v111
    v_mfma_f32_32x32x16_bf16 v[128:143], v[52:55], v[24:27], 0
    v_exp_f32 v112, v112
    v_exp_f32 v113, v113
    v_exp_f32 v114, v114
    v_exp_f32 v115, v115
    v_mfma_f32_32x32x8_bf16 v[128:143], v[62:63], v[36:37], v[128:143]
    v_exp_f32 v116, v116
    v_exp_f32 v117, v117
    v_exp_f32 v118, v118
    v_exp_f32 v119, v119
    v_smfmac_f32_32x32x32_bf16 v[160:175], v[92:95], v[104:111], v4
    v_exp_f32 v120, v120
    v_exp_f32 v121, v121
    v_exp_f32 v122, v122
    v_exp_f32 v123, v123
    v_smfmac_f32_32x32x32_bf16 v[176:191], v[88:91], v[112:119], v4
    v_exp_f32 v124, v124
    v_exp_f32 v125, v125
    v_exp_f32 v126, v126
    v_exp_f32 v127, v127
    v_mfma_f32_32x32x16_bf16 v[144:159], v[52:55], v[28:31], 0
    v_exp_f32 v128, v128
    v_exp_f32 v129, v129
    v_exp_f32 v130, v130
    v_exp_f32 v131, v131
    v_mfma_f32_32x32x8_bf16 v[144:159], v[62:63], v[38:39], v[144:159]
    v_exp_f32 v132, v132
    v_exp_f32 v133, v133
    v_exp_f32 v134, v134
    v_exp_f32 v135, v135
    v_smfmac_f32_32x32x32_bf16 v[176:191], v[92:95], v[120:127], v4
    v_exp_f32 v136, v136
    v_exp_f32 v137, v137
    v_exp_f32 v138, v138
    v_exp_f32 v139, v139
    v_smfmac_f32_32x32x32_bf16 v[192:207], v[88:91], v[128:135], v4
    v_exp_f32 v140, v140
    v_exp_f32 v141, v141
    v_exp_f32 v142, v142
    v_exp_f32 v143, v143
    s_waitcnt vmcnt(8)
    v_mfma_f32_32x32x16_bf16 v[96:111], v[40:43], v[16:19], 0
    v_exp_f32 v144, v144
    v_exp_f32 v145, v145
    v_exp_f32 v146, v146
    v_exp_f32 v147, v147
    v_mfma_f32_32x32x8_bf16 v[96:111], v[56:57], v[32:33], v[96:111]
    buffer_load_dwordx4 v[52:55], v2, s[16:19], s81 offen offset:1536 sc1
    buffer_load_dwordx2 v[62:63], v3, s[16:19], s81 offen offset:2560 sc1
    v_exp_f32 v148, v148
    v_exp_f32 v149, v149
    v_exp_f32 v150, v150
    v_exp_f32 v151, v151
    v_smfmac_f32_32x32x32_bf16 v[192:207], v[92:95], v[136:143], v4
    v_exp_f32 v152, v152
    v_exp_f32 v153, v153
    v_exp_f32 v154, v154
    v_exp_f32 v155, v155
    v_smfmac_f32_32x32x32_bf16 v[208:223], v[88:91], v[144:151], v4
    v_exp_f32 v156, v156
    v_exp_f32 v157, v157
    v_exp_f32 v158, v158
    v_exp_f32 v159, v159
    s_cmp_lg_u32 s28, 0
    s_cbranch_scc1 w0_60
    s_waitcnt vmcnt(4)
    v_cmp_le_u32 vcc, 16, v11
    s_nop 0
    s_cmp_eq_u64 vcc, exec
    s_cbranch_scc0 e2o_61
    v_mov_b32 v6, 159772
    v_mov_b32 v7, 1
    ds_write_b32 v6, v7
e2o_61:
w0_60:
    v_mfma_f32_32x32x16_bf16 v[112:127], v[40:43], v[20:23], 0
    v_exp_f32 v96, v96
    v_exp_f32 v97, v97
    v_exp_f32 v98, v98
    v_exp_f32 v99, v99
    v_mfma_f32_32x32x8_bf16 v[112:127], v[56:57], v[34:35], v[112:127]
    v_exp_f32 v100, v100
    v_exp_f32 v101, v101
    v_exp_f32 v102, v102
    v_exp_f32 v103, v103
    v_smfmac_f32_32x32x32_bf16 v[208:223], v[92:95], v[152:159], v4
    buffer_load_dwordx4 v[88:91], v2, s[16:19], s82 offen offset:2048 sc1
    buffer_load_dwordx4 v[92:95], v2, s[16:19], s82 offen offset:3072 sc1
    v_lshrrev_b32 v6, 4, v1
    v_lshlrev_b32 v7, 9, v6
    v_and_b32 v8, 15, v1
    v_lshl_add_u32 v0, v8, 4, v7
    s_mul_i32 s81, s79, 278528
    s_lshl_b32 s36, s28, 11
    s_add_u32 s81, s81, s36
    s_add_u32 s81, s81, 4194304
    s_add_u32 s36, s28, 0
    s_and_b32 s37, s36, 1
    s_lshl_b32 s37, s37, 8
    s_bfe_u32 s36, s36, 0x10001
    s_mul_i32 s36, s36, 139264
    s_add_u32 s36, s36, s37
    s_add_u32 s64, s36, s81
    s_add_u32 s36, s28, 1
    s_and_b32 s37, s36, 1
    s_lshl_b32 s37, s37, 8
    s_bfe_u32 s36, s36, 0x10001
    s_mul_i32 s36, s36, 139264
    s_add_u32 s36, s36, s37
    s_add_u32 s65, s36, s81
    s_add_u32 s36, s28, 2
    s_and_b32 s37, s36, 1
    s_lshl_b32 s37, s37, 8
    s_bfe_u32 s36, s36, 0x10001
    s_mul_i32 s36, s36, 139264
    s_add_u32 s36, s36, s37
    s_add_u32 s66, s36, s81
    s_add_u32 s36, s28, 3
    s_and_b32 s37, s36, 1
    s_lshl_b32 s37, s37, 8
    s_bfe_u32 s36, s36, 0x10001
    s_mul_i32 s36, s36, 139264
    s_add_u32 s36, s36, s37
    s_add_u32 s69, s36, s81
    s_mul_i32 s33, s28, 5120
    s_mul_i32 s36, s73, 348160
    s_add_u32 s33, s33, s36
    s_add_u32 s33, s33, 13631488
    s_and_b32 s75, s79, 7
    s_mul_i32 s75, s75, 3
    s_lshr_b32 s75, s75, 1
    s_mul_i32 s36, s31, 3
    s_add_u32 s75, s75, s36
    v_mov_b32 v6, 159772
    ds_read_b32 v7, v6
    v_exp_f32 v104, v104
    v_exp_f32 v105, v105
    v_exp_f32 v106, v106
    v_exp_f32 v107, v107
    v_smfmac_f32_32x32x32_bf16 v[160:175], v[64:67], v[96:103], v4
    v_exp_f32 v108, v108
    v_exp_f32 v109, v109
    v_exp_f32 v110, v110
    v_exp_f32 v111, v111
    v_mfma_f32_32x32x16_bf16 v[128:143], v[40:43], v[24:27], 0
    v_exp_f32 v112, v112
    v_exp_f32 v113, v113
    v_exp_f32 v114, v114
    v_exp_f32 v115, v115
    v_mfma_f32_32x32x8_bf16 v[128:143], v[56:57], v[36:37], v[128:143]
    v_exp_f32 v116, v116
    v_exp_f32 v117, v117
    v_exp_f32 v118, v118
    v_exp_f32 v119, v119
    v_smfmac_f32_32x32x32_bf16 v[160:175], v[68:71], v[104:111], v4
    s_waitcnt vmcnt(0) lgkmcnt(0)
    v_cmp_eq_u32 vcc, 0, v7
    v_exp_f32 v120, v120
    v_exp_f32 v121, v121
    v_exp_f32 v122, v122
    v_exp_f32 v123, v123
    v_smfmac_f32_32x32x32_bf16 v[176:191], v[64:67], v[112:119], v4
    v_exp_f32 v124, v124
    v_exp_f32 v125, v125
    v_exp_f32 v126, v126
    v_exp_f32 v127, v127
    v_mfma_f32_32x32x16_bf16 v[144:159], v[40:43], v[28:31], 0
    v_exp_f32 v128, v128
    v_exp_f32 v129, v129
    v_exp_f32 v130, v130
    v_exp_f32 v131, v131
    v_mfma_f32_32x32x8_bf16 v[144:159], v[56:57], v[38:39], v[144:159]
    v_exp_f32 v132, v132
    v_exp_f32 v133, v133
    v_exp_f32 v134, v134
    v_exp_f32 v135, v135
    v_smfmac_f32_32x32x32_bf16 v[176:191], v[68:71], v[120:127], v4
    s_cbranch_vccnz dsk_62
    s_add_u32 s75, s75, 1
    s_sub_u32 s36, s75, 12
    s_cmp_ge_u32 s75, 12
    s_cselect_b32 s75, s36, s75
    s_lshl_b32 s76, s75, 13
    s_mul_i32 s77, s75, 20480
    s_add_u32 s77, s77, s33
    buffer_load_dwordx4 v[224:227], v2, s[16:19], s77 offen offset:0 sc1
    buffer_load_dwordx4 v[228:231], v2, s[16:19], s77 offen offset:1024 sc1
    buffer_load_dwordx4 v[232:235], v2, s[16:19], s77 offen offset:2048 sc1
dsk_62:
    v_exp_f32 v136, v136
    v_exp_f32 v137, v137
    v_exp_f32 v138, v138
    v_exp_f32 v139, v139
    v_smfmac_f32_32x32x32_bf16 v[192:207], v[64:67], v[128:135], v4
    v_exp_f32 v140, v140
    v_exp_f32 v141, v141
    v_exp_f32 v142, v142
    v_exp_f32 v143, v143
    v_mfma_f32_32x32x16_bf16 v[96:111], v[44:47], v[16:19], 0
    v_exp_f32 v144, v144
    v_exp_f32 v145, v145
    v_exp_f32 v146, v146
    v_exp_f32 v147, v147
    v_mfma_f32_32x32x8_bf16 v[96:111], v[58:59], v[32:33], v[96:111]
    v_exp_f32 v148, v148
    v_exp_f32 v149, v149
    v_exp_f32 v150, v150
    v_exp_f32 v151, v151
    v_smfmac_f32_32x32x32_bf16 v[192:207], v[68:71], v[136:143], v4
    s_cbranch_vccnz dsk_63
    buffer_load_dwordx4 v[236:239], v2, s[16:19], s77 offen offset:3072 sc1
    s_add_u32 s77, s77, 4096
    buffer_load_dwordx4 v[244:247], v2, s[16:19], s77 offen offset:0 sc1
    s_add_u32 s82, s64, s76
    buffer_load_dwordx4 v[248:251], v0, s[16:19], s82 offen sc1
    s_add_u32 s82, s65, s76
    buffer_load_dwordx4 v[40:43], v0, s[16:19], s82 offen sc1
dsk_63:
    v_exp_f32 v152, v152
    v_exp_f32 v153, v153
    v_exp_f32 v154, v154
    v_exp_f32 v155, v155
    v_smfmac_f32_32x32x32_bf16 v[208:223], v[64:67], v[144:151], v4
    v_exp_f32 v156, v156
    v_exp_f32 v157, v157
    v_exp_f32 v158, v158
    v_exp_f32 v159, v159
    v_mfma_f32_32x32x16_bf16 v[112:127], v[44:47], v[20:23], 0
    v_exp_f32 v96, v96
    v_exp_f32 v97, v97
    v_exp_f32 v98, v98
    v_exp_f32 v99, v99
    v_mfma_f32_32x32x8_bf16 v[112:127], v[58:59], v[34:35], v[112:127]
    v_exp_f32 v100, v100
    v_exp_f32 v101, v101
    v_exp_f32 v102, v102
    v_exp_f32 v103, v103
    v_smfmac_f32_32x32x32_bf16 v[208:223], v[68:71], v[152:159], v4
    s_cbranch_vccnz dsk_64
    s_add_u32 s82, s66, s76
    buffer_load_dwordx4 v[64:67], v0, s[16:19], s82 offen sc1
    s_add_u32 s82, s69, s76
    buffer_load_dwordx4 v[68:71], v0, s[16:19], s82 offen sc1
dsk_64:
    v_exp_f32 v104, v104
    v_exp_f32 v105, v105
    v_exp_f32 v106, v106
    v_exp_f32 v107, v107
    v_smfmac_f32_32x32x32_bf16 v[160:175], v[72:75], v[96:103], v4
    v_exp_f32 v108, v108
    v_exp_f32 v109, v109
    v_exp_f32 v110, v110
    v_exp_f32 v111, v111
    v_mfma_f32_32x32x16_bf16 v[128:143], v[44:47], v[24:27], 0
    v_exp_f32 v112, v112
    v_exp_f32 v113, v113
    v_exp_f32 v114, v114
    v_exp_f32 v115, v115
    v_mfma_f32_32x32x8_bf16 v[128:143], v[58:59], v[36:37], v[128:143]
    v_exp_f32 v116, v116
    v_exp_f32 v117, v117
    v_exp_f32 v118, v118
    v_exp_f32 v119, v119
    v_smfmac_f32_32x32x32_bf16 v[160:175], v[76:79], v[104:111], v4
    v_exp_f32 v120, v120
    v_exp_f32 v121, v121
    v_exp_f32 v122, v122
    v_exp_f32 v123, v123
    v_smfmac_f32_32x32x32_bf16 v[176:191], v[72:75], v[112:119], v4
    v_exp_f32 v124, v124
    v_exp_f32 v125, v125
    v_exp_f32 v126, v126
    v_exp_f32 v127, v127
    v_mfma_f32_32x32x16_bf16 v[144:159], v[44:47], v[28:31], 0
    v_exp_f32 v128, v128
    v_exp_f32 v129, v129
    v_exp_f32 v130, v130
    v_exp_f32 v131, v131
    v_mfma_f32_32x32x8_bf16 v[144:159], v[58:59], v[38:39], v[144:159]
    v_exp_f32 v132, v132
    v_exp_f32 v133, v133
    v_exp_f32 v134, v134
    v_exp_f32 v135, v135
    v_smfmac_f32_32x32x32_bf16 v[176:191], v[76:79], v[120:127], v4
    v_exp_f32 v136, v136
    v_exp_f32 v137, v137
    v_exp_f32 v138, v138
    v_exp_f32 v139, v139
    v_smfmac_f32_32x32x32_bf16 v[192:207], v[72:75], v[128:135], v4
    v_exp_f32 v140, v140
    v_exp_f32 v141, v141
    v_exp_f32 v142, v142
    v_exp_f32 v143, v143
    v_mfma_f32_32x32x16_bf16 v[96:111], v[48:51], v[16:19], 0
    v_exp_f32 v144, v144
    v_exp_f32 v145, v145
    v_exp_f32 v146, v146
    v_exp_f32 v147, v147
    v_mfma_f32_32x32x8_bf16 v[96:111], v[60:61], v[32:33], v[96:111]
    v_exp_f32 v148, v148
    v_exp_f32 v149, v149
    v_exp_f32 v150, v150
    v_exp_f32 v151, v151
    v_smfmac_f32_32x32x32_bf16 v[192:207], v[76:79], v[136:143], v4
    s_cbranch_vccnz dsk_65
    s_add_u32 s75, s75, 1
    s_sub_u32 s36, s75, 12
    s_cmp_ge_u32 s75, 12
    s_cselect_b32 s75, s36, s75
    s_lshl_b32 s76, s75, 13
    s_mul_i32 s77, s75, 20480
    s_add_u32 s77, s77, s33
    buffer_load_dwordx4 v[44:47], v2, s[16:19], s77 offen offset:0 sc1
dsk_65:
    v_exp_f32 v152, v152
    v_exp_f32 v153, v153
    v_exp_f32 v154, v154
    v_exp_f32 v155, v155
    v_smfmac_f32_32x32x32_bf16 v[208:223], v[72:75], v[144:151], v4
    v_exp_f32 v156, v156
    v_exp_f32 v157, v157
    v_exp_f32 v158, v158
    v_exp_f32 v159, v159
    v_mfma_f32_32x32x16_bf16 v[112:127], v[48:51], v[20:23], 0
    v_exp_f32 v96, v96
    v_exp_f32 v97, v97
    v_exp_f32 v98, v98
    v_exp_f32 v99, v99
    v_mfma_f32_32x32x8_bf16 v[112:127], v[60:61], v[34:35], v[112:127]
    v_exp_f32 v100, v100
    v_exp_f32 v101, v101
    v_exp_f32 v102, v102
    v_exp_f32 v103, v103
    v_smfmac_f32_32x32x32_bf16 v[208:223], v[76:79], v[152:159], v4
    s_cbranch_vccnz dsk_66
    buffer_load_dwordx4 v[72:75], v2, s[16:19], s77 offen offset:1024 sc1
    buffer_load_dwordx4 v[76:79], v2, s[16:19], s77 offen offset:2048 sc1
dsk_66:
    v_exp_f32 v104, v104
    v_exp_f32 v105, v105
    v_exp_f32 v106, v106
    v_exp_f32 v107, v107
    v_smfmac_f32_32x32x32_bf16 v[160:175], v[80:83], v[96:103], v4
    v_exp_f32 v108, v108
    v_exp_f32 v109, v109
    v_exp_f32 v110, v110
    v_exp_f32 v111, v111
    v_mfma_f32_32x32x16_bf16 v[128:143], v[48:51], v[24:27], 0
    v_exp_f32 v112, v112
    v_exp_f32 v113, v113
    v_exp_f32 v114, v114
    v_exp_f32 v115, v115
    v_mfma_f32_32x32x8_bf16 v[128:143], v[60:61], v[36:37], v[128:143]
    v_exp_f32 v116, v116
    v_exp_f32 v117, v117
    v_exp_f32 v118, v118
    v_exp_f32 v119, v119
    v_smfmac_f32_32x32x32_bf16 v[160:175], v[84:87], v[104:111], v4
    v_exp_f32 v120, v120
    v_exp_f32 v121, v121
    v_exp_f32 v122, v122
    v_exp_f32 v123, v123
    v_smfmac_f32_32x32x32_bf16 v[176:191], v[80:83], v[112:119], v4
    v_exp_f32 v124, v124
    v_exp_f32 v125, v125
    v_exp_f32 v126, v126
    v_exp_f32 v127, v127
    v_mfma_f32_32x32x16_bf16 v[144:159], v[48:51], v[28:31], 0
    v_exp_f32 v128, v128
    v_exp_f32 v129, v129
    v_exp_f32 v130, v130
    v_exp_f32 v131, v131
    v_mfma_f32_32x32x8_bf16 v[144:159], v[60:61], v[38:39], v[144:159]
    v_exp_f32 v132, v132
    v_exp_f32 v133, v133
    v_exp_f32 v134, v134
    v_exp_f32 v135, v135
    v_smfmac_f32_32x32x32_bf16 v[176:191], v[84:87], v[120:127], v4
    v_exp_f32 v136, v136
    v_exp_f32 v137, v137
    v_exp_f32 v138, v138
    v_exp_f32 v139, v139
    v_smfmac_f32_32x32x32_bf16 v[192:207], v[80:83], v[128:135], v4
    v_exp_f32 v140, v140
    v_exp_f32 v141, v141
    v_exp_f32 v142, v142
    v_exp_f32 v143, v143
    v_mfma_f32_32x32x16_bf16 v[96:111], v[52:55], v[16:19], 0
    v_exp_f32 v144, v144
    v_exp_f32 v145, v145
    v_exp_f32 v146, v146
    v_exp_f32 v147, v147
    v_mfma_f32_32x32x8_bf16 v[96:111], v[62:63], v[32:33], v[96:111]
    v_exp_f32 v148, v148
    v_exp_f32 v149, v149
    v_exp_f32 v150, v150
    v_exp_f32 v151, v151
    v_smfmac_f32_32x32x32_bf16 v[192:207], v[84:87], v[136:143], v4
    s_cbranch_vccnz dsk_67
    buffer_load_dwordx4 v[48:51], v2, s[16:19], s77 offen offset:3072 sc1
dsk_67:
    v_exp_f32 v152, v152
    v_exp_f32 v153, v153
    v_exp_f32 v154, v154
    v_exp_f32 v155, v155
    v_smfmac_f32_32x32x32_bf16 v[208:223], v[80:83], v[144:151], v4
    v_exp_f32 v156, v156
    v_exp_f32 v157, v157
    v_exp_f32 v158, v158
    v_exp_f32 v159, v159
    v_mfma_f32_32x32x16_bf16 v[112:127], v[52:55], v[20:23], 0
    v_exp_f32 v96, v96
    v_exp_f32 v97, v97
    v_exp_f32 v98, v98
    v_exp_f32 v99, v99
    v_mfma_f32_32x32x8_bf16 v[112:127], v[62:63], v[34:35], v[112:127]
    v_exp_f32 v100, v100
    v_exp_f32 v101, v101
    v_exp_f32 v102, v102
    v_exp_f32 v103, v103
    v_smfmac_f32_32x32x32_bf16 v[208:223], v[84:87], v[152:159], v4
    s_cbranch_vccnz dsk_68
    s_add_u32 s77, s77, 4096
    buffer_load_dwordx4 v[80:83], v2, s[16:19], s77 offen offset:0 sc1
    s_add_u32 s82, s64, s76
    buffer_load_dwordx4 v[84:87], v0, s[16:19], s82 offen sc1
dsk_68:
    v_exp_f32 v104, v104
    v_exp_f32 v105, v105
    v_exp_f32 v106, v106
    v_exp_f32 v107, v107
    v_smfmac_f32_32x32x32_bf16 v[160:175], v[88:91], v[96:103], v4
    v_exp_f32 v108, v108
    v_exp_f32 v109, v109
    v_exp_f32 v110, v110
    v_exp_f32 v111, v111
    v_mfma_f32_32x32x16_bf16 v[128:143], v[52:55], v[24:27], 0
    v_exp_f32 v112, v112
    v_exp_f32 v113, v113
    v_exp_f32 v114, v114
    v_exp_f32 v115, v115
    v_mfma_f32_32x32x8_bf16 v[128:143], v[62:63], v[36:37], v[128:143]
    v_exp_f32 v116, v116
    v_exp_f32 v117, v117
    v_exp_f32 v118, v118
    v_exp_f32 v119, v119
    v_smfmac_f32_32x32x32_bf16 v[160:175], v[92:95], v[104:111], v4
    v_exp_f32 v120, v120
    v_exp_f32 v121, v121
    v_exp_f32 v122, v122
    v_exp_f32 v123, v123
    v_smfmac_f32_32x32x32_bf16 v[176:191], v[88:91], v[112:119], v4
    v_exp_f32 v124, v124
    v_exp_f32 v125, v125
    v_exp_f32 v126, v126
    v_exp_f32 v127, v127
    v_mfma_f32_32x32x16_bf16 v[144:159], v[52:55], v[28:31], 0
    v_exp_f32 v128, v128
    v_exp_f32 v129, v129
    v_exp_f32 v130, v130
    v_exp_f32 v131, v131
    v_mfma_f32_32x32x8_bf16 v[144:159], v[62:63], v[38:39], v[144:159]
    v_exp_f32 v132, v132
    v_exp_f32 v133, v133
    v_exp_f32 v134, v134
    v_exp_f32 v135, v135
    v_smfmac_f32_32x32x32_bf16 v[176:191], v[92:95], v[120:127], v4
    v_exp_f32 v136, v136
    v_exp_f32 v137, v137
    v_exp_f32 v138, v138
    v_exp_f32 v139, v139
    v_smfmac_f32_32x32x32_bf16 v[192:207], v[88:91], v[128:135], v4
    v_exp_f32 v140, v140
    v_exp_f32 v141, v141
    v_exp_f32 v142, v142
    v_exp_f32 v143, v143
    v_exp_f32 v144, v144
    v_exp_f32 v145, v145
    v_exp_f32 v146, v146
    v_exp_f32 v147, v147
    v_exp_f32 v148, v148
    v_exp_f32 v149, v149
    v_exp_f32 v150, v150
    v_exp_f32 v151, v151
    v_smfmac_f32_32x32x32_bf16 v[192:207], v[92:95], v[136:143], v4
    s_cbranch_vccnz dsk_69
    s_add_u32 s82, s65, s76
    buffer_load_dwordx4 v[52:55], v0, s[16:19], s82 offen sc1
    s_add_u32 s82, s66, s76
    buffer_load_dwordx4 v[56:59], v0, s[16:19], s82 offen sc1
    s_add_u32 s82, s69, s76
    buffer_load_dwordx4 v[60:63], v0, s[16:19], s82 offen sc1
dsk_69:
    v_exp_f32 v152, v152
    v_exp_f32 v153, v153
    v_exp_f32 v154, v154
    v_exp_f32 v155, v155
    v_smfmac_f32_32x32x32_bf16 v[208:223], v[88:91], v[144:151], v4
    v_exp_f32 v156, v156
    v_exp_f32 v157, v157
    v_exp_f32 v158, v158
    v_exp_f32 v159, v159
    s_branch e_done
a_lpre:
    s_lshl_b32 s36, s74, 12
    s_add_u32 s36, s36, 131072
    v_add_u32 v242, s36, v2
    s_waitcnt lgkmcnt(0)
    s_waitcnt vmcnt(10)
    v_mfma_f32_32x32x16_bf16 v[112:127], v[40:43], v[20:23], 0
    v_exp_f32 v96, v96
    v_exp_f32 v97, v97
    v_exp_f32 v98, v98
    v_exp_f32 v99, v99
    v_mfma_f32_32x32x8_bf16 v[112:127], v[56:57], v[34:35], v[112:127]
    buffer_store_dwordx4 v[224:227], v2, s[16:19], s33 offen offset:0 sc1
    ds_read_b128 v[244:247], v242 offset:0
    v_exp_f32 v100, v100
    v_exp_f32 v101, v101
    v_exp_f32 v102, v102
    v_exp_f32 v103, v103
    buffer_load_dwordx4 v[88:91], v2, s[16:19], s82 offen offset:2048 sc1
    buffer_load_dwordx4 v[92:95], v2, s[16:19], s82 offen offset:3072 sc1
    v_exp_f32 v104, v104
    v_exp_f32 v105, v105
    v_exp_f32 v106, v106
    v_exp_f32 v107, v107
    s_waitcnt vmcnt(11)
    v_smfmac_f32_32x32x32_bf16 v[160:175], v[64:67], v[96:103], v4
    v_exp_f32 v108, v108
    v_exp_f32 v109, v109
    v_exp_f32 v110, v110
    v_exp_f32 v111, v111
    s_waitcnt vmcnt(9)
    v_mfma_f32_32x32x16_bf16 v[128:143], v[40:43], v[24:27], 0
    v_exp_f32 v112, v112
    v_exp_f32 v113, v113
    v_exp_f32 v114, v114
    v_exp_f32 v115, v115
    v_mfma_f32_32x32x8_bf16 v[128:143], v[56:57], v[36:37], v[128:143]
    s_waitcnt lgkmcnt(0)
    buffer_store_dwordx4 v[244:247], v2, s[16:19], s33 offen offset:2048 sc1
    v_exp_f32 v116, v116
    v_exp_f32 v117, v117
    v_exp_f32 v118, v118
    v_exp_f32 v119, v119
    v_smfmac_f32_32x32x32_bf16 v[160:175], v[68:71], v[104:111], v4
    v_exp_f32 v120, v120
    v_exp_f32 v121, v121
    v_exp_f32 v122, v122
    v_exp_f32 v123, v123
    v_smfmac_f32_32x32x32_bf16 v[176:191], v[64:67], v[112:119], v4
    v_exp_f32 v124, v124
    v_exp_f32 v125, v125
    v_exp_f32 v126, v126
    v_exp_f32 v127, v127
    s_waitcnt vmcnt(8)
    v_mfma_f32_32x32x16_bf16 v[144:159], v[40:43], v[28:31], 0
    v_exp_f32 v128, v128
    v_exp_f32 v129, v129
    v_exp_f32 v130, v130
    v_exp_f32 v131, v131
    v_mfma_f32_32x32x8_bf16 v[144:159], v[56:57], v[38:39], v[144:159]
    buffer_store_dwordx4 v[228:231], v2, s[16:19], s34 offen offset:0 sc1
    ds_read_b128 v[244:247], v242 offset:1024
    v_exp_f32 v132, v132
    v_exp_f32 v133, v133
    v_exp_f32 v134, v134
    v_exp_f32 v135, v135
    v_smfmac_f32_32x32x32_bf16 v[176:191], v[68:71], v[120:127], v4
    v_exp_f32 v136, v136
    v_exp_f32 v137, v137
    v_exp_f32 v138, v138
    v_exp_f32 v139, v139
    v_smfmac_f32_32x32x32_bf16 v[192:207], v[64:67], v[128:135], v4
    v_exp_f32 v140, v140
    v_exp_f32 v141, v141
    v_exp_f32 v142, v142
    v_exp_f32 v143, v143
    s_waitcnt vmcnt(7)
    v_mfma_f32_32x32x16_bf16 v[96:111], v[44:47], v[16:19], 0
    v_exp_f32 v144, v144
    v_exp_f32 v145, v145
    v_exp_f32 v146, v146
    v_exp_f32 v147, v147
    v_mfma_f32_32x32x8_bf16 v[96:111], v[58:59], v[32:33], v[96:111]
    s_add_u32 s75, s75, 6144
    s_add_u32 s81, s75, 3072
    buffer_load_dwordx4 v[40:43], v2, s[16:19], s75 offen offset:0 sc1
    buffer_load_dwordx2 v[56:57], v3, s[16:19], s75 offen offset:1024 sc1
    s_waitcnt lgkmcnt(0)
    buffer_store_dwordx4 v[244:247], v2, s[16:19], s34 offen offset:2048 sc1
    v_exp_f32 v148, v148
    v_exp_f32 v149, v149
    v_exp_f32 v150, v150
    v_exp_f32 v151, v151
    v_smfmac_f32_32x32x32_bf16 v[192:207], v[68:71], v[136:143], v4
    v_exp_f32 v152, v152
    v_exp_f32 v153, v153
    v_exp_f32 v154, v154
    v_exp_f32 v155, v155
    v_smfmac_f32_32x32x32_bf16 v[208:223], v[64:67], v[144:151], v4
    v_exp_f32 v156, v156
    v_exp_f32 v157, v157
    v_exp_f32 v158, v158
    v_exp_f32 v159, v159
    v_mfma_f32_32x32x16_bf16 v[112:127], v[44:47], v[20:23], 0
    v_exp_f32 v96, v96
    v_exp_f32 v97, v97
    v_exp_f32 v98, v98
    v_exp_f32 v99, v99
    v_mfma_f32_32x32x8_bf16 v[112:127], v[58:59], v[34:35], v[112:127]
    buffer_store_dwordx4 v[232:235], v2, s[16:19], s33 offen offset:1024 sc1
    ds_read_b128 v[244:247], v242 offset:2048
    v_exp_f32 v100, v100
    v_exp_f32 v101, v101
    v_exp_f32 v102, v102
    v_exp_f32 v103, v103
    v_smfmac_f32_32x32x32_bf16 v[208:223], v[68:71], v[152:159], v4
    s_add_u32 s76, s76, 8192
    s_add_u32 s82, s76, 4096
    buffer_load_dwordx4 v[64:67], v2, s[16:19], s76 offen offset:0 sc1
    buffer_load_dwordx4 v[68:71], v2, s[16:19], s76 offen offset:1024 sc1
    v_exp_f32 v104, v104
    v_exp_f32 v105, v105
    v_exp_f32 v106, v106
    v_exp_f32 v107, v107
    v_smfmac_f32_32x32x32_bf16 v[160:175], v[72:75], v[96:103], v4
    v_exp_f32 v108, v108
    v_exp_f32 v109, v109
    v_exp_f32 v110, v110
    v_exp_f32 v111, v111
    v_mfma_f32_32x32x16_bf16 v[128:143], v[44:47], v[24:27], 0
    v_exp_f32 v112, v112
    v_exp_f32 v113, v113
    v_exp_f32 v114, v114
    v_exp_f32 v115, v115
    v_mfma_f32_32x32x8_bf16 v[128:143], v[58:59], v[36:37], v[128:143]
    s_waitcnt lgkmcnt(0)
    buffer_store_dwordx4 v[244:247], v2, s[16:19], s33 offen offset:3072 sc1
    v_exp_f32 v116, v116
    v_exp_f32 v117, v117
    v_exp_f32 v118, v118
    v_exp_f32 v119, v119
    v_smfmac_f32_32x32x32_bf16 v[160:175], v[76:79], v[104:111], v4
    v_exp_f32 v120, v120
    v_exp_f32 v121, v121
    v_exp_f32 v122, v122
    v_exp_f32 v123, v123
    v_smfmac_f32_32x32x32_bf16 v[176:191], v[72:75], v[112:119], v4
    v_exp_f32 v124, v124
    v_exp_f32 v125, v125
    v_exp_f32 v126, v126
    v_exp_f32 v127, v127
    v_mfma_f32_32x32x16_bf16 v[144:159], v[44:47], v[28:31], 0
    v_exp_f32 v128, v128
    v_exp_f32 v129, v129
    v_exp_f32 v130, v130
    v_exp_f32 v131, v131
    v_mfma_f32_32x32x8_bf16 v[144:159], v[58:59], v[38:39], v[144:159]
    buffer_store_dwordx4 v[236:239], v2, s[16:19], s34 offen offset:1024 sc1
    ds_read_b128 v[244:247], v242 offset:3072
    v_exp_f32 v132, v132
    v_exp_f32 v133, v133
    v_exp_f32 v134, v134
    v_exp_f32 v135, v135
    v_smfmac_f32_32x32x32_bf16 v[176:191], v[76:79], v[120:127], v4
    v_exp_f32 v136, v136
    v_exp_f32 v137, v137
    v_exp_f32 v138, v138
    v_exp_f32 v139, v139
    v_smfmac_f32_32x32x32_bf16 v[192:207], v[72:75], v[128:135], v4
    v_exp_f32 v140, v140
    v_exp_f32 v141, v141
    v_exp_f32 v142, v142
    v_exp_f32 v143, v143
    s_waitcnt vmcnt(13)
    v_mfma_f32_32x32x16_bf16 v[96:111], v[48:51], v[16:19], 0
    v_exp_f32 v144, v144
    v_exp_f32 v145, v145
    v_exp_f32 v146, v146
    v_exp_f32 v147, v147
    v_mfma_f32_32x32x8_bf16 v[96:111], v[60:61], v[32:33], v[96:111]
    buffer_load_dwordx4 v[44:47], v2, s[16:19], s75 offen offset:1536 sc1
    buffer_load_dwordx2 v[58:59], v3, s[16:19], s75 offen offset:2560 sc1
    s_waitcnt lgkmcnt(0)
    buffer_store_dwordx4 v[244:247], v2, s[16:19], s34 offen offset:3072 sc1
    v_exp_f32 v148, v148
    v_exp_f32 v149, v149
    v_exp_f32 v150, v150
    v_exp_f32 v151, v151
    v_smfmac_f32_32x32x32_bf16 v[192:207], v[76:79], v[136:143], v4
    v_exp_f32 v152, v152
    v_exp_f32 v153, v153
    v_exp_f32 v154, v154
    v_exp_f32 v155, v155
    v_smfmac_f32_32x32x32_bf16 v[208:223], v[72:75], v[144:151], v4
    v_exp_f32 v156, v156
    v_exp_f32 v157, v157
    v_exp_f32 v158, v158
    v_exp_f32 v159, v159
    v_mfma_f32_32x32x16_bf16 v[112:127], v[48:51], v[20:23], 0
    v_exp_f32 v96, v96
    v_exp_f32 v97, v97
    v_exp_f32 v98, v98
    v_exp_f32 v99, v99
    v_mfma_f32_32x32x8_bf16 v[112:127], v[60:61], v[34:35], v[112:127]
    buffer_store_dwordx4 v[248:251], v2, s[16:19], s93 offen sc1
    s_mov_b32 exec_hi, 0
    buffer_store_dwordx2 v[248:249], v2, s[16:19], s92 offen sc1
    s_mov_b32 exec_hi, -1
    v_exp_f32 v100, v100
    v_exp_f32 v101, v101
    v_exp_f32 v102, v102
    v_exp_f32 v103, v103
    v_smfmac_f32_32x32x32_bf16 v[208:223], v[76:79], v[152:159], v4
    buffer_load_dwordx4 v[72:75], v2, s[16:19], s76 offen offset:2048 sc1
    buffer_load_dwordx4 v[76:79], v2, s[16:19], s76 offen offset:3072 sc1
    v_exp_f32 v104, v104
    v_exp_f32 v105, v105
    v_exp_f32 v106, v106
    v_exp_f32 v107, v107
    v_smfmac_f32_32x32x32_bf16 v[160:175], v[80:83], v[96:103], v4
    v_exp_f32 v108, v108
    v_exp_f32 v109, v109
    v_exp_f32 v110, v110
    v_exp_f32 v111, v111
    v_mfma_f32_32x32x16_bf16 v[128:143], v[48:51], v[24:27], 0
    v_exp_f32 v112, v112
    v_exp_f32 v113, v113
    v_exp_f32 v114, v114
    v_exp_f32 v115, v115
    v_mfma_f32_32x32x8_bf16 v[128:143], v[60:61], v[36:37], v[128:143]
    v_exp_f32 v116, v116
    v_exp_f32 v117, v117
    v_exp_f32 v118, v118
    v_exp_f32 v119, v119
    v_smfmac_f32_32x32x32_bf16 v[160:175], v[84:87], v[104:111], v4
    v_exp_f32 v120, v120
    v_exp_f32 v121, v121
    v_exp_f32 v122, v122
    v_exp_f32 v123, v123
    v_smfmac_f32_32x32x32_bf16 v[176:191], v[80:83], v[112:119], v4
    v_exp_f32 v124, v124
    v_exp_f32 v125, v125
    v_exp_f32 v126, v126
    v_exp_f32 v127, v127
    v_mfma_f32_32x32x16_bf16 v[144:159], v[48:51], v[28:31], 0
    v_exp_f32 v128, v128
    v_exp_f32 v129, v129
    v_exp_f32 v130, v130
    v_exp_f32 v131, v131
    v_mfma_f32_32x32x8_bf16 v[144:159], v[60:61], v[38:39], v[144:159]
    v_exp_f32 v132, v132
    v_exp_f32 v133, v133
    v_exp_f32 v134, v134
    v_exp_f32 v135, v135
    v_smfmac_f32_32x32x32_bf16 v[176:191], v[84:87], v[120:127], v4
    v_exp_f32 v136, v136
    v_exp_f32 v137, v137
    v_exp_f32 v138, v138
    v_exp_f32 v139, v139
    v_smfmac_f32_32x32x32_bf16 v[192:207], v[80:83], v[128:135], v4
    v_exp_f32 v140, v140
    v_exp_f32 v141, v141
    v_exp_f32 v142, v142
    v_exp_f32 v143, v143
    s_waitcnt vmcnt(17)
    v_mfma_f32_32x32x16_bf16 v[96:111], v[52:55], v[16:19], 0
    v_exp_f32 v144, v144
    v_exp_f32 v145, v145
    v_exp_f32 v146, v146
    v_exp_f32 v147, v147
    v_mfma_f32_32x32x8_bf16 v[96:111], v[62:63], v[32:33], v[96:111]
    buffer_load_dwordx4 v[48:51], v2, s[16:19], s81 offen offset:0 sc1
    buffer_load_dwordx2 v[60:61], v3, s[16:19], s81 offen offset:1024 sc1
    v_exp_f32 v148, v148
    v_exp_f32 v149, v149
    v_exp_f32 v150, v150
    v_exp_f32 v151, v151
    v_smfmac_f32_32x32x32_bf16 v[192:207], v[84:87], v[136:143], v4
    v_exp_f32 v152, v152
    v_exp_f32 v153, v153
    v_exp_f32 v154, v154
    v_exp_f32 v155, v155
    v_smfmac_f32_32x32x32_bf16 v[208:223], v[80:83], v[144:151], v4
    v_exp_f32 v156, v156
    v_exp_f32 v157, v157
    v_exp_f32 v158, v158
    v_exp_f32 v159, v159
    v_mfma_f32_32x32x16_bf16 v[112:127], v[52:55], v[20:23], 0
    v_exp_f32 v96, v96
    v_exp_f32 v97, v97
    v_exp_f32 v98, v98
    v_exp_f32 v99, v99
    v_mfma_f32_32x32x8_bf16 v[112:127], v[62:63], v[34:35], v[112:127]
    v_exp_f32 v100, v100
    v_exp_f32 v101, v101
    v_exp_f32 v102, v102
    v_exp_f32 v103, v103
    v_smfmac_f32_32x32x32_bf16 v[208:223], v[84:87], v[152:159], v4
    buffer_load_dwordx4 v[80:83], v2, s[16:19], s82 offen offset:0 sc1
    buffer_load_dwordx4 v[84:87], v2, s[16:19], s82 offen offset:1024 sc1
    v_exp_f32 v104, v104
    v_exp_f32 v105, v105
    v_exp_f32 v106, v106
    v_exp_f32 v107, v107
    v_smfmac_f32_32x32x32_bf16 v[160:175], v[88:91], v[96:103], v4
    v_exp_f32 v108, v108
    v_exp_f32 v109, v109
    v_exp_f32 v110, v110
    v_exp_f32 v111, v111
    v_mfma_f32_32x32x16_bf16 v[128:143], v[52:55], v[24:27], 0
    v_exp_f32 v112, v112
    v_exp_f32 v113, v113
    v_exp_f32 v114, v114
    v_exp_f32 v115, v115
    v_mfma_f32_32x32x8_bf16 v[128:143], v[62:63], v[36:37], v[128:143]
    v_exp_f32 v116, v116
    v_exp_f32 v117, v117
    v_exp_f32 v118, v118
    v_exp_f32 v119, v119
    v_smfmac_f32_32x32x32_bf16 v[160:175], v[92:95], v[104:111], v4
    v_exp_f32 v120, v120
    v_exp_f32 v121, v121
    v_exp_f32 v122, v122
    v_exp_f32 v123, v123
    v_smfmac_f32_32x32x32_bf16 v[176:191], v[88:91], v[112:119], v4
    v_exp_f32 v124, v124
    v_exp_f32 v125, v125
    v_exp_f32 v126, v126
    v_exp_f32 v127, v127
    v_mfma_f32_32x32x16_bf16 v[144:159], v[52:55], v[28:31], 0
    v_exp_f32 v128, v128
    v_exp_f32 v129, v129
    v_exp_f32 v130, v130
    v_exp_f32 v131, v131
    v_mfma_f32_32x32x8_bf16 v[144:159], v[62:63], v[38:39], v[144:159]
    v_exp_f32 v132, v132
    v_exp_f32 v133, v133
    v_exp_f32 v134, v134
    v_exp_f32 v135, v135
    v_smfmac_f32_32x32x32_bf16 v[176:191], v[92:95], v[120:127], v4
    v_exp_f32 v136, v136
    v_exp_f32 v137, v137
    v_exp_f32 v138, v138
    v_exp_f32 v139, v139
    v_smfmac_f32_32x32x32_bf16 v[192:207], v[88:91], v[128:135], v4
    v_exp_f32 v140, v140
    v_exp_f32 v141, v141
    v_exp_f32 v142, v142
    v_exp_f32 v143, v143
    s_waitcnt vmcnt(13)
    v_mfma_f32_32x32x16_bf16 v[96:111], v[40:43], v[16:19], 0
    v_exp_f32 v144, v144
    v_exp_f32 v145, v145
    v_exp_f32 v146, v146
    v_exp_f32 v147, v147
    v_mfma_f32_32x32x8_bf16 v[96:111], v[56:57], v[32:33], v[96:111]
    buffer_load_dwordx4 v[52:55], v2, s[16:19], s81 offen offset:1536 sc1
    buffer_load_dwordx2 v[62:63], v3, s[16:19], s81 offen offset:2560 sc1
    v_exp_f32 v148, v148
    v_exp_f32 v149, v149
    v_exp_f32 v150, v150
    v_exp_f32 v151, v151
    v_smfmac_f32_32x32x32_bf16 v[192:207], v[92:95], v[136:143], v4
    v_exp_f32 v152, v152
    v_exp_f32 v153, v153
    v_exp_f32 v154, v154
    v_exp_f32 v155, v155
    v_smfmac_f32_32x32x32_bf16 v[208:223], v[88:91], v[144:151], v4
    v_exp_f32 v156, v156
    v_exp_f32 v157, v157
    v_exp_f32 v158, v158
    v_exp_f32 v159, v159
    s_waitcnt vmcnt(8)
    v_mov_b32 v6, 159768
    v_mov_b32 v7, 1
    s_mov_b64 exec, 1
    ds_add_rtn_u32 v7, v6, v7
    s_waitcnt lgkmcnt(0)
    v_readfirstlane_b32 s36, v7
    s_mov_b64 exec, -1
    s_nop 3
    s_cmp_lg_u32 s36, 7
    s_cbranch_scc1 arr_70
    s_and_b32 s36, s2, 15
    s_lshl_b32 s36, s36, 7
    v_mov_b32 v8, 4096000
    v_mov_b32 v9, 1
    s_mov_b64 exec, 1
    buffer_atomic_add v9, v8, s[16:19], s36 offen sc1
    s_mov_b64 exec, -1
arr_70:
    s_setprio 0
    v_mfma_f32_32x32x16_bf16 v[112:127], v[40:43], v[20:23], 0
    v_exp_f32 v96, v96
    v_exp_f32 v97, v97
    v_exp_f32 v98, v98
    v_exp_f32 v99, v99
    v_mfma_f32_32x32x8_bf16 v[112:127], v[56:57], v[34:35], v[112:127]
    v_exp_f32 v100, v100
    v_exp_f32 v101, v101
    v_exp_f32 v102, v102
    v_exp_f32 v103, v103
    v_smfmac_f32_32x32x32_bf16 v[208:223], v[92:95], v[152:159], v4
    buffer_load_dwordx4 v[88:91], v2, s[16:19], s82 offen offset:2048 sc1
    buffer_load_dwordx4 v[92:95], v2, s[16:19], s82 offen offset:3072 sc1
    v_exp_f32 v104, v104
    v_exp_f32 v105, v105
    v_exp_f32 v106, v106
    v_exp_f32 v107, v107
    v_smfmac_f32_32x32x32_bf16 v[160:175], v[64:67], v[96:103], v4
    v_exp_f32 v108, v108
    v_exp_f32 v109, v109
    v_exp_f32 v110, v110
    v_exp_f32 v111, v111
    v_mfma_f32_32x32x16_bf16 v[128:143], v[40:43], v[24:27], 0
    v_exp_f32 v112, v112
    v_exp_f32 v113, v113
    v_exp_f32 v114, v114
    v_exp_f32 v115, v115
    v_mfma_f32_32x32x8_bf16 v[128:143], v[56:57], v[36:37], v[128:143]
    v_exp_f32 v116, v116
    v_exp_f32 v117, v117
    v_exp_f32 v118, v118
    v_exp_f32 v119, v119
    v_smfmac_f32_32x32x32_bf16 v[160:175], v[68:71], v[104:111], v4
    v_exp_f32 v120, v120
    v_exp_f32 v121, v121
    v_exp_f32 v122, v122
    v_exp_f32 v123, v123
    v_smfmac_f32_32x32x32_bf16 v[176:191], v[64:67], v[112:119], v4
    v_exp_f32 v124, v124
    v_exp_f32 v125, v125
    v_exp_f32 v126, v126
    v_exp_f32 v127, v127
    v_mfma_f32_32x32x16_bf16 v[144:159], v[40:43], v[28:31], 0
    v_exp_f32 v128, v128
    v_exp_f32 v129, v129
    v_exp_f32 v130, v130
    v_exp_f32 v131, v131
    v_mfma_f32_32x32x8_bf16 v[144:159], v[56:57], v[38:39], v[144:159]
    v_exp_f32 v132, v132
    v_exp_f32 v133, v133
    v_exp_f32 v134, v134
    v_exp_f32 v135, v135
    v_smfmac_f32_32x32x32_bf16 v[176:191], v[68:71], v[120:127], v4
    v_exp_f32 v136, v136
    v_exp_f32 v137, v137
    v_exp_f32 v138, v138
    v_exp_f32 v139, v139
    v_smfmac_f32_32x32x32_bf16 v[192:207], v[64:67], v[128:135], v4
    v_exp_f32 v140, v140
    v_exp_f32 v141, v141
    v_exp_f32 v142, v142
    v_exp_f32 v143, v143
    s_waitcnt vmcnt(8)
    v_mfma_f32_32x32x16_bf16 v[96:111], v[44:47], v[16:19], 0
    v_exp_f32 v144, v144
    v_exp_f32 v145, v145
    v_exp_f32 v146, v146
    v_exp_f32 v147, v147
    v_mfma_f32_32x32x8_bf16 v[96:111], v[58:59], v[32:33], v[96:111]
    v_mov_b32 v6, s80
    s_mov_b32 s78, 0
lsp_71:
    ds_read_b32 v7, v6
    s_add_u32 s78, s78, 1
    s_waitcnt lgkmcnt(0)
    v_readfirstlane_b32 s83, v7
    s_cmp_gt_u32 s78, 0x40000
    s_cbranch_scc1 lso_72
    s_cmp_ge_u32 s83, 1
    s_cbranch_scc1 lso_72
    s_sleep 2
    s_branch lsp_71
lso_72:
    ds_read_b128 v[40:43], v240 offset:0
    ds_read_b64 v[56:57], v241 offset:1024
    v_exp_f32 v148, v148
    v_exp_f32 v149, v149
    v_exp_f32 v150, v150
    v_exp_f32 v151, v151
    v_smfmac_f32_32x32x32_bf16 v[192:207], v[68:71], v[136:143], v4
    v_exp_f32 v152, v152
    v_exp_f32 v153, v153
    v_exp_f32 v154, v154
    v_exp_f32 v155, v155
    v_smfmac_f32_32x32x32_bf16 v[208:223], v[64:67], v[144:151], v4
    v_exp_f32 v156, v156
    v_exp_f32 v157, v157
    v_exp_f32 v158, v158
    v_exp_f32 v159, v159
    v_mfma_f32_32x32x16_bf16 v[112:127], v[44:47], v[20:23], 0
    v_exp_f32 v96, v96
    v_exp_f32 v97, v97
    v_exp_f32 v98, v98
    v_exp_f32 v99, v99
    v_mfma_f32_32x32x8_bf16 v[112:127], v[58:59], v[34:35], v[112:127]
    v_exp_f32 v100, v100
    v_exp_f32 v101, v101
    v_exp_f32 v102, v102
    v_exp_f32 v103, v103
    v_smfmac_f32_32x32x32_bf16 v[208:223], v[68:71], v[152:159], v4
    ds_read_b128 v[64:67], v240 offset:1536
    ds_read_b128 v[68:71], v240 offset:2560
    v_exp_f32 v104, v104
    v_exp_f32 v105, v105
    v_exp_f32 v106, v106
    v_exp_f32 v107, v107
    v_smfmac_f32_32x32x32_bf16 v[160:175], v[72:75], v[96:103], v4
    v_exp_f32 v108, v108
    v_exp_f32 v109, v109
    v_exp_f32 v110, v110
    v_exp_f32 v111, v111
    v_mfma_f32_32x32x16_bf16 v[128:143], v[44:47], v[24:27], 0
    v_exp_f32 v112, v112
    v_exp_f32 v113, v113
    v_exp_f32 v114, v114
    v_exp_f32 v115, v115
    v_mfma_f32_32x32x8_bf16 v[128:143], v[58:59], v[36:37], v[128:143]
    v_exp_f32 v116, v116
    v_exp_f32 v117, v117
    v_exp_f32 v118, v118
    v_exp_f32 v119, v119
    v_smfmac_f32_32x32x32_bf16 v[160:175], v[76:79], v[104:111], v4
    v_exp_f32 v120, v120
    v_exp_f32 v121, v121
    v_exp_f32 v122, v122
    v_exp_f32 v123, v123
    v_smfmac_f32_32x32x32_bf16 v[176:191], v[72:75], v[112:119], v4
    v_exp_f32 v124, v124
    v_exp_f32 v125, v125
    v_exp_f32 v126, v126
    v_exp_f32 v127, v127
    v_mfma_f32_32x32x16_bf16 v[144:159], v[44:47], v[28:31], 0
    v_exp_f32 v128, v128
    v_exp_f32 v129, v129
    v_exp_f32 v130, v130
    v_exp_f32 v131, v131
    v_mfma_f32_32x32x8_bf16 v[144:159], v[58:59], v[38:39], v[144:159]
    v_exp_f32 v132, v132
    v_exp_f32 v133, v133
    v_exp_f32 v134, v134
    v_exp_f32 v135, v135
    v_smfmac_f32_32x32x32_bf16 v[176:191], v[76:79], v[120:127], v4
    v_exp_f32 v136, v136
    v_exp_f32 v137, v137
    v_exp_f32 v138, v138
    v_exp_f32 v139, v139
    v_smfmac_f32_32x32x32_bf16 v[192:207], v[72:75], v[128:135], v4
    v_exp_f32 v140, v140
    v_exp_f32 v141, v141
    v_exp_f32 v142, v142
    v_exp_f32 v143, v143
    s_waitcnt vmcnt(4)
    v_mfma_f32_32x32x16_bf16 v[96:111], v[48:51], v[16:19], 0
    v_exp_f32 v144, v144
    v_exp_f32 v145, v145
    v_exp_f32 v146, v146
    v_exp_f32 v147, v147
    v_mfma_f32_32x32x8_bf16 v[96:111], v[60:61], v[32:33], v[96:111]
    ds_read_b128 v[44:47], v240 offset:3584
    ds_read_b64 v[58:59], v241 offset:4608
    v_exp_f32 v148, v148
    v_exp_f32 v149, v149
    v_exp_f32 v150, v150
    v_exp_f32 v151, v151
    v_smfmac_f32_32x32x32_bf16 v[192:207], v[76:79], v[136:143], v4
    v_exp_f32 v152, v152
    v_exp_f32 v153, v153
    v_exp_f32 v154, v154
    v_exp_f32 v155, v155
    v_smfmac_f32_32x32x32_bf16 v[208:223], v[72:75], v[144:151], v4
    v_exp_f32 v156, v156
    v_exp_f32 v157, v157
    v_exp_f32 v158, v158
    v_exp_f32 v159, v159
    v_mfma_f32_32x32x16_bf16 v[112:127], v[48:51], v[20:23], 0
    v_exp_f32 v96, v96
    v_exp_f32 v97, v97
    v_exp_f32 v98, v98
    v_exp_f32 v99, v99
    v_mfma_f32_32x32x8_bf16 v[112:127], v[60:61], v[34:35], v[112:127]
    v_exp_f32 v100, v100
    v_exp_f32 v101, v101
    v_exp_f32 v102, v102
    v_exp_f32 v103, v103
    v_smfmac_f32_32x32x32_bf16 v[208:223], v[76:79], v[152:159], v4
    ds_read_b128 v[72:75], v240 offset:5120
    ds_read_b128 v[76:79], v240 offset:6144
    v_exp_f32 v104, v104
    v_exp_f32 v105, v105
    v_exp_f32 v106, v106
    v_exp_f32 v107, v107
    v_smfmac_f32_32x32x32_bf16 v[160:175], v[80:83], v[96:103], v4
    v_exp_f32 v108, v108
    v_exp_f32 v109, v109
    v_exp_f32 v110, v110
    v_exp_f32 v111, v111
    v_mfma_f32_32x32x16_bf16 v[128:143], v[48:51], v[24:27], 0
    v_exp_f32 v112, v112
    v_exp_f32 v113, v113
    v_exp_f32 v114, v114
    v_exp_f32 v115, v115
    v_mfma_f32_32x32x8_bf16 v[128:143], v[60:61], v[36:37], v[128:143]
    v_exp_f32 v116, v116
    v_exp_f32 v117, v117
    v_exp_f32 v118, v118
    v_exp_f32 v119, v119
    v_smfmac_f32_32x32x32_bf16 v[160:175], v[84:87], v[104:111], v4
    v_exp_f32 v120, v120
    v_exp_f32 v121, v121
    v_exp_f32 v122, v122
    v_exp_f32 v123, v123
    v_smfmac_f32_32x32x32_bf16 v[176:191], v[80:83], v[112:119], v4
    v_exp_f32 v124, v124
    v_exp_f32 v125, v125
    v_exp_f32 v126, v126
    v_exp_f32 v127, v127
    v_mfma_f32_32x32x16_bf16 v[144:159], v[48:51], v[28:31], 0
    v_exp_f32 v128, v128
    v_exp_f32 v129, v129
    v_exp_f32 v130, v130
    v_exp_f32 v131, v131
    v_mfma_f32_32x32x8_bf16 v[144:159], v[60:61], v[38:39], v[144:159]
    v_exp_f32 v132, v132
    v_exp_f32 v133, v133
    v_exp_f32 v134, v134
    v_exp_f32 v135, v135
    v_smfmac_f32_32x32x32_bf16 v[176:191], v[84:87], v[120:127], v4
    v_exp_f32 v136, v136
    v_exp_f32 v137, v137
    v_exp_f32 v138, v138
    v_exp_f32 v139, v139
    v_smfmac_f32_32x32x32_bf16 v[192:207], v[80:83], v[128:135], v4
    v_exp_f32 v140, v140
    v_exp_f32 v141, v141
    v_exp_f32 v142, v142
    v_exp_f32 v143, v143
    s_waitcnt vmcnt(0)
    v_mfma_f32_32x32x16_bf16 v[96:111], v[52:55], v[16:19], 0
    v_exp_f32 v144, v144
    v_exp_f32 v145, v145
    v_exp_f32 v146, v146
    v_exp_f32 v147, v147
    v_mfma_f32_32x32x8_bf16 v[96:111], v[62:63], v[32:33], v[96:111]
    ds_read_b128 v[48:51], v240 offset:7168
    ds_read_b64 v[60:61], v241 offset:8192
    v_exp_f32 v148, v148
    v_exp_f32 v149, v149
    v_exp_f32 v150, v150
    v_exp_f32 v151, v151
    v_smfmac_f32_32x32x32_bf16 v[192:207], v[84:87], v[136:143], v4
    v_exp_f32 v152, v152
    v_exp_f32 v153, v153
    v_exp_f32 v154, v154
    v_exp_f32 v155, v155
    v_smfmac_f32_32x32x32_bf16 v[208:223], v[80:83], v[144:151], v4
    v_exp_f32 v156, v156
    v_exp_f32 v157, v157
    v_exp_f32 v158, v158
    v_exp_f32 v159, v159
    v_mfma_f32_32x32x16_bf16 v[112:127], v[52:55], v[20:23], 0
    v_exp_f32 v96, v96
    v_exp_f32 v97, v97
    v_exp_f32 v98, v98
    v_exp_f32 v99, v99
    v_mfma_f32_32x32x8_bf16 v[112:127], v[62:63], v[34:35], v[112:127]
    v_exp_f32 v100, v100
    v_exp_f32 v101, v101
    v_exp_f32 v102, v102
    v_exp_f32 v103, v103
    v_smfmac_f32_32x32x32_bf16 v[208:223], v[84:87], v[152:159], v4
    ds_read_b128 v[80:83], v240 offset:8704
    ds_read_b128 v[84:87], v240 offset:9728
    v_exp_f32 v104, v104
    v_exp_f32 v105, v105
    v_exp_f32 v106, v106
    v_exp_f32 v107, v107
    v_smfmac_f32_32x32x32_bf16 v[160:175], v[88:91], v[96:103], v4
    v_exp_f32 v108, v108
    v_exp_f32 v109, v109
    v_exp_f32 v110, v110
    v_exp_f32 v111, v111
    v_mfma_f32_32x32x16_bf16 v[128:143], v[52:55], v[24:27], 0
    v_exp_f32 v112, v112
    v_exp_f32 v113, v113
    v_exp_f32 v114, v114
    v_exp_f32 v115, v115
    v_mfma_f32_32x32x8_bf16 v[128:143], v[62:63], v[36:37], v[128:143]
    v_exp_f32 v116, v116
    v_exp_f32 v117, v117
    v_exp_f32 v118, v118
    v_exp_f32 v119, v119
    v_smfmac_f32_32x32x32_bf16 v[160:175], v[92:95], v[104:111], v4
    v_exp_f32 v120, v120
    v_exp_f32 v121, v121
    v_exp_f32 v122, v122
    v_exp_f32 v123, v123
    v_smfmac_f32_32x32x32_bf16 v[176:191], v[88:91], v[112:119], v4
    v_exp_f32 v124, v124
    v_exp_f32 v125, v125
    v_exp_f32 v126, v126
    v_exp_f32 v127, v127
    v_mfma_f32_32x32x16_bf16 v[144:159], v[52:55], v[28:31], 0
    v_exp_f32 v128, v128
    v_exp_f32 v129, v129
    v_exp_f32 v130, v130
    v_exp_f32 v131, v131
    v_mfma_f32_32x32x8_bf16 v[144:159], v[62:63], v[38:39], v[144:159]
    v_exp_f32 v132, v132
    v_exp_f32 v133, v133
    v_exp_f32 v134, v134
    v_exp_f32 v135, v135
    v_smfmac_f32_32x32x32_bf16 v[176:191], v[92:95], v[120:127], v4
    v_exp_f32 v136, v136
    v_exp_f32 v137, v137
    v_exp_f32 v138, v138
    v_exp_f32 v139, v139
    v_smfmac_f32_32x32x32_bf16 v[192:207], v[88:91], v[128:135], v4
    v_exp_f32 v140, v140
    v_exp_f32 v141, v141
    v_exp_f32 v142, v142
    v_exp_f32 v143, v143
    s_waitcnt lgkmcnt(8)
    v_mfma_f32_32x32x16_bf16 v[96:111], v[40:43], v[16:19], 0
    v_exp_f32 v144, v144
    v_exp_f32 v145, v145
    v_exp_f32 v146, v146
    v_exp_f32 v147, v147
    v_mfma_f32_32x32x8_bf16 v[96:111], v[56:57], v[32:33], v[96:111]
    ds_read_b128 v[52:55], v240 offset:10752
    ds_read_b64 v[62:63], v241 offset:11776
    v_exp_f32 v148, v148
    v_exp_f32 v149, v149
    v_exp_f32 v150, v150
    v_exp_f32 v151, v151
    v_smfmac_f32_32x32x32_bf16 v[192:207], v[92:95], v[136:143], v4
    v_exp_f32 v152, v152
    v_exp_f32 v153, v153
    v_exp_f32 v154, v154
    v_exp_f32 v155, v155
    v_smfmac_f32_32x32x32_bf16 v[208:223], v[88:91], v[144:151], v4
    v_exp_f32 v156, v156
    v_exp_f32 v157, v157
    v_exp_f32 v158, v158
    v_exp_f32 v159, v159
    v_mfma_f32_32x32x16_bf16 v[112:127], v[40:43], v[20:23], 0
    v_exp_f32 v96, v96
    v_exp_f32 v97, v97
    v_exp_f32 v98, v98
    v_exp_f32 v99, v99
    v_mfma_f32_32x32x8_bf16 v[112:127], v[56:57], v[34:35], v[112:127]
    v_exp_f32 v100, v100
    v_exp_f32 v101, v101
    v_exp_f32 v102, v102
    v_exp_f32 v103, v103
    v_smfmac_f32_32x32x32_bf16 v[208:223], v[92:95], v[152:159], v4
    ds_read_b128 v[88:91], v240 offset:12288
    ds_read_b128 v[92:95], v240 offset:13312
    v_exp_f32 v104, v104
    v_exp_f32 v105, v105
    v_exp_f32 v106, v106
    v_exp_f32 v107, v107
    v_smfmac_f32_32x32x32_bf16 v[160:175], v[64:67], v[96:103], v4
    v_exp_f32 v108, v108
    v_exp_f32 v109, v109
    v_exp_f32 v110, v110
    v_exp_f32 v111, v111
    v_mfma_f32_32x32x16_bf16 v[128:143], v[40:43], v[24:27], 0
    v_exp_f32 v112, v112
    v_exp_f32 v113, v113
    v_exp_f32 v114, v114
    v_exp_f32 v115, v115
    v_mfma_f32_32x32x8_bf16 v[128:143], v[56:57], v[36:37], v[128:143]
    v_exp_f32 v116, v116
    v_exp_f32 v117, v117
    v_exp_f32 v118, v118
    v_exp_f32 v119, v119
    v_smfmac_f32_32x32x32_bf16 v[160:175], v[68:71], v[104:111], v4
    v_exp_f32 v120, v120
    v_exp_f32 v121, v121
    v_exp_f32 v122, v122
    v_exp_f32 v123, v123
    v_smfmac_f32_32x32x32_bf16 v[176:191], v[64:67], v[112:119], v4
    v_exp_f32 v124, v124
    v_exp_f32 v125, v125
    v_exp_f32 v126, v126
    v_exp_f32 v127, v127
    v_mfma_f32_32x32x16_bf16 v[144:159], v[40:43], v[28:31], 0
    v_exp_f32 v128, v128
    v_exp_f32 v129, v129
    v_exp_f32 v130, v130
    v_exp_f32 v131, v131
    v_mfma_f32_32x32x8_bf16 v[144:159], v[56:57], v[38:39], v[144:159]
    v_exp_f32 v132, v132
    v_exp_f32 v133, v133
    v_exp_f32 v134, v134
    v_exp_f32 v135, v135
    v_smfmac_f32_32x32x32_bf16 v[176:191], v[68:71], v[120:127], v4
    v_exp_f32 v136, v136
    v_exp_f32 v137, v137
    v_exp_f32 v138, v138
    v_exp_f32 v139, v139
    v_smfmac_f32_32x32x32_bf16 v[192:207], v[64:67], v[128:135], v4
    v_exp_f32 v140, v140
    v_exp_f32 v141, v141
    v_exp_f32 v142, v142
    v_exp_f32 v143, v143
    s_waitcnt lgkmcnt(8)
    v_mfma_f32_32x32x16_bf16 v[96:111], v[44:47], v[16:19], 0
    v_exp_f32 v144, v144
    v_exp_f32 v145, v145
    v_exp_f32 v146, v146
    v_exp_f32 v147, v147
    v_mfma_f32_32x32x8_bf16 v[96:111], v[58:59], v[32:33], v[96:111]
    v_mov_b32 v6, s80
    s_mov_b32 s78, 0
lsp_73:
    ds_read_b32 v7, v6
    s_add_u32 s78, s78, 1
    s_waitcnt lgkmcnt(0)
    v_readfirstlane_b32 s83, v7
    s_cmp_gt_u32 s78, 0x40000
    s_cbranch_scc1 lso_74
    s_cmp_ge_u32 s83, 2
    s_cbranch_scc1 lso_74
    s_sleep 2
    s_branch lsp_73
lso_74:
    ds_read_b128 v[40:43], v240 offset:14336
    ds_read_b64 v[56:57], v241 offset:15360
    v_exp_f32 v148, v148
    v_exp_f32 v149, v149
    v_exp_f32 v150, v150
    v_exp_f32 v151, v151
    v_smfmac_f32_32x32x32_bf16 v[192:207], v[68:71], v[136:143], v4
    v_exp_f32 v152, v152
    v_exp_f32 v153, v153
    v_exp_f32 v154, v154
    v_exp_f32 v155, v155
    v_smfmac_f32_32x32x32_bf16 v[208:223], v[64:67], v[144:151], v4
    v_exp_f32 v156, v156
    v_exp_f32 v157, v157
    v_exp_f32 v158, v158
    v_exp_f32 v159, v159
    v_mfma_f32_32x32x16_bf16 v[112:127], v[44:47], v[20:23], 0
    v_exp_f32 v96, v96
    v_exp_f32 v97, v97
    v_exp_f32 v98, v98
    v_exp_f32 v99, v99
    v_mfma_f32_32x32x8_bf16 v[112:127], v[58:59], v[34:35], v[112:127]
    v_exp_f32 v100, v100
    v_exp_f32 v101, v101
    v_exp_f32 v102, v102
    v_exp_f32 v103, v103
    v_smfmac_f32_32x32x32_bf16 v[208:223], v[68:71], v[152:159], v4
    ds_read_b128 v[64:67], v240 offset:15872
    ds_read_b128 v[68:71], v240 offset:16896
    v_exp_f32 v104, v104
    v_exp_f32 v105, v105
    v_exp_f32 v106, v106
    v_exp_f32 v107, v107
    v_smfmac_f32_32x32x32_bf16 v[160:175], v[72:75], v[96:103], v4
    v_exp_f32 v108, v108
    v_exp_f32 v109, v109
    v_exp_f32 v110, v110
    v_exp_f32 v111, v111
    v_mfma_f32_32x32x16_bf16 v[128:143], v[44:47], v[24:27], 0
    v_exp_f32 v112, v112
    v_exp_f32 v113, v113
    v_exp_f32 v114, v114
    v_exp_f32 v115, v115
    v_mfma_f32_32x32x8_bf16 v[128:143], v[58:59], v[36:37], v[128:143]
    v_exp_f32 v116, v116
    v_exp_f32 v117, v117
    v_exp_f32 v118, v118
    v_exp_f32 v119, v119
    v_smfmac_f32_32x32x32_bf16 v[160:175], v[76:79], v[104:111], v4
    v_exp_f32 v120, v120
    v_exp_f32 v121, v121
    v_exp_f32 v122, v122
    v_exp_f32 v123, v123
    v_smfmac_f32_32x32x32_bf16 v[176:191], v[72:75], v[112:119], v4
    v_exp_f32 v124, v124
    v_exp_f32 v125, v125
    v_exp_f32 v126, v126
    v_exp_f32 v127, v127
    v_mfma_f32_32x32x16_bf16 v[144:159], v[44:47], v[28:31], 0
    v_exp_f32 v128, v128
    v_exp_f32 v129, v129
    v_exp_f32 v130, v130
    v_exp_f32 v131, v131
    v_mfma_f32_32x32x8_bf16 v[144:159], v[58:59], v[38:39], v[144:159]
    v_exp_f32 v132, v132
    v_exp_f32 v133, v133
    v_exp_f32 v134, v134
    v_exp_f32 v135, v135
    v_smfmac_f32_32x32x32_bf16 v[176:191], v[76:79], v[120:127], v4
    v_exp_f32 v136, v136
    v_exp_f32 v137, v137
    v_exp_f32 v138, v138
    v_exp_f32 v139, v139
    v_smfmac_f32_32x32x32_bf16 v[192:207], v[72:75], v[128:135], v4
    v_exp_f32 v140, v140
    v_exp_f32 v141, v141
    v_exp_f32 v142, v142
    v_exp_f32 v143, v143
    v_mfma_f32_32x32x16_bf16 v[96:111], v[48:51], v[16:19], 0
    v_exp_f32 v144, v144
    v_exp_f32 v145, v145
    v_exp_f32 v146, v146
    v_exp_f32 v147, v147
    v_mfma_f32_32x32x8_bf16 v[96:111], v[60:61], v[32:33], v[96:111]
    ds_read_b128 v[44:47], v240 offset:17920
    ds_read_b64 v[58:59], v241 offset:18944
    v_exp_f32 v148, v148
    v_exp_f32 v149, v149
    v_exp_f32 v150, v150
    v_exp_f32 v151, v151
    v_smfmac_f32_32x32x32_bf16 v[192:207], v[76:79], v[136:143], v4
    v_exp_f32 v152, v152
    v_exp_f32 v153, v153
    v_exp_f32 v154, v154
    v_exp_f32 v155, v155
    v_smfmac_f32_32x32x32_bf16 v[208:223], v[72:75], v[144:151], v4
    v_exp_f32 v156, v156
    v_exp_f32 v157, v157
    v_exp_f32 v158, v158
    v_exp_f32 v159, v159
    v_mfma_f32_32x32x16_bf16 v[112:127], v[48:51], v[20:23], 0
    v_exp_f32 v96, v96
    v_exp_f32 v97, v97
    v_exp_f32 v98, v98
    v_exp_f32 v99, v99
    v_mfma_f32_32x32x8_bf16 v[112:127], v[60:61], v[34:35], v[112:127]
    v_exp_f32 v100, v100
    v_exp_f32 v101, v101
    v_exp_f32 v102, v102
    v_exp_f32 v103, v103
    v_smfmac_f32_32x32x32_bf16 v[208:223], v[76:79], v[152:159], v4
    ds_read_b128 v[72:75], v240 offset:19456
    ds_read_b128 v[76:79], v240 offset:20480
    v_exp_f32 v104, v104
    v_exp_f32 v105, v105
    v_exp_f32 v106, v106
    v_exp_f32 v107, v107
    v_smfmac_f32_32x32x32_bf16 v[160:175], v[80:83], v[96:103], v4
    v_exp_f32 v108, v108
    v_exp_f32 v109, v109
    v_exp_f32 v110, v110
    v_exp_f32 v111, v111
    v_mfma_f32_32x32x16_bf16 v[128:143], v[48:51], v[24:27], 0
    v_exp_f32 v112, v112
    v_exp_f32 v113, v113
    v_exp_f32 v114, v114
    v_exp_f32 v115, v115
    v_mfma_f32_32x32x8_bf16 v[128:143], v[60:61], v[36:37], v[128:143]
    v_exp_f32 v116, v116
    v_exp_f32 v117, v117
    v_exp_f32 v118, v118
    v_exp_f32 v119, v119
    v_smfmac_f32_32x32x32_bf16 v[160:175], v[84:87], v[104:111], v4
    v_exp_f32 v120, v120
    v_exp_f32 v121, v121
    v_exp_f32 v122, v122
    v_exp_f32 v123, v123
    v_smfmac_f32_32x32x32_bf16 v[176:191], v[80:83], v[112:119], v4
    v_exp_f32 v124, v124
    v_exp_f32 v125, v125
    v_exp_f32 v126, v126
    v_exp_f32 v127, v127
    v_mfma_f32_32x32x16_bf16 v[144:159], v[48:51], v[28:31], 0
    v_exp_f32 v128, v128
    v_exp_f32 v129, v129
    v_exp_f32 v130, v130
    v_exp_f32 v131, v131
    v_mfma_f32_32x32x8_bf16 v[144:159], v[60:61], v[38:39], v[144:159]
    v_exp_f32 v132, v132
    v_exp_f32 v133, v133
    v_exp_f32 v134, v134
    v_exp_f32 v135, v135
    v_smfmac_f32_32x32x32_bf16 v[176:191], v[84:87], v[120:127], v4
    v_exp_f32 v136, v136
    v_exp_f32 v137, v137
    v_exp_f32 v138, v138
    v_exp_f32 v139, v139
    v_smfmac_f32_32x32x32_bf16 v[192:207], v[80:83], v[128:135], v4
    v_exp_f32 v140, v140
    v_exp_f32 v141, v141
    v_exp_f32 v142, v142
    v_exp_f32 v143, v143
    v_mfma_f32_32x32x16_bf16 v[96:111], v[52:55], v[16:19], 0
    v_exp_f32 v144, v144
    v_exp_f32 v145, v145
    v_exp_f32 v146, v146
    v_exp_f32 v147, v147
    v_mfma_f32_32x32x8_bf16 v[96:111], v[62:63], v[32:33], v[96:111]
    ds_read_b128 v[48:51], v240 offset:21504
    ds_read_b64 v[60:61], v241 offset:22528
    v_exp_f32 v148, v148
    v_exp_f32 v149, v149
    v_exp_f32 v150, v150
    v_exp_f32 v151, v151
    v_smfmac_f32_32x32x32_bf16 v[192:207], v[84:87], v[136:143], v4
    v_exp_f32 v152, v152
    v_exp_f32 v153, v153
    v_exp_f32 v154, v154
    v_exp_f32 v155, v155
    v_smfmac_f32_32x32x32_bf16 v[208:223], v[80:83], v[144:151], v4
    v_exp_f32 v156, v156
    v_exp_f32 v157, v157
    v_exp_f32 v158, v158
    v_exp_f32 v159, v159
    v_mfma_f32_32x32x16_bf16 v[112:127], v[52:55], v[20:23], 0
    v_exp_f32 v96, v96
    v_exp_f32 v97, v97
    v_exp_f32 v98, v98
    v_exp_f32 v99, v99
    v_mfma_f32_32x32x8_bf16 v[112:127], v[62:63], v[34:35], v[112:127]
    v_exp_f32 v100, v100
    v_exp_f32 v101, v101
    v_exp_f32 v102, v102
    v_exp_f32 v103, v103
    v_smfmac_f32_32x32x32_bf16 v[208:223], v[84:87], v[152:159], v4
    ds_read_b128 v[80:83], v240 offset:23040
    ds_read_b128 v[84:87], v240 offset:24064
    v_exp_f32 v104, v104
    v_exp_f32 v105, v105
    v_exp_f32 v106, v106
    v_exp_f32 v107, v107
    v_smfmac_f32_32x32x32_bf16 v[160:175], v[88:91], v[96:103], v4
    v_exp_f32 v108, v108
    v_exp_f32 v109, v109
    v_exp_f32 v110, v110
    v_exp_f32 v111, v111
    v_mfma_f32_32x32x16_bf16 v[128:143], v[52:55], v[24:27], 0
    v_exp_f32 v112, v112
    v_exp_f32 v113, v113
    v_exp_f32 v114, v114
    v_exp_f32 v115, v115
    v_mfma_f32_32x32x8_bf16 v[128:143], v[62:63], v[36:37], v[128:143]
    v_exp_f32 v116, v116
    v_exp_f32 v117, v117
    v_exp_f32 v118, v118
    v_exp_f32 v119, v119
    v_smfmac_f32_32x32x32_bf16 v[160:175], v[92:95], v[104:111], v4
    v_exp_f32 v120, v120
    v_exp_f32 v121, v121
    v_exp_f32 v122, v122
    v_exp_f32 v123, v123
    v_smfmac_f32_32x32x32_bf16 v[176:191], v[88:91], v[112:119], v4
    v_exp_f32 v124, v124
    v_exp_f32 v125, v125
    v_exp_f32 v126, v126
    v_exp_f32 v127, v127
    v_mfma_f32_32x32x16_bf16 v[144:159], v[52:55], v[28:31], 0
    v_exp_f32 v128, v128
    v_exp_f32 v129, v129
    v_exp_f32 v130, v130
    v_exp_f32 v131, v131
    v_mfma_f32_32x32x8_bf16 v[144:159], v[62:63], v[38:39], v[144:159]
    v_exp_f32 v132, v132
    v_exp_f32 v133, v133
    v_exp_f32 v134, v134
    v_exp_f32 v135, v135
    v_smfmac_f32_32x32x32_bf16 v[176:191], v[92:95], v[120:127], v4
    v_exp_f32 v136, v136
    v_exp_f32 v137, v137
    v_exp_f32 v138, v138
    v_exp_f32 v139, v139
    v_smfmac_f32_32x32x32_bf16 v[192:207], v[88:91], v[128:135], v4
    v_exp_f32 v140, v140
    v_exp_f32 v141, v141
    v_exp_f32 v142, v142
    v_exp_f32 v143, v143
    s_waitcnt lgkmcnt(8)
    v_mfma_f32_32x32x16_bf16 v[96:111], v[40:43], v[16:19], 0
    v_exp_f32 v144, v144
    v_exp_f32 v145, v145
    v_exp_f32 v146, v146
    v_exp_f32 v147, v147
    v_mfma_f32_32x32x8_bf16 v[96:111], v[56:57], v[32:33], v[96:111]
    ds_read_b128 v[52:55], v240 offset:25088
    ds_read_b64 v[62:63], v241 offset:26112
    v_exp_f32 v148, v148
    v_exp_f32 v149, v149
    v_exp_f32 v150, v150
    v_exp_f32 v151, v151
    v_smfmac_f32_32x32x32_bf16 v[192:207], v[92:95], v[136:143], v4
    v_exp_f32 v152, v152
    v_exp_f32 v153, v153
    v_exp_f32 v154, v154
    v_exp_f32 v155, v155
    v_smfmac_f32_32x32x32_bf16 v[208:223], v[88:91], v[144:151], v4
    v_exp_f32 v156, v156
    v_exp_f32 v157, v157
    v_exp_f32 v158, v158
    v_exp_f32 v159, v159
    v_mfma_f32_32x32x16_bf16 v[112:127], v[40:43], v[20:23], 0
    v_exp_f32 v96, v96
    v_exp_f32 v97, v97
    v_exp_f32 v98, v98
    v_exp_f32 v99, v99
    v_mfma_f32_32x32x8_bf16 v[112:127], v[56:57], v[34:35], v[112:127]
    v_exp_f32 v100, v100
    v_exp_f32 v101, v101
    v_exp_f32 v102, v102
    v_exp_f32 v103, v103
    v_smfmac_f32_32x32x32_bf16 v[208:223], v[92:95], v[152:159], v4
    ds_read_b128 v[88:91], v240 offset:26624
    ds_read_b128 v[92:95], v240 offset:27648
    v_exp_f32 v104, v104
    v_exp_f32 v105, v105
    v_exp_f32 v106, v106
    v_exp_f32 v107, v107
    v_smfmac_f32_32x32x32_bf16 v[160:175], v[64:67], v[96:103], v4
    v_exp_f32 v108, v108
    v_exp_f32 v109, v109
    v_exp_f32 v110, v110
    v_exp_f32 v111, v111
    v_mfma_f32_32x32x16_bf16 v[128:143], v[40:43], v[24:27], 0
    v_exp_f32 v112, v112
    v_exp_f32 v113, v113
    v_exp_f32 v114, v114
    v_exp_f32 v115, v115
    v_mfma_f32_32x32x8_bf16 v[128:143], v[56:57], v[36:37], v[128:143]
    v_exp_f32 v116, v116
    v_exp_f32 v117, v117
    v_exp_f32 v118, v118
    v_exp_f32 v119, v119
    v_smfmac_f32_32x32x32_bf16 v[160:175], v[68:71], v[104:111], v4
    v_exp_f32 v120, v120
    v_exp_f32 v121, v121
    v_exp_f32 v122, v122
    v_exp_f32 v123, v123
    v_smfmac_f32_32x32x32_bf16 v[176:191], v[64:67], v[112:119], v4
    v_exp_f32 v124, v124
    v_exp_f32 v125, v125
    v_exp_f32 v126, v126
    v_exp_f32 v127, v127
    v_mfma_f32_32x32x16_bf16 v[144:159], v[40:43], v[28:31], 0
    v_exp_f32 v128, v128
    v_exp_f32 v129, v129
    v_exp_f32 v130, v130
    v_exp_f32 v131, v131
    v_mfma_f32_32x32x8_bf16 v[144:159], v[56:57], v[38:39], v[144:159]
    v_exp_f32 v132, v132
    v_exp_f32 v133, v133
    v_exp_f32 v134, v134
    v_exp_f32 v135, v135
    v_smfmac_f32_32x32x32_bf16 v[176:191], v[68:71], v[120:127], v4
    v_exp_f32 v136, v136
    v_exp_f32 v137, v137
    v_exp_f32 v138, v138
    v_exp_f32 v139, v139
    v_smfmac_f32_32x32x32_bf16 v[192:207], v[64:67], v[128:135], v4
    v_exp_f32 v140, v140
    v_exp_f32 v141, v141
    v_exp_f32 v142, v142
    v_exp_f32 v143, v143
    s_waitcnt lgkmcnt(8)
    v_mfma_f32_32x32x16_bf16 v[96:111], v[44:47], v[16:19], 0
    v_exp_f32 v144, v144
    v_exp_f32 v145, v145
    v_exp_f32 v146, v146
    v_exp_f32 v147, v147
    v_mfma_f32_32x32x8_bf16 v[96:111], v[58:59], v[32:33], v[96:111]
    v_exp_f32 v148, v148
    v_exp_f32 v149, v149
    v_exp_f32 v150, v150
    v_exp_f32 v151, v151
    v_smfmac_f32_32x32x32_bf16 v[192:207], v[68:71], v[136:143], v4
    v_exp_f32 v152, v152
    v_exp_f32 v153, v153
    v_exp_f32 v154, v154
    v_exp_f32 v155, v155
    v_smfmac_f32_32x32x32_bf16 v[208:223], v[64:67], v[144:151], v4
    v_exp_f32 v156, v156
    v_exp_f32 v157, v157
    v_exp_f32 v158, v158
    v_exp_f32 v159, v159
    v_mfma_f32_32x32x16_bf16 v[112:127], v[44:47], v[20:23], 0
    v_exp_f32 v96, v96
    v_exp_f32 v97, v97
    v_exp_f32 v98, v98
    v_exp_f32 v99, v99
    v_mfma_f32_32x32x8_bf16 v[112:127], v[58:59], v[34:35], v[112:127]
    v_exp_f32 v100, v100
    v_exp_f32 v101, v101
    v_exp_f32 v102, v102
    v_exp_f32 v103, v103
    v_smfmac_f32_32x32x32_bf16 v[208:223], v[68:71], v[152:159], v4
    v_exp_f32 v104, v104
    v_exp_f32 v105, v105
    v_exp_f32 v106, v106
    v_exp_f32 v107, v107
    v_smfmac_f32_32x32x32_bf16 v[160:175], v[72:75], v[96:103], v4
    v_exp_f32 v108, v108
    v_exp_f32 v109, v109
    v_exp_f32 v110, v110
    v_exp_f32 v111, v111
    v_mfma_f32_32x32x16_bf16 v[128:143], v[44:47], v[24:27], 0
    v_exp_f32 v112, v112
    v_exp_f32 v113, v113
    v_exp_f32 v114, v114
    v_exp_f32 v115, v115
    v_mfma_f32_32x32x8_bf16 v[128:143], v[58:59], v[36:37], v[128:143]
    v_exp_f32 v116, v116
    v_exp_f32 v117, v117
    v_exp_f32 v118, v118
    v_exp_f32 v119, v119
    v_smfmac_f32_32x32x32_bf16 v[160:175], v[76:79], v[104:111], v4
    v_exp_f32 v120, v120
    v_exp_f32 v121, v121
    v_exp_f32 v122, v122
    v_exp_f32 v123, v123
    v_smfmac_f32_32x32x32_bf16 v[176:191], v[72:75], v[112:119], v4
    v_exp_f32 v124, v124
    v_exp_f32 v125, v125
    v_exp_f32 v126, v126
    v_exp_f32 v127, v127
    v_mfma_f32_32x32x16_bf16 v[144:159], v[44:47], v[28:31], 0
    v_exp_f32 v128, v128
    v_exp_f32 v129, v129
    v_exp_f32 v130, v130
    v_exp_f32 v131, v131
    v_mfma_f32_32x32x8_bf16 v[144:159], v[58:59], v[38:39], v[144:159]
    v_exp_f32 v132, v132
    v_exp_f32 v133, v133
    v_exp_f32 v134, v134
    v_exp_f32 v135, v135
    v_smfmac_f32_32x32x32_bf16 v[176:191], v[76:79], v[120:127], v4
    v_exp_f32 v136, v136
    v_exp_f32 v137, v137
    v_exp_f32 v138, v138
    v_exp_f32 v139, v139
    v_smfmac_f32_32x32x32_bf16 v[192:207], v[72:75], v[128:135], v4
    v_exp_f32 v140, v140
    v_exp_f32 v141, v141
    v_exp_f32 v142, v142
    v_exp_f32 v143, v143
    s_waitcnt lgkmcnt(4)
    v_mfma_f32_32x32x16_bf16 v[96:111], v[48:51], v[16:19], 0
    v_exp_f32 v144, v144
    v_exp_f32 v145, v145
    v_exp_f32 v146, v146
    v_exp_f32 v147, v147
    v_mfma_f32_32x32x8_bf16 v[96:111], v[60:61], v[32:33], v[96:111]
    v_exp_f32 v148, v148
    v_exp_f32 v149, v149
    v_exp_f32 v150, v150
    v_exp_f32 v151, v151
    v_smfmac_f32_32x32x32_bf16 v[192:207], v[76:79], v[136:143], v4
    v_exp_f32 v152, v152
    v_exp_f32 v153, v153
    v_exp_f32 v154, v154
    v_exp_f32 v155, v155
    v_smfmac_f32_32x32x32_bf16 v[208:223], v[72:75], v[144:151], v4
    v_exp_f32 v156, v156
    v_exp_f32 v157, v157
    v_exp_f32 v158, v158
    v_exp_f32 v159, v159
    v_mfma_f32_32x32x16_bf16 v[112:127], v[48:51], v[20:23], 0
    v_exp_f32 v96, v96
    v_exp_f32 v97, v97
    v_exp_f32 v98, v98
    v_exp_f32 v99, v99
    v_mfma_f32_32x32x8_bf16 v[112:127], v[60:61], v[34:35], v[112:127]
    v_exp_f32 v100, v100
    v_exp_f32 v101, v101
    v_exp_f32 v102, v102
    v_exp_f32 v103, v103
    v_smfmac_f32_32x32x32_bf16 v[208:223], v[76:79], v[152:159], v4
    v_exp_f32 v104, v104
    v_exp_f32 v105, v105
    v_exp_f32 v106, v106
    v_exp_f32 v107, v107
    v_smfmac_f32_32x32x32_bf16 v[160:175], v[80:83], v[96:103], v4
    v_exp_f32 v108, v108
    v_exp_f32 v109, v109
    v_exp_f32 v110, v110
    v_exp_f32 v111, v111
    v_mfma_f32_32x32x16_bf16 v[128:143], v[48:51], v[24:27], 0
    v_exp_f32 v112, v112
    v_exp_f32 v113, v113
    v_exp_f32 v114, v114
    v_exp_f32 v115, v115
    v_mfma_f32_32x32x8_bf16 v[128:143], v[60:61], v[36:37], v[128:143]
    v_exp_f32 v116, v116
    v_exp_f32 v117, v117
    v_exp_f32 v118, v118
    v_exp_f32 v119, v119
    v_smfmac_f32_32x32x32_bf16 v[160:175], v[84:87], v[104:111], v4
    v_exp_f32 v120, v120
    v_exp_f32 v121, v121
    v_exp_f32 v122, v122
    v_exp_f32 v123, v123
    v_smfmac_f32_32x32x32_bf16 v[176:191], v[80:83], v[112:119], v4
    v_exp_f32 v124, v124
    v_exp_f32 v125, v125
    v_exp_f32 v126, v126
    v_exp_f32 v127, v127
    v_mfma_f32_32x32x16_bf16 v[144:159], v[48:51], v[28:31], 0
    v_exp_f32 v128, v128
    v_exp_f32 v129, v129
    v_exp_f32 v130, v130
    v_exp_f32 v131, v131
    v_mfma_f32_32x32x8_bf16 v[144:159], v[60:61], v[38:39], v[144:159]
    v_exp_f32 v132, v132
    v_exp_f32 v133, v133
    v_exp_f32 v134, v134
    v_exp_f32 v135, v135
    v_smfmac_f32_32x32x32_bf16 v[176:191], v[84:87], v[120:127], v4
    v_exp_f32 v136, v136
    v_exp_f32 v137, v137
    v_exp_f32 v138, v138
    v_exp_f32 v139, v139
    v_smfmac_f32_32x32x32_bf16 v[192:207], v[80:83], v[128:135], v4
    v_exp_f32 v140, v140
    v_exp_f32 v141, v141
    v_exp_f32 v142, v142
    v_exp_f32 v143, v143
    s_waitcnt lgkmcnt(0)
    v_mfma_f32_32x32x16_bf16 v[96:111], v[52:55], v[16:19], 0
    v_exp_f32 v144, v144
    v_exp_f32 v145, v145
    v_exp_f32 v146, v146
    v_exp_f32 v147, v147
    v_mfma_f32_32x32x8_bf16 v[96:111], v[62:63], v[32:33], v[96:111]
    v_exp_f32 v148, v148
    v_exp_f32 v149, v149
    v_exp_f32 v150, v150
    v_exp_f32 v151, v151
    v_smfmac_f32_32x32x32_bf16 v[192:207], v[84:87], v[136:143], v4
    v_exp_f32 v152, v152
    v_exp_f32 v153, v153
    v_exp_f32 v154, v154
    v_exp_f32 v155, v155
    v_smfmac_f32_32x32x32_bf16 v[208:223], v[80:83], v[144:151], v4
    v_exp_f32 v156, v156
    v_exp_f32 v157, v157
    v_exp_f32 v158, v158
    v_exp_f32 v159, v159
    s_mov_b32 s38, 159796
    v_mov_b32 v6, s38
    s_mov_b32 s78, 0
lsp_75:
    ds_read_b32 v7, v6
    s_add_u32 s78, s78, 1
    s_waitcnt lgkmcnt(0)
    v_readfirstlane_b32 s83, v7
    s_cmp_gt_u32 s78, 0x40000
    s_cbranch_scc1 lso_76
    s_cmp_ge_u32 s83, 4
    s_cbranch_scc1 lso_76
    s_sleep 1
    s_branch lsp_75
lso_76:
    v_mfma_f32_32x32x16_bf16 v[112:127], v[52:55], v[20:23], 0
    v_exp_f32 v96, v96
    v_exp_f32 v97, v97
    v_exp_f32 v98, v98
    v_exp_f32 v99, v99
    v_mfma_f32_32x32x8_bf16 v[112:127], v[62:63], v[34:35], v[112:127]
    v_exp_f32 v100, v100
    v_exp_f32 v101, v101
    v_exp_f32 v102, v102
    v_exp_f32 v103, v103
    v_smfmac_f32_32x32x32_bf16 v[208:223], v[84:87], v[152:159], v4
    v_exp_f32 v104, v104
    v_exp_f32 v105, v105
    v_exp_f32 v106, v106
    v_exp_f32 v107, v107
    v_smfmac_f32_32x32x32_bf16 v[160:175], v[88:91], v[96:103], v4
    v_exp_f32 v108, v108
    v_exp_f32 v109, v109
    v_exp_f32 v110, v110
    v_exp_f32 v111, v111
    v_mfma_f32_32x32x16_bf16 v[128:143], v[52:55], v[24:27], 0
    v_exp_f32 v112, v112
    v_exp_f32 v113, v113
    v_exp_f32 v114, v114
    v_exp_f32 v115, v115
    v_mfma_f32_32x32x8_bf16 v[128:143], v[62:63], v[36:37], v[128:143]
    v_exp_f32 v116, v116
    v_exp_f32 v117, v117
    v_exp_f32 v118, v118
    v_exp_f32 v119, v119
    v_smfmac_f32_32x32x32_bf16 v[160:175], v[92:95], v[104:111], v4
    v_exp_f32 v120, v120
    v_exp_f32 v121, v121
    v_exp_f32 v122, v122
    v_exp_f32 v123, v123
    v_smfmac_f32_32x32x32_bf16 v[176:191], v[88:91], v[112:119], v4
    v_exp_f32 v124, v124
    v_exp_f32 v125, v125
    v_exp_f32 v126, v126
    v_exp_f32 v127, v127
    v_mfma_f32_32x32x16_bf16 v[144:159], v[52:55], v[28:31], 0
    v_exp_f32 v128, v128
    v_exp_f32 v129, v129
    v_exp_f32 v130, v130
    v_exp_f32 v131, v131
    v_mfma_f32_32x32x8_bf16 v[144:159], v[62:63], v[38:39], v[144:159]
    v_exp_f32 v132, v132
    v_exp_f32 v133, v133
    v_exp_f32 v134, v134
    v_exp_f32 v135, v135
    v_smfmac_f32_32x32x32_bf16 v[176:191], v[92:95], v[120:127], v4
    v_exp_f32 v136, v136
    v_exp_f32 v137, v137
    v_exp_f32 v138, v138
    v_exp_f32 v139, v139
    v_smfmac_f32_32x32x32_bf16 v[192:207], v[88:91], v[128:135], v4
    v_exp_f32 v140, v140
    v_exp_f32 v141, v141
    v_exp_f32 v142, v142
    v_exp_f32 v143, v143
    v_exp_f32 v144, v144
    v_exp_f32 v145, v145
    v_exp_f32 v146, v146
    v_exp_f32 v147, v147
    v_exp_f32 v148, v148
    v_exp_f32 v149, v149
    v_exp_f32 v150, v150
    v_exp_f32 v151, v151
    v_smfmac_f32_32x32x32_bf16 v[192:207], v[92:95], v[136:143], v4
    v_exp_f32 v152, v152
    v_exp_f32 v153, v153
    v_exp_f32 v154, v154
    v_exp_f32 v155, v155
    v_smfmac_f32_32x32x32_bf16 v[208:223], v[88:91], v[144:151], v4
    v_exp_f32 v156, v156
    v_exp_f32 v157, v157
    v_exp_f32 v158, v158
    v_exp_f32 v159, v159
    s_setprio 2
    s_nop 0
    v_smfmac_f32_32x32x32_bf16 v[208:223], v[92:95], v[152:159], v4
    v_mov_b64 v[14:15], v[32:33]
    s_mov_b32 s36, 114688
    s_add_u32 s37, s74, 1
    s_and_b32 s37, s37, 3
    s_mul_i32 s37, s37, 9216
    s_add_u32 s37, s37, s36
    v_add_u32 v6, s37, v2
    ds_write_b128 v6, v[176:179] offset:0
    ds_write_b128 v6, v[180:183] offset:1024
    ds_write_b128 v6, v[184:187] offset:2048
    s_add_u32 s37, s74, 2
    s_and_b32 s37, s37, 3
    s_mul_i32 s37, s37, 9216
    s_add_u32 s37, s37, s36
    v_add_u32 v6, s37, v2
    ds_write_b128 v6, v[192:195] offset:3072
    ds_write_b128 v6, v[196:199] offset:4096
    ds_write_b128 v6, v[200:203] offset:5120
    s_add_u32 s37, s74, 3
    s_and_b32 s37, s37, 3
    s_mul_i32 s37, s37, 9216
    s_add_u32 s37, s37, s36
    v_add_u32 v6, s37, v2
    ds_write_b128 v6, v[208:211] offset:6144
    ds_write_b128 v6, v[212:215] offset:7168
    ds_write_b128 v6, v[216:219] offset:8192
    s_lshl_b32 s38, s72, 2
    s_add_u32 s38, s38, 159744
    v_mov_b32 v6, s38
    v_mov_b32 v7, 1
    s_mul_i32 s37, s74, 9216
    s_add_u32 s37, s37, s36
    v_add_u32 v9, s37, v2
    s_waitcnt lgkmcnt(0)
    s_mov_b64 exec, 1
    ds_add_u32 v6, v7
    s_mov_b64 exec, -1
    v_mov_b32 v6, s38
    s_mov_b32 s78, 0
lsp_77:
    ds_read_b32 v7, v6
    s_add_u32 s78, s78, 1
    s_waitcnt lgkmcnt(0)
    v_readfirstlane_b32 s83, v7
    s_cmp_gt_u32 s78, 0x40000
    s_cbranch_scc1 lso_78
    s_cmp_ge_u32 s83, 4
    s_cbranch_scc1 lso_78
    s_branch lsp_77
lso_78:
    ds_read_b128 v[96:99], v9 offset:0
    ds_read_b128 v[100:103], v9 offset:1024
    ds_read_b128 v[104:107], v9 offset:2048
    ds_read_b128 v[112:115], v9 offset:3072
    ds_read_b128 v[116:119], v9 offset:4096
    ds_read_b128 v[120:123], v9 offset:5120
    ds_read_b128 v[128:131], v9 offset:6144
    ds_read_b128 v[132:135], v9 offset:7168
    ds_read_b128 v[136:139], v9 offset:8192
    s_lshl_b32 s36, s79, 1
    s_and_b32 s37, s74, 1
    s_add_u32 s36, s36, s37
    s_mul_i32 s36, s36, 136
    s_mul_i32 s37, s72, 20
    s_add_u32 s36, s36, s37
    s_lshl_b32 s36, s36, 10
    s_add_u32 s36, s36, 4292608
    s_lshr_b32 s39, s74, 1
    s_lshl_b32 s37, s73, 1
    s_add_u32 s37, s37, s39
    s_lshl_b32 s37, s37, 10
    s_add_u32 s37, s37, s36
    s_lshl_b32 s83, s73, 9
    s_add_u32 s36, s36, s83
    s_lshl_b32 s39, s39, 3
    s_add_u32 s36, s36, s39
    s_add_u32 s36, s36, 16384
    s_waitcnt lgkmcnt(6)
    v_pk_add_f32 v[160:161], v[160:161], v[96:97]
    v_pk_add_f32 v[162:163], v[162:163], v[98:99]
    v_pk_add_f32 v[164:165], v[164:165], v[100:101]
    v_pk_add_f32 v[166:167], v[166:167], v[102:103]
    v_pk_add_f32 v[168:169], v[168:169], v[104:105]
    v_pk_add_f32 v[170:171], v[170:171], v[106:107]
    s_waitcnt lgkmcnt(3)
    v_pk_add_f32 v[160:161], v[160:161], v[112:113]
    v_pk_add_f32 v[162:163], v[162:163], v[114:115]
    v_pk_add_f32 v[164:165], v[164:165], v[116:117]
    v_pk_add_f32 v[166:167], v[166:167], v[118:119]
    v_pk_add_f32 v[168:169], v[168:169], v[120:121]
    v_pk_add_f32 v[170:171], v[170:171], v[122:123]
    s_waitcnt lgkmcnt(0)
    v_pk_add_f32 v[160:161], v[160:161], v[128:129]
    v_pk_add_f32 v[162:163], v[162:163], v[130:131]
    v_pk_add_f32 v[164:165], v[164:165], v[132:133]
    v_pk_add_f32 v[166:167], v[166:167], v[134:135]
    v_pk_add_f32 v[168:169], v[168:169], v[136:137]
    v_pk_add_f32 v[170:171], v[170:171], v[138:139]
    v_mov_b32 v6, v168
    v_mov_b32 v7, v168
    v_pk_mul_f32 v[12:13], v[160:161], 0 op_sel_hi:[1,0]
    s_nop 0
    v_permlane32_swap_b32 v6, v7
    v_pk_fma_f32 v[12:13], v[162:163], 0, v[12:13] op_sel_hi:[1,0,1]
    v_pk_fma_f32 v[12:13], v[164:165], 0, v[12:13] op_sel_hi:[1,0,1]
    v_pk_fma_f32 v[12:13], v[166:167], 0, v[12:13] op_sel_hi:[1,0,1]
    v_pk_fma_f32 v[12:13], v[168:169], 0, v[12:13] op_sel_hi:[1,0,1]
    v_pk_fma_f32 v[12:13], v[170:171], 0, v[12:13] op_sel_hi:[1,0,1]
    v_rcp_f32 v6, v7
    v_cmp_u_f32 vcc, v12, v13
    v_cmp_ngt_f32 s[84:85], v7, 0
    v_pk_mul_f32 v[160:161], v[160:161], v[6:7] op_sel_hi:[1,0]
    v_pk_mul_f32 v[162:163], v[162:163], v[6:7] op_sel_hi:[1,0]
    v_pk_mul_f32 v[164:165], v[164:165], v[6:7] op_sel_hi:[1,0]
    v_pk_mul_f32 v[166:167], v[166:167], v[6:7] op_sel_hi:[1,0]
    v_pk_mul_f32 v[168:169], v[168:169], v[6:7] op_sel_hi:[1,0]
    v_pk_mul_f32 v[170:171], v[170:171], v[6:7] op_sel_hi:[1,0]
    v_cvt_pk_bf16_f32 v144, v160, v161
    v_cvt_pk_bf16_f32 v145, v162, v163
    v_cvt_pk_bf16_f32 v146, v164, v165
    v_cvt_pk_bf16_f32 v147, v166, v167
    v_cvt_pk_bf16_f32 v148, v168, v169
    v_cvt_pk_bf16_f32 v149, v170, v171
    v_min_u32 v144, -2, v144
    v_min_u32 v145, -2, v145
    v_min_u32 v146, -2, v146
    v_min_u32 v147, -2, v147
    v_min_u32 v148, -2, v148
    v_min_u32 v149, -2, v149
    s_or_b64 s[84:85], vcc, s[84:85]
    v_cmp_ngt_f32 vcc, 0x7b800000, v7
    s_nop 1
    s_or_b64 vcc, vcc, s[84:85]
    s_cbranch_vccnz fb_l
st_l:
    buffer_store_dwordx4 v[144:147], v2, s[16:19], s37 offen sc1
    s_mov_b32 exec_hi, 0
    buffer_store_dwordx2 v[148:149], v2, s[16:19], s36 offen sc1
    s_mov_b32 exec_hi, -1
    s_endpgm
fb_l:
    s_mov_b32 exec_lo, 0
    v_mov_b64 v[14:15], 0
    s_mov_b32 exec_lo, -1
    v_mov_b32 v10, 0xff800000
    s_mov_b32 s32, 3145728
fbx_l:
    buffer_load_dwordx4 v[176:179], v2, s[16:19], s32 offen sc1
    buffer_load_dwordx2 v[180:181], v3, s[16:19], s32 offen offset:1024 sc1
    s_add_u32 s32, s32, 1536
    s_waitcnt vmcnt(0)
    v_mfma_f32_32x32x16_bf16 v[96:111], v[176:179], v[16:19], 0
    v_mfma_f32_32x32x8_bf16 v[96:111], v[180:181], v[14:15], v[96:111]
    s_nop 15
    v_max3_f32 v10, v96, v97, v10
    v_max3_f32 v10, v98, v99, v10
    v_max3_f32 v10, v100, v101, v10
    v_max3_f32 v10, v102, v103, v10
    v_max3_f32 v10, v104, v105, v10
    v_max3_f32 v10, v106, v107, v10
    v_max3_f32 v10, v108, v109, v10
    v_max3_f32 v10, v110, v111, v10
    s_cmp_lt_u32 s32, 3244032
    s_cbranch_scc1 fbx_l
    v_mov_b32 v6, v10
    s_nop 1
    v_permlane32_swap_b32 v10, v6
    s_nop 1
    v_max_f32 v10, v10, v6
    v_xor_b32 v10, 0x80000000, v10
    v_and_b32 v6, 0xffff0000, v10
    v_sub_f32 v7, v10, v6
    v_and_b32 v8, 0xffff0000, v7
    v_sub_f32 v7, v7, v8
    v_lshrrev_b32 v6, 16, v6
    v_or_b32 v12, v6, v8
    v_lshrrev_b32 v13, 16, v7
    s_mov_b32 exec_lo, 0
    v_mov_b64 v[14:15], v[12:13]
    s_mov_b32 exec_lo, -1
    v_mov_b64 v[160:161], 0
    v_mov_b64 v[162:163], 0
    v_mov_b64 v[164:165], 0
    v_mov_b64 v[166:167], 0
    v_mov_b64 v[168:169], 0
    v_mov_b64 v[170:171], 0
    v_mov_b64 v[172:173], 0
    v_mov_b64 v[174:175], 0
    s_mov_b32 s32, 3145728
    s_mov_b32 s35, 3276800
fbm_l:
    buffer_load_dwordx4 v[176:179], v2, s[16:19], s32 offen sc1
    buffer_load_dwordx2 v[180:181], v3, s[16:19], s32 offen offset:1024 sc1
    s_add_u32 s32, s32, 1536
    buffer_load_dwordx4 v[192:195], v2, s[16:19], s35 offen sc1
    buffer_load_dwordx4 v[196:199], v2, s[16:19], s35 offen offset:1024 sc1
    s_add_u32 s35, s35, 2048
    s_waitcnt vmcnt(0)
    v_mfma_f32_32x32x16_bf16 v[96:111], v[176:179], v[16:19], 0
    v_mfma_f32_32x32x8_bf16 v[96:111], v[180:181], v[14:15], v[96:111]
    s_nop 15
    v_exp_f32 v96, v96
    v_exp_f32 v97, v97
    v_exp_f32 v98, v98
    v_exp_f32 v99, v99
    v_exp_f32 v100, v100
    v_exp_f32 v101, v101
    v_exp_f32 v102, v102
    v_exp_f32 v103, v103
    v_exp_f32 v104, v104
    v_exp_f32 v105, v105
    v_exp_f32 v106, v106
    v_exp_f32 v107, v107
    v_exp_f32 v108, v108
    v_exp_f32 v109, v109
    v_exp_f32 v110, v110
    v_exp_f32 v111, v111
    s_nop 1
    v_smfmac_f32_32x32x32_bf16 v[160:175], v[192:195], v[96:103], v4
    v_smfmac_f32_32x32x32_bf16 v[160:175], v[196:199], v[104:111], v4
    s_cmp_lt_u32 s32, 3244032
    s_cbranch_scc1 fbm_l
    s_nop 15
    v_mov_b32 v6, v168
    v_mov_b32 v7, v168
    v_pk_mul_f32 v[12:13], v[160:161], 0 op_sel_hi:[1,0]
    s_nop 0
    v_permlane32_swap_b32 v6, v7
    v_pk_fma_f32 v[12:13], v[162:163], 0, v[12:13] op_sel_hi:[1,0,1]
    v_pk_fma_f32 v[12:13], v[164:165], 0, v[12:13] op_sel_hi:[1,0,1]
    v_pk_fma_f32 v[12:13], v[166:167], 0, v[12:13] op_sel_hi:[1,0,1]
    v_pk_fma_f32 v[12:13], v[168:169], 0, v[12:13] op_sel_hi:[1,0,1]
    v_pk_fma_f32 v[12:13], v[170:171], 0, v[12:13] op_sel_hi:[1,0,1]
    v_rcp_f32 v6, v7
    v_cmp_u_f32 vcc, v12, v13
    v_cmp_ngt_f32 s[84:85], v7, 0
    v_pk_mul_f32 v[160:161], v[160:161], v[6:7] op_sel_hi:[1,0]
    v_pk_mul_f32 v[162:163], v[162:163], v[6:7] op_sel_hi:[1,0]
    v_pk_mul_f32 v[164:165], v[164:165], v[6:7] op_sel_hi:[1,0]
    v_pk_mul_f32 v[166:167], v[166:167], v[6:7] op_sel_hi:[1,0]
    v_pk_mul_f32 v[168:169], v[168:169], v[6:7] op_sel_hi:[1,0]
    v_pk_mul_f32 v[170:171], v[170:171], v[6:7] op_sel_hi:[1,0]
    v_cvt_pk_bf16_f32 v144, v160, v161
    v_cvt_pk_bf16_f32 v145, v162, v163
    v_cvt_pk_bf16_f32 v146, v164, v165
    v_cvt_pk_bf16_f32 v147, v166, v167
    v_cvt_pk_bf16_f32 v148, v168, v169
    v_cvt_pk_bf16_f32 v149, v170, v171
    v_min_u32 v144, -2, v144
    v_min_u32 v145, -2, v145
    v_min_u32 v146, -2, v146
    v_min_u32 v147, -2, v147
    v_min_u32 v148, -2, v148
    v_min_u32 v149, -2, v149
    s_or_b64 s[84:85], vcc, s[84:85]
    v_cmp_ngt_f32 vcc, 0x7b800000, v7
    s_nop 1
    s_or_b64 vcc, vcc, s[84:85]
    s_branch st_l
fb_e:
    s_mov_b32 exec_lo, 0
    v_mov_b64 v[14:15], 0
    s_mov_b32 exec_lo, -1
    v_mov_b32 v10, 0xff800000
    s_mov_b32 s32, 3145728
fbx_e:
    buffer_load_dwordx4 v[176:179], v2, s[16:19], s32 offen sc1
    buffer_load_dwordx2 v[180:181], v3, s[16:19], s32 offen offset:1024 sc1
    s_add_u32 s32, s32, 1536
    s_waitcnt vmcnt(0)
    v_mfma_f32_32x32x16_bf16 v[96:111], v[176:179], v[16:19], 0
    v_mfma_f32_32x32x8_bf16 v[96:111], v[180:181], v[14:15], v[96:111]
    s_nop 15
    v_max3_f32 v10, v96, v97, v10
    v_max3_f32 v10, v98, v99, v10
    v_max3_f32 v10, v100, v101, v10
    v_max3_f32 v10, v102, v103, v10
    v_max3_f32 v10, v104, v105, v10
    v_max3_f32 v10, v106, v107, v10
    v_max3_f32 v10, v108, v109, v10
    v_max3_f32 v10, v110, v111, v10
    s_cmp_lt_u32 s32, 3244032
    s_cbranch_scc1 fbx_e
    v_mov_b32 v6, v10
    s_nop 1
    v_permlane32_swap_b32 v10, v6
    s_nop 1
    v_max_f32 v10, v10, v6
    v_xor_b32 v10, 0x80000000, v10
    v_and_b32 v6, 0xffff0000, v10
    v_sub_f32 v7, v10, v6
    v_and_b32 v8, 0xffff0000, v7
    v_sub_f32 v7, v7, v8
    v_lshrrev_b32 v6, 16, v6
    v_or_b32 v12, v6, v8
    v_lshrrev_b32 v13, 16, v7
    s_mov_b32 exec_lo, 0
    v_mov_b64 v[14:15], v[12:13]
    s_mov_b32 exec_lo, -1
    v_mov_b64 v[160:161], 0
    v_mov_b64 v[162:163], 0
    v_mov_b64 v[164:165], 0
    v_mov_b64 v[166:167], 0
    v_mov_b64 v[168:169], 0
    v_mov_b64 v[170:171], 0
    v_mov_b64 v[172:173], 0
    v_mov_b64 v[174:175], 0
    s_mov_b32 s32, 3145728
    s_mov_b32 s35, 3276800
fbm_e:
    buffer_load_dwordx4 v[176:179], v2, s[16:19], s32 offen sc1
    buffer_load_dwordx2 v[180:181], v3, s[16:19], s32 offen offset:1024 sc1
    s_add_u32 s32, s32, 1536
    buffer_load_dwordx4 v[192:195], v2, s[16:19], s35 offen sc1
    buffer_load_dwordx4 v[196:199], v2, s[16:19], s35 offen offset:1024 sc1
    s_add_u32 s35, s35, 2048
    s_waitcnt vmcnt(0)
    v_mfma_f32_32x32x16_bf16 v[96:111], v[176:179], v[16:19], 0
    v_mfma_f32_32x32x8_bf16 v[96:111], v[180:181], v[14:15], v[96:111]
    s_nop 15
    v_exp_f32 v96, v96
    v_exp_f32 v97, v97
    v_exp_f32 v98, v98
    v_exp_f32 v99, v99
    v_exp_f32 v100, v100
    v_exp_f32 v101, v101
    v_exp_f32 v102, v102
    v_exp_f32 v103, v103
    v_exp_f32 v104, v104
    v_exp_f32 v105, v105
    v_exp_f32 v106, v106
    v_exp_f32 v107, v107
    v_exp_f32 v108, v108
    v_exp_f32 v109, v109
    v_exp_f32 v110, v110
    v_exp_f32 v111, v111
    s_nop 1
    v_smfmac_f32_32x32x32_bf16 v[160:175], v[192:195], v[96:103], v4
    v_smfmac_f32_32x32x32_bf16 v[160:175], v[196:199], v[104:111], v4
    s_cmp_lt_u32 s32, 3244032
    s_cbranch_scc1 fbm_e
    s_nop 15
    v_mov_b32 v6, v168
    v_mov_b32 v7, v168
    v_pk_mul_f32 v[12:13], v[160:161], 0 op_sel_hi:[1,0]
    s_nop 0
    v_permlane32_swap_b32 v6, v7
    v_pk_fma_f32 v[12:13], v[162:163], 0, v[12:13] op_sel_hi:[1,0,1]
    v_pk_fma_f32 v[12:13], v[164:165], 0, v[12:13] op_sel_hi:[1,0,1]
    v_pk_fma_f32 v[12:13], v[166:167], 0, v[12:13] op_sel_hi:[1,0,1]
    v_pk_fma_f32 v[12:13], v[168:169], 0, v[12:13] op_sel_hi:[1,0,1]
    v_pk_fma_f32 v[12:13], v[170:171], 0, v[12:13] op_sel_hi:[1,0,1]
    v_rcp_f32 v6, v7
    v_cmp_u_f32 vcc, v12, v13
    v_cmp_ngt_f32 s[84:85], v7, 0
    v_pk_mul_f32 v[160:161], v[160:161], v[6:7] op_sel_hi:[1,0]
    v_pk_mul_f32 v[162:163], v[162:163], v[6:7] op_sel_hi:[1,0]
    v_pk_mul_f32 v[164:165], v[164:165], v[6:7] op_sel_hi:[1,0]
    v_pk_mul_f32 v[166:167], v[166:167], v[6:7] op_sel_hi:[1,0]
    v_pk_mul_f32 v[168:169], v[168:169], v[6:7] op_sel_hi:[1,0]
    v_pk_mul_f32 v[170:171], v[170:171], v[6:7] op_sel_hi:[1,0]
    v_cvt_pk_bf16_f32 v144, v160, v161
    v_cvt_pk_bf16_f32 v145, v162, v163
    v_cvt_pk_bf16_f32 v146, v164, v165
    v_cvt_pk_bf16_f32 v147, v166, v167
    v_cvt_pk_bf16_f32 v148, v168, v169
    v_cvt_pk_bf16_f32 v149, v170, v171
    v_min_u32 v144, -2, v144
    v_min_u32 v145, -2, v145
    v_min_u32 v146, -2, v146
    v_min_u32 v147, -2, v147
    v_min_u32 v148, -2, v148
    v_min_u32 v149, -2, v149
    s_or_b64 s[84:85], vcc, s[84:85]
    v_cmp_ngt_f32 vcc, 0x7b800000, v7
    s_nop 1
    s_or_b64 vcc, vcc, s[84:85]
    s_branch st_e
e_done:
    s_nop 0
    v_smfmac_f32_32x32x32_bf16 v[208:223], v[92:95], v[152:159], v4
    v_mov_b64 v[14:15], v[32:33]
    s_cbranch_vccz e_have
    s_cmp_lg_u32 s28, 0
    s_cbranch_scc1 w0_79
    buffer_load_dword v11, v5, s[16:19], 0 offen sc1
    s_mov_b32 s78, 0
e_pl:
    s_waitcnt vmcnt(0)
    v_cmp_le_u32 vcc, 16, v11
    s_nop 0
    s_cmp_eq_u64 vcc, exec
    s_cbranch_scc1 e_pd
    s_add_u32 s78, s78, 1
    s_cmp_gt_u32 s78, 0x8000
    s_cbranch_scc1 e_pd
    s_sleep 4
    buffer_load_dword v11, v5, s[16:19], 0 offen sc1
    s_branch e_pl
e_pd:
    v_mov_b32 v6, 159772
    v_mov_b32 v7, 1
    ds_write_b32 v6, v7
w0_79:
    s_mov_b32 s38, 159772
    v_mov_b32 v6, s38
    s_mov_b32 s78, 0
lsp_80:
    ds_read_b32 v7, v6
    s_add_u32 s78, s78, 1
    s_waitcnt lgkmcnt(0)
    v_readfirstlane_b32 s83, v7
    s_cmp_gt_u32 s78, 0x40000
    s_cbranch_scc1 lso_81
    s_cmp_ge_u32 s83, 1
    s_cbranch_scc1 lso_81
    s_sleep 1
    s_branch lsp_80
lso_81:
    s_add_u32 s75, s75, 1
    s_sub_u32 s36, s75, 12
    s_cmp_ge_u32 s75, 12
    s_cselect_b32 s75, s36, s75
    s_lshl_b32 s76, s75, 13
    s_mul_i32 s77, s75, 20480
    s_add_u32 s77, s77, s33
    buffer_load_dwordx4 v[224:227], v2, s[16:19], s77 offen offset:0 sc1
    buffer_load_dwordx4 v[228:231], v2, s[16:19], s77 offen offset:1024 sc1
    buffer_load_dwordx4 v[232:235], v2, s[16:19], s77 offen offset:2048 sc1
    buffer_load_dwordx4 v[236:239], v2, s[16:19], s77 offen offset:3072 sc1
    s_add_u32 s77, s77, 4096
    buffer_load_dwordx4 v[244:247], v2, s[16:19], s77 offen offset:0 sc1
    s_add_u32 s82, s64, s76
    buffer_load_dwordx4 v[248:251], v0, s[16:19], s82 offen sc1
    s_add_u32 s82, s65, s76
    buffer_load_dwordx4 v[40:43], v0, s[16:19], s82 offen sc1
    s_add_u32 s82, s66, s76
    buffer_load_dwordx4 v[64:67], v0, s[16:19], s82 offen sc1
    s_add_u32 s82, s69, s76
    buffer_load_dwordx4 v[68:71], v0, s[16:19], s82 offen sc1
    s_add_u32 s75, s75, 1
    s_sub_u32 s36, s75, 12
    s_cmp_ge_u32 s75, 12
    s_cselect_b32 s75, s36, s75
    s_lshl_b32 s76, s75, 13
    s_mul_i32 s77, s75, 20480
    s_add_u32 s77, s77, s33
    buffer_load_dwordx4 v[44:47], v2, s[16:19], s77 offen offset:0 sc1
    buffer_load_dwordx4 v[72:75], v2, s[16:19], s77 offen offset:1024 sc1
    buffer_load_dwordx4 v[76:79], v2, s[16:19], s77 offen offset:2048 sc1
    buffer_load_dwordx4 v[48:51], v2, s[16:19], s77 offen offset:3072 sc1
    s_add_u32 s77, s77, 4096
    buffer_load_dwordx4 v[80:83], v2, s[16:19], s77 offen offset:0 sc1
    s_add_u32 s82, s64, s76
    buffer_load_dwordx4 v[84:87], v0, s[16:19], s82 offen sc1
    s_add_u32 s82, s65, s76
    buffer_load_dwordx4 v[52:55], v0, s[16:19], s82 offen sc1
    s_add_u32 s82, s66, s76
    buffer_load_dwordx4 v[56:59], v0, s[16:19], s82 offen sc1
    s_add_u32 s82, s69, s76
    buffer_load_dwordx4 v[60:63], v0, s[16:19], s82 offen sc1
e_have:
    s_mov_b32 s36, 114688
    s_add_u32 s37, s74, 1
    s_and_b32 s37, s37, 3
    s_mul_i32 s37, s37, 9216
    s_add_u32 s37, s37, s36
    v_add_u32 v6, s37, v2
    ds_write_b128 v6, v[176:179] offset:0
    ds_write_b128 v6, v[180:183] offset:1024
    ds_write_b128 v6, v[184:187] offset:2048
    s_add_u32 s37, s74, 2
    s_and_b32 s37, s37, 3
    s_mul_i32 s37, s37, 9216
    s_add_u32 s37, s37, s36
    v_add_u32 v6, s37, v2
    ds_write_b128 v6, v[192:195] offset:3072
    ds_write_b128 v6, v[196:199] offset:4096
    ds_write_b128 v6, v[200:203] offset:5120
    s_add_u32 s37, s74, 3
    s_and_b32 s37, s37, 3
    s_mul_i32 s37, s37, 9216
    s_add_u32 s37, s37, s36
    v_add_u32 v6, s37, v2
    ds_write_b128 v6, v[208:211] offset:6144
    ds_write_b128 v6, v[212:215] offset:7168
    ds_write_b128 v6, v[216:219] offset:8192
    s_lshl_b32 s38, s72, 2
    s_add_u32 s38, s38, 159744
    v_mov_b32 v6, s38
    v_mov_b32 v7, 1
    s_mul_i32 s37, s74, 9216
    s_add_u32 s37, s37, s36
    v_add_u32 v9, s37, v2
    s_waitcnt lgkmcnt(0)
    s_mov_b64 exec, 1
    ds_add_u32 v6, v7
    s_mov_b64 exec, -1
    s_add_u32 s75, s75, 1
    s_sub_u32 s36, s75, 12
    s_cmp_ge_u32 s75, 12
    s_cselect_b32 s75, s36, s75
    s_lshl_b32 s76, s75, 13
    s_mul_i32 s77, s75, 20480
    s_add_u32 s77, s77, s33
    buffer_load_dwordx4 v[20:23], v2, s[16:19], s77 offen offset:0 sc1
    buffer_load_dwordx4 v[24:27], v2, s[16:19], s77 offen offset:1024 sc1
    buffer_load_dwordx4 v[28:31], v2, s[16:19], s77 offen offset:2048 sc1
    buffer_load_dwordx4 v[36:39], v2, s[16:19], s77 offen offset:3072 sc1
    s_add_u32 s77, s77, 4096
    buffer_load_dwordx4 v[88:91], v2, s[16:19], s77 offen offset:0 sc1
    s_add_u32 s82, s64, s76
    buffer_load_dwordx4 v[92:95], v0, s[16:19], s82 offen sc1
    v_mov_b32 v6, s38
    s_mov_b32 s78, 0
lsp_82:
    ds_read_b32 v7, v6
    s_add_u32 s78, s78, 1
    s_waitcnt lgkmcnt(0)
    v_readfirstlane_b32 s83, v7
    s_cmp_gt_u32 s78, 0x40000
    s_cbranch_scc1 lso_83
    s_cmp_ge_u32 s83, 4
    s_cbranch_scc1 lso_83
    s_branch lsp_82
lso_83:
    ds_read_b128 v[96:99], v9 offset:0
    ds_read_b128 v[100:103], v9 offset:1024
    ds_read_b128 v[104:107], v9 offset:2048
    ds_read_b128 v[112:115], v9 offset:3072
    ds_read_b128 v[116:119], v9 offset:4096
    ds_read_b128 v[120:123], v9 offset:5120
    ds_read_b128 v[128:131], v9 offset:6144
    ds_read_b128 v[132:135], v9 offset:7168
    ds_read_b128 v[136:139], v9 offset:8192
    s_lshl_b32 s36, s79, 1
    s_and_b32 s37, s74, 1
    s_add_u32 s36, s36, s37
    s_mul_i32 s36, s36, 136
    s_mul_i32 s37, s72, 20
    s_add_u32 s36, s36, s37
    s_lshl_b32 s36, s36, 10
    s_add_u32 s36, s36, 4292608
    s_lshr_b32 s39, s74, 1
    s_lshl_b32 s37, s73, 1
    s_add_u32 s37, s37, s39
    s_lshl_b32 s37, s37, 10
    s_add_u32 s37, s37, s36
    s_lshl_b32 s83, s73, 9
    s_add_u32 s36, s36, s83
    s_lshl_b32 s39, s39, 3
    s_add_u32 s36, s36, s39
    s_add_u32 s36, s36, 16384
    s_waitcnt lgkmcnt(6)
    v_pk_add_f32 v[160:161], v[160:161], v[96:97]
    v_pk_add_f32 v[162:163], v[162:163], v[98:99]
    v_pk_add_f32 v[164:165], v[164:165], v[100:101]
    v_pk_add_f32 v[166:167], v[166:167], v[102:103]
    v_pk_add_f32 v[168:169], v[168:169], v[104:105]
    v_pk_add_f32 v[170:171], v[170:171], v[106:107]
    s_waitcnt lgkmcnt(3)
    v_pk_add_f32 v[160:161], v[160:161], v[112:113]
    v_pk_add_f32 v[162:163], v[162:163], v[114:115]
    v_pk_add_f32 v[164:165], v[164:165], v[116:117]
    v_pk_add_f32 v[166:167], v[166:167], v[118:119]
    v_pk_add_f32 v[168:169], v[168:169], v[120:121]
    v_pk_add_f32 v[170:171], v[170:171], v[122:123]
    s_waitcnt lgkmcnt(0)
    v_pk_add_f32 v[160:161], v[160:161], v[128:129]
    v_pk_add_f32 v[162:163], v[162:163], v[130:131]
    v_pk_add_f32 v[164:165], v[164:165], v[132:133]
    v_pk_add_f32 v[166:167], v[166:167], v[134:135]
    v_pk_add_f32 v[168:169], v[168:169], v[136:137]
    v_pk_add_f32 v[170:171], v[170:171], v[138:139]
    v_mov_b32 v6, 159796
    v_mov_b32 v7, 1
    s_mov_b64 exec, 1
    ds_add_u32 v6, v7
    s_mov_b64 exec, -1
    v_mov_b32 v6, v168
    v_mov_b32 v7, v168
    v_pk_mul_f32 v[12:13], v[160:161], 0 op_sel_hi:[1,0]
    s_nop 0
    v_permlane32_swap_b32 v6, v7
    v_pk_fma_f32 v[12:13], v[162:163], 0, v[12:13] op_sel_hi:[1,0,1]
    v_pk_fma_f32 v[12:13], v[164:165], 0, v[12:13] op_sel_hi:[1,0,1]
    v_pk_fma_f32 v[12:13], v[166:167], 0, v[12:13] op_sel_hi:[1,0,1]
    v_pk_fma_f32 v[12:13], v[168:169], 0, v[12:13] op_sel_hi:[1,0,1]
    v_pk_fma_f32 v[12:13], v[170:171], 0, v[12:13] op_sel_hi:[1,0,1]
    v_rcp_f32 v6, v7
    v_cmp_u_f32 vcc, v12, v13
    v_cmp_ngt_f32 s[84:85], v7, 0
    v_pk_mul_f32 v[160:161], v[160:161], v[6:7] op_sel_hi:[1,0]
    v_pk_mul_f32 v[162:163], v[162:163], v[6:7] op_sel_hi:[1,0]
    v_pk_mul_f32 v[164:165], v[164:165], v[6:7] op_sel_hi:[1,0]
    v_pk_mul_f32 v[166:167], v[166:167], v[6:7] op_sel_hi:[1,0]
    v_pk_mul_f32 v[168:169], v[168:169], v[6:7] op_sel_hi:[1,0]
    v_pk_mul_f32 v[170:171], v[170:171], v[6:7] op_sel_hi:[1,0]
    v_cvt_pk_bf16_f32 v144, v160, v161
    v_cvt_pk_bf16_f32 v145, v162, v163
    v_cvt_pk_bf16_f32 v146, v164, v165
    v_cvt_pk_bf16_f32 v147, v166, v167
    v_cvt_pk_bf16_f32 v148, v168, v169
    v_cvt_pk_bf16_f32 v149, v170, v171
    v_min_u32 v144, -2, v144
    v_min_u32 v145, -2, v145
    v_min_u32 v146, -2, v146
    v_min_u32 v147, -2, v147
    v_min_u32 v148, -2, v148
    v_min_u32 v149, -2, v149
    s_or_b64 s[84:85], vcc, s[84:85]
    v_cmp_ngt_f32 vcc, 0x7b800000, v7
    s_nop 1
    s_or_b64 vcc, vcc, s[84:85]
    s_cbranch_vccnz fb_e
st_e:
    buffer_store_dwordx4 v[144:147], v2, s[16:19], s37 offen sc1
    s_mov_b32 exec_hi, 0
    buffer_store_dwordx2 v[148:149], v2, s[16:19], s36 offen sc1
    s_mov_b32 exec_hi, -1
    v_lshrrev_b32 v6, 4, v1
    v_and_b32 v8, 15, v1
    s_lshl_b32 s36, s79, 6
    s_lshl_b32 s37, s28, 4
    s_add_u32 s36, s36, s37
    v_add_u32 v8, s36, v8
    v_mul_u32_u24 v10, 1280, v8
    v_lshl_add_u32 v10, v6, 3, v10
    s_mul_i32 s36, s73, 160
    v_add_u32 v10, s36, v10
    s_lshr_b32 s36, s79, 3
    s_lshl_b32 s36, s36, 2
    s_and_b32 s37, s79, 7
    s_lshl_b32 s37, s37, 9
    s_add_u32 s36, s36, s37
    s_add_u32 s36, s36, 4079616
    v_and_b32 v6, 1, v1
    v_lshlrev_b32 v6, 12, v6
    v_bfe_u32 v7, v1, 1, 2
    v_lshl_add_u32 v6, v7, 7, v6
    v_add_u32 v12, s36, v6
    s_add_u32 s82, s65, s76
    buffer_load_dwordx4 v[176:179], v0, s[16:19], s82 offen sc1
    s_add_u32 s82, s66, s76
    buffer_load_dwordx4 v[180:183], v0, s[16:19], s82 offen sc1
    s_add_u32 s82, s69, s76
    buffer_load_dwordx4 v[184:187], v0, s[16:19], s82 offen sc1
    s_add_u32 s75, s75, 1
    s_sub_u32 s36, s75, 12
    s_cmp_ge_u32 s75, 12
    s_cselect_b32 s75, s36, s75
    s_lshl_b32 s76, s75, 13
    s_mul_i32 s77, s75, 20480
    s_add_u32 s77, s77, s33
    buffer_load_dwordx4 v[188:191], v2, s[16:19], s77 offen offset:0 sc1
    buffer_load_dwordx4 v[192:195], v2, s[16:19], s77 offen offset:1024 sc1
    buffer_load_dwordx4 v[196:199], v2, s[16:19], s77 offen offset:2048 sc1
    buffer_load_dwordx4 v[200:203], v2, s[16:19], s77 offen offset:3072 sc1
    s_add_u32 s77, s77, 4096
    buffer_load_dwordx4 v[204:207], v2, s[16:19], s77 offen offset:0 sc1
    s_add_u32 s82, s64, s76
    buffer_load_dwordx4 v[208:211], v0, s[16:19], s82 offen sc1
    s_add_u32 s82, s65, s76
    buffer_load_dwordx4 v[212:215], v0, s[16:19], s82 offen sc1
    s_add_u32 s82, s66, s76
    buffer_load_dwordx4 v[216:219], v0, s[16:19], s82 offen sc1
    s_add_u32 s82, s69, s76
    buffer_load_dwordx4 v[220:223], v0, s[16:19], s82 offen sc1
    buffer_load_dwordx2 v[16:17], v10, s[4:7], 0 offen offset:0
    buffer_load_dwordx2 v[18:19], v10, s[4:7], 0 offen offset:32
    buffer_load_dwordx2 v[32:33], v10, s[4:7], 0 offen offset:64
    buffer_load_dwordx2 v[34:35], v10, s[4:7], 0 offen offset:96
    buffer_load_dwordx2 v[252:253], v10, s[4:7], 0 offen offset:128
    s_waitcnt vmcnt(34)
    v_mfma_f32_16x16x32_bf16 v[96:99], v[224:227], v[248:251], 0
    v_mfma_f32_16x16x32_bf16 v[100:103], v[224:227], v[40:43], 0
    v_mfma_f32_16x16x32_bf16 v[104:107], v[224:227], v[64:67], 0
    v_mfma_f32_16x16x32_bf16 v[108:111], v[224:227], v[68:71], 0
    s_add_u32 s75, s75, 1
    s_sub_u32 s36, s75, 12
    s_cmp_ge_u32 s75, 12
    s_cselect_b32 s75, s36, s75
    s_lshl_b32 s76, s75, 13
    s_mul_i32 s77, s75, 20480
    s_add_u32 s77, s77, s33
    buffer_load_dwordx4 v[224:227], v2, s[16:19], s77 offen offset:0 sc1
    v_mfma_f32_16x16x32_bf16 v[112:115], v[228:231], v[248:251], 0
    v_mfma_f32_16x16x32_bf16 v[116:119], v[228:231], v[40:43], 0
    v_mfma_f32_16x16x32_bf16 v[120:123], v[228:231], v[64:67], 0
    v_mfma_f32_16x16x32_bf16 v[124:127], v[228:231], v[68:71], 0
    buffer_load_dwordx4 v[228:231], v2, s[16:19], s77 offen offset:1024 sc1
    v_mfma_f32_16x16x32_bf16 v[128:131], v[232:235], v[248:251], 0
    v_mfma_f32_16x16x32_bf16 v[132:135], v[232:235], v[40:43], 0
    v_mfma_f32_16x16x32_bf16 v[136:139], v[232:235], v[64:67], 0
    v_mfma_f32_16x16x32_bf16 v[140:143], v[232:235], v[68:71], 0
    buffer_load_dwordx4 v[232:235], v2, s[16:19], s77 offen offset:2048 sc1
    v_mfma_f32_16x16x32_bf16 v[144:147], v[236:239], v[248:251], 0
    v_mfma_f32_16x16x32_bf16 v[148:151], v[236:239], v[40:43], 0
    v_mfma_f32_16x16x32_bf16 v[152:155], v[236:239], v[64:67], 0
    v_mfma_f32_16x16x32_bf16 v[156:159], v[236:239], v[68:71], 0
    buffer_load_dwordx4 v[236:239], v2, s[16:19], s77 offen offset:3072 sc1
    v_mfma_f32_16x16x32_bf16 v[160:163], v[244:247], v[248:251], 0
    v_mfma_f32_16x16x32_bf16 v[164:167], v[244:247], v[40:43], 0
    v_mfma_f32_16x16x32_bf16 v[168:171], v[244:247], v[64:67], 0
    v_mfma_f32_16x16x32_bf16 v[172:175], v[244:247], v[68:71], 0
    s_add_u32 s77, s77, 4096
    buffer_load_dwordx4 v[244:247], v2, s[16:19], s77 offen offset:0 sc1
    s_add_u32 s82, s64, s76
    buffer_load_dwordx4 v[248:251], v0, s[16:19], s82 offen sc1
    s_add_u32 s82, s65, s76
    buffer_load_dwordx4 v[40:43], v0, s[16:19], s82 offen sc1
    s_add_u32 s82, s66, s76
    buffer_load_dwordx4 v[64:67], v0, s[16:19], s82 offen sc1
    s_add_u32 s82, s69, s76
    buffer_load_dwordx4 v[68:71], v0, s[16:19], s82 offen sc1
    s_waitcnt vmcnt(34)
    v_mfma_f32_16x16x32_bf16 v[96:99], v[44:47], v[84:87], v[96:99]
    v_mfma_f32_16x16x32_bf16 v[100:103], v[44:47], v[52:55], v[100:103]
    v_mfma_f32_16x16x32_bf16 v[104:107], v[44:47], v[56:59], v[104:107]
    v_mfma_f32_16x16x32_bf16 v[108:111], v[44:47], v[60:63], v[108:111]
    s_add_u32 s75, s75, 1
    s_sub_u32 s36, s75, 12
    s_cmp_ge_u32 s75, 12
    s_cselect_b32 s75, s36, s75
    s_lshl_b32 s76, s75, 13
    s_mul_i32 s77, s75, 20480
    s_add_u32 s77, s77, s33
    buffer_load_dwordx4 v[44:47], v2, s[16:19], s77 offen offset:0 sc1
    v_mfma_f32_16x16x32_bf16 v[112:115], v[72:75], v[84:87], v[112:115]
    v_mfma_f32_16x16x32_bf16 v[116:119], v[72:75], v[52:55], v[116:119]
    v_mfma_f32_16x16x32_bf16 v[120:123], v[72:75], v[56:59], v[120:123]
    v_mfma_f32_16x16x32_bf16 v[124:127], v[72:75], v[60:63], v[124:127]
    buffer_load_dwordx4 v[72:75], v2, s[16:19], s77 offen offset:1024 sc1
    v_mfma_f32_16x16x32_bf16 v[128:131], v[76:79], v[84:87], v[128:131]
    v_mfma_f32_16x16x32_bf16 v[132:135], v[76:79], v[52:55], v[132:135]
    v_mfma_f32_16x16x32_bf16 v[136:139], v[76:79], v[56:59], v[136:139]
    v_mfma_f32_16x16x32_bf16 v[140:143], v[76:79], v[60:63], v[140:143]
    buffer_load_dwordx4 v[76:79], v2, s[16:19], s77 offen offset:2048 sc1
    v_mfma_f32_16x16x32_bf16 v[144:147], v[48:51], v[84:87], v[144:147]
    v_mfma_f32_16x16x32_bf16 v[148:151], v[48:51], v[52:55], v[148:151]
    v_mfma_f32_16x16x32_bf16 v[152:155], v[48:51], v[56:59], v[152:155]
    v_mfma_f32_16x16x32_bf16 v[156:159], v[48:51], v[60:63], v[156:159]
    buffer_load_dwordx4 v[48:51], v2, s[16:19], s77 offen offset:3072 sc1
    v_mfma_f32_16x16x32_bf16 v[160:163], v[80:83], v[84:87], v[160:163]
    v_mfma_f32_16x16x32_bf16 v[164:167], v[80:83], v[52:55], v[164:167]
    v_mfma_f32_16x16x32_bf16 v[168:171], v[80:83], v[56:59], v[168:171]
    v_mfma_f32_16x16x32_bf16 v[172:175], v[80:83], v[60:63], v[172:175]
    s_add_u32 s77, s77, 4096
    buffer_load_dwordx4 v[80:83], v2, s[16:19], s77 offen offset:0 sc1
    s_add_u32 s82, s64, s76
    buffer_load_dwordx4 v[84:87], v0, s[16:19], s82 offen sc1
    s_add_u32 s82, s65, s76
    buffer_load_dwordx4 v[52:55], v0, s[16:19], s82 offen sc1
    s_add_u32 s82, s66, s76
    buffer_load_dwordx4 v[56:59], v0, s[16:19], s82 offen sc1
    s_add_u32 s82, s69, s76
    buffer_load_dwordx4 v[60:63], v0, s[16:19], s82 offen sc1
    s_waitcnt vmcnt(32)
    v_mfma_f32_16x16x32_bf16 v[96:99], v[20:23], v[92:95], v[96:99]
    v_mfma_f32_16x16x32_bf16 v[100:103], v[20:23], v[176:179], v[100:103]
    v_mfma_f32_16x16x32_bf16 v[104:107], v[20:23], v[180:183], v[104:107]
    v_mfma_f32_16x16x32_bf16 v[108:111], v[20:23], v[184:187], v[108:111]
    s_add_u32 s75, s75, 1
    s_sub_u32 s36, s75, 12
    s_cmp_ge_u32 s75, 12
    s_cselect_b32 s75, s36, s75
    s_lshl_b32 s76, s75, 13
    s_mul_i32 s77, s75, 20480
    s_add_u32 s77, s77, s33
    buffer_load_dwordx4 v[20:23], v2, s[16:19], s77 offen offset:0 sc1
    v_mfma_f32_16x16x32_bf16 v[112:115], v[24:27], v[92:95], v[112:115]
    v_mfma_f32_16x16x32_bf16 v[116:119], v[24:27], v[176:179], v[116:119]
    v_mfma_f32_16x16x32_bf16 v[120:123], v[24:27], v[180:183], v[120:123]
    v_mfma_f32_16x16x32_bf16 v[124:127], v[24:27], v[184:187], v[124:127]
    buffer_load_dwordx4 v[24:27], v2, s[16:19], s77 offen offset:1024 sc1
    v_mfma_f32_16x16x32_bf16 v[128:131], v[28:31], v[92:95], v[128:131]
    v_mfma_f32_16x16x32_bf16 v[132:135], v[28:31], v[176:179], v[132:135]
    v_mfma_f32_16x16x32_bf16 v[136:139], v[28:31], v[180:183], v[136:139]
    v_mfma_f32_16x16x32_bf16 v[140:143], v[28:31], v[184:187], v[140:143]
    buffer_load_dwordx4 v[28:31], v2, s[16:19], s77 offen offset:2048 sc1
    v_mfma_f32_16x16x32_bf16 v[144:147], v[36:39], v[92:95], v[144:147]
    v_mfma_f32_16x16x32_bf16 v[148:151], v[36:39], v[176:179], v[148:151]
    v_mfma_f32_16x16x32_bf16 v[152:155], v[36:39], v[180:183], v[152:155]
    v_mfma_f32_16x16x32_bf16 v[156:159], v[36:39], v[184:187], v[156:159]
    buffer_load_dwordx4 v[36:39], v2, s[16:19], s77 offen offset:3072 sc1
    v_mfma_f32_16x16x32_bf16 v[160:163], v[88:91], v[92:95], v[160:163]
    v_mfma_f32_16x16x32_bf16 v[164:167], v[88:91], v[176:179], v[164:167]
    v_mfma_f32_16x16x32_bf16 v[168:171], v[88:91], v[180:183], v[168:171]
    v_mfma_f32_16x16x32_bf16 v[172:175], v[88:91], v[184:187], v[172:175]
    s_add_u32 s77, s77, 4096
    buffer_load_dwordx4 v[88:91], v2, s[16:19], s77 offen offset:0 sc1
    s_add_u32 s82, s64, s76
    buffer_load_dwordx4 v[92:95], v0, s[16:19], s82 offen sc1
    s_add_u32 s82, s65, s76
    buffer_load_dwordx4 v[176:179], v0, s[16:19], s82 offen sc1
    s_add_u32 s82, s66, s76
    buffer_load_dwordx4 v[180:183], v0, s[16:19], s82 offen sc1
    s_add_u32 s82, s69, s76
    buffer_load_dwordx4 v[184:187], v0, s[16:19], s82 offen sc1
    s_waitcnt vmcnt(32)
    v_mfma_f32_16x16x32_bf16 v[96:99], v[188:191], v[208:211], v[96:99]
    v_mfma_f32_16x16x32_bf16 v[100:103], v[188:191], v[212:215], v[100:103]
    v_mfma_f32_16x16x32_bf16 v[104:107], v[188:191], v[216:219], v[104:107]
    v_mfma_f32_16x16x32_bf16 v[108:111], v[188:191], v[220:223], v[108:111]
    s_add_u32 s75, s75, 1
    s_sub_u32 s36, s75, 12
    s_cmp_ge_u32 s75, 12
    s_cselect_b32 s75, s36, s75
    s_lshl_b32 s76, s75, 13
    s_mul_i32 s77, s75, 20480
    s_add_u32 s77, s77, s33
    buffer_load_dwordx4 v[188:191], v2, s[16:19], s77 offen offset:0 sc1
    v_mfma_f32_16x16x32_bf16 v[112:115], v[192:195], v[208:211], v[112:115]
    v_mfma_f32_16x16x32_bf16 v[116:119], v[192:195], v[212:215], v[116:119]
    v_mfma_f32_16x16x32_bf16 v[120:123], v[192:195], v[216:219], v[120:123]
    v_mfma_f32_16x16x32_bf16 v[124:127], v[192:195], v[220:223], v[124:127]
    buffer_load_dwordx4 v[192:195], v2, s[16:19], s77 offen offset:1024 sc1
    v_mfma_f32_16x16x32_bf16 v[128:131], v[196:199], v[208:211], v[128:131]
    v_mfma_f32_16x16x32_bf16 v[132:135], v[196:199], v[212:215], v[132:135]
    v_mfma_f32_16x16x32_bf16 v[136:139], v[196:199], v[216:219], v[136:139]
    v_mfma_f32_16x16x32_bf16 v[140:143], v[196:199], v[220:223], v[140:143]
    buffer_load_dwordx4 v[196:199], v2, s[16:19], s77 offen offset:2048 sc1
    v_mfma_f32_16x16x32_bf16 v[144:147], v[200:203], v[208:211], v[144:147]
    v_mfma_f32_16x16x32_bf16 v[148:151], v[200:203], v[212:215], v[148:151]
    v_mfma_f32_16x16x32_bf16 v[152:155], v[200:203], v[216:219], v[152:155]
    v_mfma_f32_16x16x32_bf16 v[156:159], v[200:203], v[220:223], v[156:159]
    buffer_load_dwordx4 v[200:203], v2, s[16:19], s77 offen offset:3072 sc1
    v_mfma_f32_16x16x32_bf16 v[160:163], v[204:207], v[208:211], v[160:163]
    v_mfma_f32_16x16x32_bf16 v[164:167], v[204:207], v[212:215], v[164:167]
    v_mfma_f32_16x16x32_bf16 v[168:171], v[204:207], v[216:219], v[168:171]
    v_mfma_f32_16x16x32_bf16 v[172:175], v[204:207], v[220:223], v[172:175]
    s_add_u32 s77, s77, 4096
    buffer_load_dwordx4 v[204:207], v2, s[16:19], s77 offen offset:0 sc1
    s_add_u32 s82, s64, s76
    buffer_load_dwordx4 v[208:211], v0, s[16:19], s82 offen sc1
    s_add_u32 s82, s65, s76
    buffer_load_dwordx4 v[212:215], v0, s[16:19], s82 offen sc1
    s_add_u32 s82, s66, s76
    buffer_load_dwordx4 v[216:219], v0, s[16:19], s82 offen sc1
    s_add_u32 s82, s69, s76
    buffer_load_dwordx4 v[220:223], v0, s[16:19], s82 offen sc1
    s_waitcnt vmcnt(27)
    v_mfma_f32_16x16x32_bf16 v[96:99], v[224:227], v[248:251], v[96:99]
    v_mfma_f32_16x16x32_bf16 v[100:103], v[224:227], v[40:43], v[100:103]
    v_mfma_f32_16x16x32_bf16 v[104:107], v[224:227], v[64:67], v[104:107]
    v_mfma_f32_16x16x32_bf16 v[108:111], v[224:227], v[68:71], v[108:111]
    s_add_u32 s75, s75, 1
    s_sub_u32 s36, s75, 12
    s_cmp_ge_u32 s75, 12
    s_cselect_b32 s75, s36, s75
    s_lshl_b32 s76, s75, 13
    s_mul_i32 s77, s75, 20480
    s_add_u32 s77, s77, s33
    buffer_load_dwordx4 v[224:227], v2, s[16:19], s77 offen offset:0 sc1
    v_mfma_f32_16x16x32_bf16 v[112:115], v[228:231], v[248:251], v[112:115]
    v_mfma_f32_16x16x32_bf16 v[116:119], v[228:231], v[40:43], v[116:119]
    v_mfma_f32_16x16x32_bf16 v[120:123], v[228:231], v[64:67], v[120:123]
    v_mfma_f32_16x16x32_bf16 v[124:127], v[228:231], v[68:71], v[124:127]
    buffer_load_dwordx4 v[228:231], v2, s[16:19], s77 offen offset:1024 sc1
    v_mfma_f32_16x16x32_bf16 v[128:131], v[232:235], v[248:251], v[128:131]
    v_mfma_f32_16x16x32_bf16 v[132:135], v[232:235], v[40:43], v[132:135]
    v_mfma_f32_16x16x32_bf16 v[136:139], v[232:235], v[64:67], v[136:139]
    v_mfma_f32_16x16x32_bf16 v[140:143], v[232:235], v[68:71], v[140:143]
    buffer_load_dwordx4 v[232:235], v2, s[16:19], s77 offen offset:2048 sc1
    v_mfma_f32_16x16x32_bf16 v[144:147], v[236:239], v[248:251], v[144:147]
    v_mfma_f32_16x16x32_bf16 v[148:151], v[236:239], v[40:43], v[148:151]
    v_mfma_f32_16x16x32_bf16 v[152:155], v[236:239], v[64:67], v[152:155]
    v_mfma_f32_16x16x32_bf16 v[156:159], v[236:239], v[68:71], v[156:159]
    buffer_load_dwordx4 v[236:239], v2, s[16:19], s77 offen offset:3072 sc1
    v_mfma_f32_16x16x32_bf16 v[160:163], v[244:247], v[248:251], v[160:163]
    v_mfma_f32_16x16x32_bf16 v[164:167], v[244:247], v[40:43], v[164:167]
    v_mfma_f32_16x16x32_bf16 v[168:171], v[244:247], v[64:67], v[168:171]
    v_mfma_f32_16x16x32_bf16 v[172:175], v[244:247], v[68:71], v[172:175]
    s_add_u32 s77, s77, 4096
    buffer_load_dwordx4 v[244:247], v2, s[16:19], s77 offen offset:0 sc1
    s_add_u32 s82, s64, s76
    buffer_load_dwordx4 v[248:251], v0, s[16:19], s82 offen sc1
    s_add_u32 s82, s65, s76
    buffer_load_dwordx4 v[40:43], v0, s[16:19], s82 offen sc1
    s_add_u32 s82, s66, s76
    buffer_load_dwordx4 v[64:67], v0, s[16:19], s82 offen sc1
    s_add_u32 s82, s69, s76
    buffer_load_dwordx4 v[68:71], v0, s[16:19], s82 offen sc1
    s_waitcnt vmcnt(27)
    v_mfma_f32_16x16x32_bf16 v[96:99], v[44:47], v[84:87], v[96:99]
    v_mfma_f32_16x16x32_bf16 v[100:103], v[44:47], v[52:55], v[100:103]
    v_mfma_f32_16x16x32_bf16 v[104:107], v[44:47], v[56:59], v[104:107]
    v_mfma_f32_16x16x32_bf16 v[108:111], v[44:47], v[60:63], v[108:111]
    s_add_u32 s75, s75, 1
    s_sub_u32 s36, s75, 12
    s_cmp_ge_u32 s75, 12
    s_cselect_b32 s75, s36, s75
    s_lshl_b32 s76, s75, 13
    s_mul_i32 s77, s75, 20480
    s_add_u32 s77, s77, s33
    buffer_load_dwordx4 v[44:47], v2, s[16:19], s77 offen offset:0 sc1
    v_mfma_f32_16x16x32_bf16 v[112:115], v[72:75], v[84:87], v[112:115]
    v_mfma_f32_16x16x32_bf16 v[116:119], v[72:75], v[52:55], v[116:119]
    v_mfma_f32_16x16x32_bf16 v[120:123], v[72:75], v[56:59], v[120:123]
    v_mfma_f32_16x16x32_bf16 v[124:127], v[72:75], v[60:63], v[124:127]
    buffer_load_dwordx4 v[72:75], v2, s[16:19], s77 offen offset:1024 sc1
    v_mfma_f32_16x16x32_bf16 v[128:131], v[76:79], v[84:87], v[128:131]
    v_mfma_f32_16x16x32_bf16 v[132:135], v[76:79], v[52:55], v[132:135]
    v_mfma_f32_16x16x32_bf16 v[136:139], v[76:79], v[56:59], v[136:139]
    v_mfma_f32_16x16x32_bf16 v[140:143], v[76:79], v[60:63], v[140:143]
    buffer_load_dwordx4 v[76:79], v2, s[16:19], s77 offen offset:2048 sc1
    v_mfma_f32_16x16x32_bf16 v[144:147], v[48:51], v[84:87], v[144:147]
    v_mfma_f32_16x16x32_bf16 v[148:151], v[48:51], v[52:55], v[148:151]
    v_mfma_f32_16x16x32_bf16 v[152:155], v[48:51], v[56:59], v[152:155]
    v_mfma_f32_16x16x32_bf16 v[156:159], v[48:51], v[60:63], v[156:159]
    buffer_load_dwordx4 v[48:51], v2, s[16:19], s77 offen offset:3072 sc1
    v_mfma_f32_16x16x32_bf16 v[160:163], v[80:83], v[84:87], v[160:163]
    v_mfma_f32_16x16x32_bf16 v[164:167], v[80:83], v[52:55], v[164:167]
    v_mfma_f32_16x16x32_bf16 v[168:171], v[80:83], v[56:59], v[168:171]
    v_mfma_f32_16x16x32_bf16 v[172:175], v[80:83], v[60:63], v[172:175]
    s_add_u32 s77, s77, 4096
    buffer_load_dwordx4 v[80:83], v2, s[16:19], s77 offen offset:0 sc1
    s_add_u32 s82, s64, s76
    buffer_load_dwordx4 v[84:87], v0, s[16:19], s82 offen sc1
    s_add_u32 s82, s65, s76
    buffer_load_dwordx4 v[52:55], v0, s[16:19], s82 offen sc1
    s_add_u32 s82, s66, s76
    buffer_load_dwordx4 v[56:59], v0, s[16:19], s82 offen sc1
    s_add_u32 s82, s69, s76
    buffer_load_dwordx4 v[60:63], v0, s[16:19], s82 offen sc1
    s_waitcnt vmcnt(27)
    v_mfma_f32_16x16x32_bf16 v[96:99], v[20:23], v[92:95], v[96:99]
    v_mfma_f32_16x16x32_bf16 v[100:103], v[20:23], v[176:179], v[100:103]
    v_mfma_f32_16x16x32_bf16 v[104:107], v[20:23], v[180:183], v[104:107]
    v_mfma_f32_16x16x32_bf16 v[108:111], v[20:23], v[184:187], v[108:111]
    s_add_u32 s75, s75, 1
    s_sub_u32 s36, s75, 12
    s_cmp_ge_u32 s75, 12
    s_cselect_b32 s75, s36, s75
    s_lshl_b32 s76, s75, 13
    s_mul_i32 s77, s75, 20480
    s_add_u32 s77, s77, s33
    buffer_load_dwordx4 v[20:23], v2, s[16:19], s77 offen offset:0 sc1
    v_mfma_f32_16x16x32_bf16 v[112:115], v[24:27], v[92:95], v[112:115]
    v_mfma_f32_16x16x32_bf16 v[116:119], v[24:27], v[176:179], v[116:119]
    v_mfma_f32_16x16x32_bf16 v[120:123], v[24:27], v[180:183], v[120:123]
    v_mfma_f32_16x16x32_bf16 v[124:127], v[24:27], v[184:187], v[124:127]
    buffer_load_dwordx4 v[24:27], v2, s[16:19], s77 offen offset:1024 sc1
    v_mfma_f32_16x16x32_bf16 v[128:131], v[28:31], v[92:95], v[128:131]
    v_mfma_f32_16x16x32_bf16 v[132:135], v[28:31], v[176:179], v[132:135]
    v_mfma_f32_16x16x32_bf16 v[136:139], v[28:31], v[180:183], v[136:139]
    v_mfma_f32_16x16x32_bf16 v[140:143], v[28:31], v[184:187], v[140:143]
    buffer_load_dwordx4 v[28:31], v2, s[16:19], s77 offen offset:2048 sc1
    v_mfma_f32_16x16x32_bf16 v[144:147], v[36:39], v[92:95], v[144:147]
    v_mfma_f32_16x16x32_bf16 v[148:151], v[36:39], v[176:179], v[148:151]
    v_mfma_f32_16x16x32_bf16 v[152:155], v[36:39], v[180:183], v[152:155]
    v_mfma_f32_16x16x32_bf16 v[156:159], v[36:39], v[184:187], v[156:159]
    buffer_load_dwordx4 v[36:39], v2, s[16:19], s77 offen offset:3072 sc1
    v_mfma_f32_16x16x32_bf16 v[160:163], v[88:91], v[92:95], v[160:163]
    v_mfma_f32_16x16x32_bf16 v[164:167], v[88:91], v[176:179], v[164:167]
    v_mfma_f32_16x16x32_bf16 v[168:171], v[88:91], v[180:183], v[168:171]
    v_mfma_f32_16x16x32_bf16 v[172:175], v[88:91], v[184:187], v[172:175]
    s_add_u32 s77, s77, 4096
    buffer_load_dwordx4 v[88:91], v2, s[16:19], s77 offen offset:0 sc1
    s_add_u32 s82, s64, s76
    buffer_load_dwordx4 v[92:95], v0, s[16:19], s82 offen sc1
    s_add_u32 s82, s65, s76
    buffer_load_dwordx4 v[176:179], v0, s[16:19], s82 offen sc1
    s_add_u32 s82, s66, s76
    buffer_load_dwordx4 v[180:183], v0, s[16:19], s82 offen sc1
    s_add_u32 s82, s69, s76
    buffer_load_dwordx4 v[184:187], v0, s[16:19], s82 offen sc1
    s_waitcnt vmcnt(27)
    v_mfma_f32_16x16x32_bf16 v[96:99], v[188:191], v[208:211], v[96:99]
    v_mfma_f32_16x16x32_bf16 v[100:103], v[188:191], v[212:215], v[100:103]
    v_mfma_f32_16x16x32_bf16 v[104:107], v[188:191], v[216:219], v[104:107]
    v_mfma_f32_16x16x32_bf16 v[108:111], v[188:191], v[220:223], v[108:111]
    s_add_u32 s75, s75, 1
    s_sub_u32 s36, s75, 12
    s_cmp_ge_u32 s75, 12
    s_cselect_b32 s75, s36, s75
    s_lshl_b32 s76, s75, 13
    s_mul_i32 s77, s75, 20480
    s_add_u32 s77, s77, s33
    buffer_load_dwordx4 v[188:191], v2, s[16:19], s77 offen offset:0 sc1
    v_mfma_f32_16x16x32_bf16 v[112:115], v[192:195], v[208:211], v[112:115]
    v_mfma_f32_16x16x32_bf16 v[116:119], v[192:195], v[212:215], v[116:119]
    v_mfma_f32_16x16x32_bf16 v[120:123], v[192:195], v[216:219], v[120:123]
    v_mfma_f32_16x16x32_bf16 v[124:127], v[192:195], v[220:223], v[124:127]
    buffer_load_dwordx4 v[192:195], v2, s[16:19], s77 offen offset:1024 sc1
    v_mfma_f32_16x16x32_bf16 v[128:131], v[196:199], v[208:211], v[128:131]
    v_mfma_f32_16x16x32_bf16 v[132:135], v[196:199], v[212:215], v[132:135]
    v_mfma_f32_16x16x32_bf16 v[136:139], v[196:199], v[216:219], v[136:139]
    v_mfma_f32_16x16x32_bf16 v[140:143], v[196:199], v[220:223], v[140:143]
    buffer_load_dwordx4 v[196:199], v2, s[16:19], s77 offen offset:2048 sc1
    v_mfma_f32_16x16x32_bf16 v[144:147], v[200:203], v[208:211], v[144:147]
    v_mfma_f32_16x16x32_bf16 v[148:151], v[200:203], v[212:215], v[148:151]
    v_mfma_f32_16x16x32_bf16 v[152:155], v[200:203], v[216:219], v[152:155]
    v_mfma_f32_16x16x32_bf16 v[156:159], v[200:203], v[220:223], v[156:159]
    buffer_load_dwordx4 v[200:203], v2, s[16:19], s77 offen offset:3072 sc1
    v_mfma_f32_16x16x32_bf16 v[160:163], v[204:207], v[208:211], v[160:163]
    v_mfma_f32_16x16x32_bf16 v[164:167], v[204:207], v[212:215], v[164:167]
    v_mfma_f32_16x16x32_bf16 v[168:171], v[204:207], v[216:219], v[168:171]
    v_mfma_f32_16x16x32_bf16 v[172:175], v[204:207], v[220:223], v[172:175]
    s_add_u32 s77, s77, 4096
    buffer_load_dwordx4 v[204:207], v2, s[16:19], s77 offen offset:0 sc1
    s_add_u32 s82, s64, s76
    buffer_load_dwordx4 v[208:211], v0, s[16:19], s82 offen sc1
    s_add_u32 s82, s65, s76
    buffer_load_dwordx4 v[212:215], v0, s[16:19], s82 offen sc1
    s_add_u32 s82, s66, s76
    buffer_load_dwordx4 v[216:219], v0, s[16:19], s82 offen sc1
    s_add_u32 s82, s69, s76
    buffer_load_dwordx4 v[220:223], v0, s[16:19], s82 offen sc1
    s_mov_b32 s38, 159748
    v_mov_b32 v6, s38
    s_mov_b32 s78, 0
lsp_84:
    ds_read_b32 v7, v6
    s_add_u32 s78, s78, 1
    s_waitcnt lgkmcnt(0)
    v_readfirstlane_b32 s83, v7
    s_cmp_gt_u32 s78, 0x40000
    s_cbranch_scc1 lso_85
    s_cmp_ge_u32 s83, 4
    s_cbranch_scc1 lso_85
    s_sleep 4
    s_branch lsp_84
lso_85:
    s_waitcnt vmcnt(27)
    v_mfma_f32_16x16x32_bf16 v[96:99], v[224:227], v[248:251], v[96:99]
    v_mfma_f32_16x16x32_bf16 v[100:103], v[224:227], v[40:43], v[100:103]
    v_mfma_f32_16x16x32_bf16 v[104:107], v[224:227], v[64:67], v[104:107]
    v_mfma_f32_16x16x32_bf16 v[108:111], v[224:227], v[68:71], v[108:111]
    v_mfma_f32_16x16x32_bf16 v[112:115], v[228:231], v[248:251], v[112:115]
    v_mfma_f32_16x16x32_bf16 v[116:119], v[228:231], v[40:43], v[116:119]
    v_mfma_f32_16x16x32_bf16 v[120:123], v[228:231], v[64:67], v[120:123]
    v_mfma_f32_16x16x32_bf16 v[124:127], v[228:231], v[68:71], v[124:127]
    v_mfma_f32_16x16x32_bf16 v[128:131], v[232:235], v[248:251], v[128:131]
    v_mfma_f32_16x16x32_bf16 v[132:135], v[232:235], v[40:43], v[132:135]
    v_mfma_f32_16x16x32_bf16 v[136:139], v[232:235], v[64:67], v[136:139]
    v_mfma_f32_16x16x32_bf16 v[140:143], v[232:235], v[68:71], v[140:143]
    v_mfma_f32_16x16x32_bf16 v[144:147], v[236:239], v[248:251], v[144:147]
    v_mfma_f32_16x16x32_bf16 v[148:151], v[236:239], v[40:43], v[148:151]
    v_mfma_f32_16x16x32_bf16 v[152:155], v[236:239], v[64:67], v[152:155]
    v_mfma_f32_16x16x32_bf16 v[156:159], v[236:239], v[68:71], v[156:159]
    v_mfma_f32_16x16x32_bf16 v[160:163], v[244:247], v[248:251], v[160:163]
    v_mfma_f32_16x16x32_bf16 v[164:167], v[244:247], v[40:43], v[164:167]
    v_mfma_f32_16x16x32_bf16 v[168:171], v[244:247], v[64:67], v[168:171]
    v_mfma_f32_16x16x32_bf16 v[172:175], v[244:247], v[68:71], v[172:175]
    s_waitcnt vmcnt(18)
    v_mfma_f32_16x16x32_bf16 v[96:99], v[44:47], v[84:87], v[96:99]
    v_mfma_f32_16x16x32_bf16 v[100:103], v[44:47], v[52:55], v[100:103]
    v_mfma_f32_16x16x32_bf16 v[104:107], v[44:47], v[56:59], v[104:107]
    v_mfma_f32_16x16x32_bf16 v[108:111], v[44:47], v[60:63], v[108:111]
    v_mfma_f32_16x16x32_bf16 v[112:115], v[72:75], v[84:87], v[112:115]
    v_mfma_f32_16x16x32_bf16 v[116:119], v[72:75], v[52:55], v[116:119]
    v_mfma_f32_16x16x32_bf16 v[120:123], v[72:75], v[56:59], v[120:123]
    v_mfma_f32_16x16x32_bf16 v[124:127], v[72:75], v[60:63], v[124:127]
    v_mfma_f32_16x16x32_bf16 v[128:131], v[76:79], v[84:87], v[128:131]
    v_mfma_f32_16x16x32_bf16 v[132:135], v[76:79], v[52:55], v[132:135]
    v_mfma_f32_16x16x32_bf16 v[136:139], v[76:79], v[56:59], v[136:139]
    v_mfma_f32_16x16x32_bf16 v[140:143], v[76:79], v[60:63], v[140:143]
    v_mfma_f32_16x16x32_bf16 v[144:147], v[48:51], v[84:87], v[144:147]
    v_mfma_f32_16x16x32_bf16 v[148:151], v[48:51], v[52:55], v[148:151]
    v_mfma_f32_16x16x32_bf16 v[152:155], v[48:51], v[56:59], v[152:155]
    v_mfma_f32_16x16x32_bf16 v[156:159], v[48:51], v[60:63], v[156:159]
    v_mfma_f32_16x16x32_bf16 v[160:163], v[80:83], v[84:87], v[160:163]
    v_mfma_f32_16x16x32_bf16 v[164:167], v[80:83], v[52:55], v[164:167]
    v_mfma_f32_16x16x32_bf16 v[168:171], v[80:83], v[56:59], v[168:171]
    v_mfma_f32_16x16x32_bf16 v[172:175], v[80:83], v[60:63], v[172:175]
    s_mov_b32 s76, 98304
    s_add_u32 s77, s33, 245760
    buffer_load_dwordx4 v[224:227], v2, s[16:19], s77 offen offset:0 sc1
    buffer_load_dwordx4 v[228:231], v2, s[16:19], s77 offen offset:1024 sc1
    buffer_load_dwordx4 v[232:235], v2, s[16:19], s77 offen offset:2048 sc1
    buffer_load_dwordx4 v[236:239], v2, s[16:19], s77 offen offset:3072 sc1
    s_add_u32 s77, s77, 4096
    buffer_load_dwordx4 v[244:247], v2, s[16:19], s77 offen offset:0 sc1
    s_add_u32 s82, s64, s76
    buffer_load_dwordx4 v[248:251], v0, s[16:19], s82 offen sc1
    s_add_u32 s82, s65, s76
    buffer_load_dwordx4 v[40:43], v0, s[16:19], s82 offen sc1
    s_add_u32 s82, s66, s76
    buffer_load_dwordx4 v[64:67], v0, s[16:19], s82 offen sc1
    s_add_u32 s82, s69, s76
    buffer_load_dwordx4 v[68:71], v0, s[16:19], s82 offen sc1
    s_mov_b32 s76, 106496
    s_add_u32 s77, s33, 266240
    buffer_load_dwordx4 v[44:47], v2, s[16:19], s77 offen offset:0 sc1
    buffer_load_dwordx4 v[72:75], v2, s[16:19], s77 offen offset:1024 sc1
    buffer_load_dwordx4 v[76:79], v2, s[16:19], s77 offen offset:2048 sc1
    buffer_load_dwordx4 v[48:51], v2, s[16:19], s77 offen offset:3072 sc1
    s_add_u32 s77, s77, 4096
    buffer_load_dwordx4 v[80:83], v2, s[16:19], s77 offen offset:0 sc1
    s_add_u32 s82, s64, s76
    buffer_load_dwordx4 v[84:87], v0, s[16:19], s82 offen sc1
    s_add_u32 s82, s65, s76
    buffer_load_dwordx4 v[52:55], v0, s[16:19], s82 offen sc1
    s_add_u32 s82, s66, s76
    buffer_load_dwordx4 v[56:59], v0, s[16:19], s82 offen sc1
    s_add_u32 s82, s69, s76
    buffer_load_dwordx4 v[60:63], v0, s[16:19], s82 offen sc1
    s_waitcnt vmcnt(27)
    v_mfma_f32_16x16x32_bf16 v[96:99], v[20:23], v[92:95], v[96:99]
    v_mfma_f32_16x16x32_bf16 v[100:103], v[20:23], v[176:179], v[100:103]
    v_mfma_f32_16x16x32_bf16 v[104:107], v[20:23], v[180:183], v[104:107]
    v_mfma_f32_16x16x32_bf16 v[108:111], v[20:23], v[184:187], v[108:111]
    s_mov_b32 s76, 114688
    s_add_u32 s77, s33, 286720
    buffer_load_dwordx4 v[20:23], v2, s[16:19], s77 offen offset:0 sc1
    v_mfma_f32_16x16x32_bf16 v[112:115], v[24:27], v[92:95], v[112:115]
    v_mfma_f32_16x16x32_bf16 v[116:119], v[24:27], v[176:179], v[116:119]
    v_mfma_f32_16x16x32_bf16 v[120:123], v[24:27], v[180:183], v[120:123]
    v_mfma_f32_16x16x32_bf16 v[124:127], v[24:27], v[184:187], v[124:127]
    buffer_load_dwordx4 v[24:27], v2, s[16:19], s77 offen offset:1024 sc1
    v_mfma_f32_16x16x32_bf16 v[128:131], v[28:31], v[92:95], v[128:131]
    v_mfma_f32_16x16x32_bf16 v[132:135], v[28:31], v[176:179], v[132:135]
    v_mfma_f32_16x16x32_bf16 v[136:139], v[28:31], v[180:183], v[136:139]
    v_mfma_f32_16x16x32_bf16 v[140:143], v[28:31], v[184:187], v[140:143]
    buffer_load_dwordx4 v[28:31], v2, s[16:19], s77 offen offset:2048 sc1
    v_mfma_f32_16x16x32_bf16 v[144:147], v[36:39], v[92:95], v[144:147]
    v_mfma_f32_16x16x32_bf16 v[148:151], v[36:39], v[176:179], v[148:151]
    v_mfma_f32_16x16x32_bf16 v[152:155], v[36:39], v[180:183], v[152:155]
    v_mfma_f32_16x16x32_bf16 v[156:159], v[36:39], v[184:187], v[156:159]
    buffer_load_dwordx4 v[36:39], v2, s[16:19], s77 offen offset:3072 sc1
    v_mfma_f32_16x16x32_bf16 v[160:163], v[88:91], v[92:95], v[160:163]
    v_mfma_f32_16x16x32_bf16 v[164:167], v[88:91], v[176:179], v[164:167]
    v_mfma_f32_16x16x32_bf16 v[168:171], v[88:91], v[180:183], v[168:171]
    v_mfma_f32_16x16x32_bf16 v[172:175], v[88:91], v[184:187], v[172:175]
    s_add_u32 s77, s77, 4096
    buffer_load_dwordx4 v[88:91], v2, s[16:19], s77 offen offset:0 sc1
    s_waitcnt vmcnt(23)
    v_mfma_f32_16x16x32_bf16 v[96:99], v[188:191], v[208:211], v[96:99]
    v_mfma_f32_16x16x32_bf16 v[100:103], v[188:191], v[212:215], v[100:103]
    v_mfma_f32_16x16x32_bf16 v[104:107], v[188:191], v[216:219], v[104:107]
    v_mfma_f32_16x16x32_bf16 v[108:111], v[188:191], v[220:223], v[108:111]
    s_mov_b32 s76, 122880
    s_add_u32 s77, s33, 307200
    buffer_load_dwordx4 v[188:191], v2, s[16:19], s77 offen offset:0 sc1
    v_mfma_f32_16x16x32_bf16 v[112:115], v[192:195], v[208:211], v[112:115]
    v_mfma_f32_16x16x32_bf16 v[116:119], v[192:195], v[212:215], v[116:119]
    v_mfma_f32_16x16x32_bf16 v[120:123], v[192:195], v[216:219], v[120:123]
    v_mfma_f32_16x16x32_bf16 v[124:127], v[192:195], v[220:223], v[124:127]
    buffer_load_dwordx4 v[192:195], v2, s[16:19], s77 offen offset:1024 sc1
    v_mfma_f32_16x16x32_bf16 v[128:131], v[196:199], v[208:211], v[128:131]
    v_mfma_f32_16x16x32_bf16 v[132:135], v[196:199], v[212:215], v[132:135]
    v_mfma_f32_16x16x32_bf16 v[136:139], v[196:199], v[216:219], v[136:139]
    v_mfma_f32_16x16x32_bf16 v[140:143], v[196:199], v[220:223], v[140:143]
    buffer_load_dwordx4 v[196:199], v2, s[16:19], s77 offen offset:2048 sc1
    v_mfma_f32_16x16x32_bf16 v[144:147], v[200:203], v[208:211], v[144:147]
    v_mfma_f32_16x16x32_bf16 v[148:151], v[200:203], v[212:215], v[148:151]
    v_mfma_f32_16x16x32_bf16 v[152:155], v[200:203], v[216:219], v[152:155]
    v_mfma_f32_16x16x32_bf16 v[156:159], v[200:203], v[220:223], v[156:159]
    buffer_load_dwordx4 v[200:203], v2, s[16:19], s77 offen offset:3072 sc1
    v_mfma_f32_16x16x32_bf16 v[160:163], v[204:207], v[208:211], v[160:163]
    v_mfma_f32_16x16x32_bf16 v[164:167], v[204:207], v[212:215], v[164:167]
    v_mfma_f32_16x16x32_bf16 v[168:171], v[204:207], v[216:219], v[168:171]
    v_mfma_f32_16x16x32_bf16 v[172:175], v[204:207], v[220:223], v[172:175]
    s_add_u32 s77, s77, 4096
    buffer_load_dwordx4 v[204:207], v2, s[16:19], s77 offen offset:0 sc1
    s_waitcnt vmcnt(19)
    s_mov_b32 s78, 0
op_86:
    v_max3_u32 v6, v248, v249, v250
    v_max3_u32 v7, v251, v40, v41
    v_max3_u32 v6, v42, v43, v6
    v_max3_u32 v7, v64, v65, v7
    v_max3_u32 v6, v66, v67, v6
    v_max3_u32 v7, v68, v69, v7
    v_max3_u32 v6, v70, v71, v6
    v_max_u32 v6, v6, v7
    v_cmp_eq_u32 vcc, -1, v6
    s_add_u32 s78, s78, 1
    s_cmp_eq_u64 vcc, 0
    s_cbranch_scc1 ok_87
    s_cmp_gt_u32 s78, 0x8000
    s_cbranch_scc1 ok_87
    s_sleep 8
    s_add_u32 s82, s64, 98304
    buffer_load_dwordx4 v[248:251], v0, s[16:19], s82 offen sc1
    s_add_u32 s82, s65, 98304
    buffer_load_dwordx4 v[40:43], v0, s[16:19], s82 offen sc1
    s_add_u32 s82, s66, 98304
    buffer_load_dwordx4 v[64:67], v0, s[16:19], s82 offen sc1
    s_add_u32 s82, s69, 98304
    buffer_load_dwordx4 v[68:71], v0, s[16:19], s82 offen sc1
    s_waitcnt vmcnt(0)
    s_branch op_86
ok_87:
    v_mfma_f32_16x16x32_bf16 v[96:99], v[224:227], v[248:251], v[96:99]
    v_mfma_f32_16x16x32_bf16 v[100:103], v[224:227], v[40:43], v[100:103]
    v_mfma_f32_16x16x32_bf16 v[104:107], v[224:227], v[64:67], v[104:107]
    v_mfma_f32_16x16x32_bf16 v[108:111], v[224:227], v[68:71], v[108:111]
    s_mov_b32 s76, 131072
    s_add_u32 s77, s33, 327680
    buffer_load_dwordx4 v[224:227], v2, s[16:19], s77 offen offset:0 sc1
    v_mfma_f32_16x16x32_bf16 v[112:115], v[228:231], v[248:251], v[112:115]
    v_mfma_f32_16x16x32_bf16 v[116:119], v[228:231], v[40:43], v[116:119]
    v_mfma_f32_16x16x32_bf16 v[120:123], v[228:231], v[64:67], v[120:123]
    v_mfma_f32_16x16x32_bf16 v[124:127], v[228:231], v[68:71], v[124:127]
    buffer_load_dwordx4 v[228:231], v2, s[16:19], s77 offen offset:1024 sc1
    v_mfma_f32_16x16x32_bf16 v[128:131], v[232:235], v[248:251], v[128:131]
    v_mfma_f32_16x16x32_bf16 v[132:135], v[232:235], v[40:43], v[132:135]
    v_mfma_f32_16x16x32_bf16 v[136:139], v[232:235], v[64:67], v[136:139]
    v_mfma_f32_16x16x32_bf16 v[140:143], v[232:235], v[68:71], v[140:143]
    buffer_load_dwordx4 v[232:235], v2, s[16:19], s77 offen offset:2048 sc1
    v_mfma_f32_16x16x32_bf16 v[144:147], v[236:239], v[248:251], v[144:147]
    v_mfma_f32_16x16x32_bf16 v[148:151], v[236:239], v[40:43], v[148:151]
    v_mfma_f32_16x16x32_bf16 v[152:155], v[236:239], v[64:67], v[152:155]
    v_mfma_f32_16x16x32_bf16 v[156:159], v[236:239], v[68:71], v[156:159]
    buffer_load_dwordx4 v[236:239], v2, s[16:19], s77 offen offset:3072 sc1
    v_mfma_f32_16x16x32_bf16 v[160:163], v[244:247], v[248:251], v[160:163]
    v_mfma_f32_16x16x32_bf16 v[164:167], v[244:247], v[40:43], v[164:167]
    v_mfma_f32_16x16x32_bf16 v[168:171], v[244:247], v[64:67], v[168:171]
    v_mfma_f32_16x16x32_bf16 v[172:175], v[244:247], v[68:71], v[172:175]
    s_add_u32 s77, s77, 4096
    buffer_load_dwordx4 v[244:247], v2, s[16:19], s77 offen offset:0 sc1
    s_waitcnt vmcnt(15)
    s_mov_b32 s78, 0
op_88:
    v_max3_u32 v6, v84, v85, v86
    v_max3_u32 v7, v87, v52, v53
    v_max3_u32 v6, v54, v55, v6
    v_max3_u32 v7, v56, v57, v7
    v_max3_u32 v6, v58, v59, v6
    v_max3_u32 v7, v60, v61, v7
    v_max3_u32 v6, v62, v63, v6
    v_max_u32 v6, v6, v7
    v_cmp_eq_u32 vcc, -1, v6
    s_add_u32 s78, s78, 1
    s_cmp_eq_u64 vcc, 0
    s_cbranch_scc1 ok_89
    s_cmp_gt_u32 s78, 0x8000
    s_cbranch_scc1 ok_89
    s_sleep 8
    s_add_u32 s82, s64, 106496
    buffer_load_dwordx4 v[84:87], v0, s[16:19], s82 offen sc1
    s_add_u32 s82, s65, 106496
    buffer_load_dwordx4 v[52:55], v0, s[16:19], s82 offen sc1
    s_add_u32 s82, s66, 106496
    buffer_load_dwordx4 v[56:59], v0, s[16:19], s82 offen sc1
    s_add_u32 s82, s69, 106496
    buffer_load_dwordx4 v[60:63], v0, s[16:19], s82 offen sc1
    s_waitcnt vmcnt(0)
    s_branch op_88
ok_89:
    v_mfma_f32_16x16x32_bf16 v[96:99], v[44:47], v[84:87], v[96:99]
    v_mfma_f32_16x16x32_bf16 v[100:103], v[44:47], v[52:55], v[100:103]
    v_mfma_f32_16x16x32_bf16 v[104:107], v[44:47], v[56:59], v[104:107]
    v_mfma_f32_16x16x32_bf16 v[108:111], v[44:47], v[60:63], v[108:111]
    v_mfma_f32_16x16x32_bf16 v[112:115], v[72:75], v[84:87], v[112:115]
    v_mfma_f32_16x16x32_bf16 v[116:119], v[72:75], v[52:55], v[116:119]
    v_mfma_f32_16x16x32_bf16 v[120:123], v[72:75], v[56:59], v[120:123]
    v_mfma_f32_16x16x32_bf16 v[124:127], v[72:75], v[60:63], v[124:127]
    v_mfma_f32_16x16x32_bf16 v[128:131], v[76:79], v[84:87], v[128:131]
    v_mfma_f32_16x16x32_bf16 v[132:135], v[76:79], v[52:55], v[132:135]
    v_mfma_f32_16x16x32_bf16 v[136:139], v[76:79], v[56:59], v[136:139]
    v_mfma_f32_16x16x32_bf16 v[140:143], v[76:79], v[60:63], v[140:143]
    v_mfma_f32_16x16x32_bf16 v[144:147], v[48:51], v[84:87], v[144:147]
    v_mfma_f32_16x16x32_bf16 v[148:151], v[48:51], v[52:55], v[148:151]
    v_mfma_f32_16x16x32_bf16 v[152:155], v[48:51], v[56:59], v[152:155]
    v_mfma_f32_16x16x32_bf16 v[156:159], v[48:51], v[60:63], v[156:159]
    v_mfma_f32_16x16x32_bf16 v[160:163], v[80:83], v[84:87], v[160:163]
    v_mfma_f32_16x16x32_bf16 v[164:167], v[80:83], v[52:55], v[164:167]
    v_mfma_f32_16x16x32_bf16 v[168:171], v[80:83], v[56:59], v[168:171]
    v_mfma_f32_16x16x32_bf16 v[172:175], v[80:83], v[60:63], v[172:175]
    s_add_u32 s82, s64, 114688
    buffer_load_dwordx4 v[92:95], v0, s[16:19], s82 offen sc1
    s_add_u32 s82, s65, 114688
    buffer_load_dwordx4 v[176:179], v0, s[16:19], s82 offen sc1
    s_add_u32 s82, s66, 114688
    buffer_load_dwordx4 v[180:183], v0, s[16:19], s82 offen sc1
    s_add_u32 s82, s69, 114688
    buffer_load_dwordx4 v[184:187], v0, s[16:19], s82 offen sc1
    s_add_u32 s82, s64, 122880
    buffer_load_dwordx4 v[208:211], v0, s[16:19], s82 offen sc1
    s_add_u32 s82, s65, 122880
    buffer_load_dwordx4 v[212:215], v0, s[16:19], s82 offen sc1
    s_add_u32 s82, s66, 122880
    buffer_load_dwordx4 v[216:219], v0, s[16:19], s82 offen sc1
    s_add_u32 s82, s69, 122880
    buffer_load_dwordx4 v[220:223], v0, s[16:19], s82 offen sc1
    s_add_u32 s82, s64, 131072
    buffer_load_dwordx4 v[248:251], v0, s[16:19], s82 offen sc1
    s_add_u32 s82, s65, 131072
    buffer_load_dwordx4 v[40:43], v0, s[16:19], s82 offen sc1
    s_add_u32 s82, s66, 131072
    buffer_load_dwordx4 v[64:67], v0, s[16:19], s82 offen sc1
    s_add_u32 s82, s69, 131072
    buffer_load_dwordx4 v[68:71], v0, s[16:19], s82 offen sc1
    s_waitcnt vmcnt(8)
    s_mov_b32 s78, 0
op_90:
    v_max3_u32 v6, v92, v93, v94
    v_max3_u32 v7, v95, v176, v177
    v_max3_u32 v6, v178, v179, v6
    v_max3_u32 v7, v180, v181, v7
    v_max3_u32 v6, v182, v183, v6
    v_max3_u32 v7, v184, v185, v7
    v_max3_u32 v6, v186, v187, v6
    v_max_u32 v6, v6, v7
    v_cmp_eq_u32 vcc, -1, v6
    s_add_u32 s78, s78, 1
    s_cmp_eq_u64 vcc, 0
    s_cbranch_scc1 ok_91
    s_cmp_gt_u32 s78, 0x8000
    s_cbranch_scc1 ok_91
    s_sleep 8
    s_add_u32 s82, s64, 114688
    buffer_load_dwordx4 v[92:95], v0, s[16:19], s82 offen sc1
    s_add_u32 s82, s65, 114688
    buffer_load_dwordx4 v[176:179], v0, s[16:19], s82 offen sc1
    s_add_u32 s82, s66, 114688
    buffer_load_dwordx4 v[180:183], v0, s[16:19], s82 offen sc1
    s_add_u32 s82, s69, 114688
    buffer_load_dwordx4 v[184:187], v0, s[16:19], s82 offen sc1
    s_add_u32 s82, s64, 122880
    buffer_load_dwordx4 v[208:211], v0, s[16:19], s82 offen sc1
    s_add_u32 s82, s65, 122880
    buffer_load_dwordx4 v[212:215], v0, s[16:19], s82 offen sc1
    s_add_u32 s82, s66, 122880
    buffer_load_dwordx4 v[216:219], v0, s[16:19], s82 offen sc1
    s_add_u32 s82, s69, 122880
    buffer_load_dwordx4 v[220:223], v0, s[16:19], s82 offen sc1
    s_add_u32 s82, s64, 131072
    buffer_load_dwordx4 v[248:251], v0, s[16:19], s82 offen sc1
    s_add_u32 s82, s65, 131072
    buffer_load_dwordx4 v[40:43], v0, s[16:19], s82 offen sc1
    s_add_u32 s82, s66, 131072
    buffer_load_dwordx4 v[64:67], v0, s[16:19], s82 offen sc1
    s_add_u32 s82, s69, 131072
    buffer_load_dwordx4 v[68:71], v0, s[16:19], s82 offen sc1
    s_waitcnt vmcnt(8)
    s_branch op_90
ok_91:
    v_mfma_f32_16x16x32_bf16 v[96:99], v[20:23], v[92:95], v[96:99]
    v_mfma_f32_16x16x32_bf16 v[100:103], v[20:23], v[176:179], v[100:103]
    v_mfma_f32_16x16x32_bf16 v[104:107], v[20:23], v[180:183], v[104:107]
    v_mfma_f32_16x16x32_bf16 v[108:111], v[20:23], v[184:187], v[108:111]
    v_mfma_f32_16x16x32_bf16 v[112:115], v[24:27], v[92:95], v[112:115]
    v_mfma_f32_16x16x32_bf16 v[116:119], v[24:27], v[176:179], v[116:119]
    v_mfma_f32_16x16x32_bf16 v[120:123], v[24:27], v[180:183], v[120:123]
    v_mfma_f32_16x16x32_bf16 v[124:127], v[24:27], v[184:187], v[124:127]
    v_mfma_f32_16x16x32_bf16 v[128:131], v[28:31], v[92:95], v[128:131]
    v_mfma_f32_16x16x32_bf16 v[132:135], v[28:31], v[176:179], v[132:135]
    v_mfma_f32_16x16x32_bf16 v[136:139], v[28:31], v[180:183], v[136:139]
    v_mfma_f32_16x16x32_bf16 v[140:143], v[28:31], v[184:187], v[140:143]
    v_mfma_f32_16x16x32_bf16 v[144:147], v[36:39], v[92:95], v[144:147]
    v_mfma_f32_16x16x32_bf16 v[148:151], v[36:39], v[176:179], v[148:151]
    v_mfma_f32_16x16x32_bf16 v[152:155], v[36:39], v[180:183], v[152:155]
    v_mfma_f32_16x16x32_bf16 v[156:159], v[36:39], v[184:187], v[156:159]
    v_mfma_f32_16x16x32_bf16 v[160:163], v[88:91], v[92:95], v[160:163]
    v_mfma_f32_16x16x32_bf16 v[164:167], v[88:91], v[176:179], v[164:167]
    v_mfma_f32_16x16x32_bf16 v[168:171], v[88:91], v[180:183], v[168:171]
    v_mfma_f32_16x16x32_bf16 v[172:175], v[88:91], v[184:187], v[172:175]
    s_waitcnt vmcnt(4)
    s_mov_b32 s78, 0
op_92:
    v_max3_u32 v6, v208, v209, v210
    v_max3_u32 v7, v211, v212, v213
    v_max3_u32 v6, v214, v215, v6
    v_max3_u32 v7, v216, v217, v7
    v_max3_u32 v6, v218, v219, v6
    v_max3_u32 v7, v220, v221, v7
    v_max3_u32 v6, v222, v223, v6
    v_max_u32 v6, v6, v7
    v_cmp_eq_u32 vcc, -1, v6
    s_add_u32 s78, s78, 1
    s_cmp_eq_u64 vcc, 0
    s_cbranch_scc1 ok_93
    s_cmp_gt_u32 s78, 0x8000
    s_cbranch_scc1 ok_93
    s_sleep 8
    s_add_u32 s82, s64, 122880
    buffer_load_dwordx4 v[208:211], v0, s[16:19], s82 offen sc1
    s_add_u32 s82, s65, 122880
    buffer_load_dwordx4 v[212:215], v0, s[16:19], s82 offen sc1
    s_add_u32 s82, s66, 122880
    buffer_load_dwordx4 v[216:219], v0, s[16:19], s82 offen sc1
    s_add_u32 s82, s69, 122880
    buffer_load_dwordx4 v[220:223], v0, s[16:19], s82 offen sc1
    s_add_u32 s82, s64, 131072
    buffer_load_dwordx4 v[248:251], v0, s[16:19], s82 offen sc1
    s_add_u32 s82, s65, 131072
    buffer_load_dwordx4 v[40:43], v0, s[16:19], s82 offen sc1
    s_add_u32 s82, s66, 131072
    buffer_load_dwordx4 v[64:67], v0, s[16:19], s82 offen sc1
    s_add_u32 s82, s69, 131072
    buffer_load_dwordx4 v[68:71], v0, s[16:19], s82 offen sc1
    s_waitcnt vmcnt(4)
    s_branch op_92
ok_93:
    v_mfma_f32_16x16x32_bf16 v[96:99], v[188:191], v[208:211], v[96:99]
    v_mfma_f32_16x16x32_bf16 v[100:103], v[188:191], v[212:215], v[100:103]
    v_mfma_f32_16x16x32_bf16 v[104:107], v[188:191], v[216:219], v[104:107]
    v_mfma_f32_16x16x32_bf16 v[108:111], v[188:191], v[220:223], v[108:111]
    v_mfma_f32_16x16x32_bf16 v[112:115], v[192:195], v[208:211], v[112:115]
    v_mfma_f32_16x16x32_bf16 v[116:119], v[192:195], v[212:215], v[116:119]
    v_mfma_f32_16x16x32_bf16 v[120:123], v[192:195], v[216:219], v[120:123]
    v_mfma_f32_16x16x32_bf16 v[124:127], v[192:195], v[220:223], v[124:127]
    v_mfma_f32_16x16x32_bf16 v[128:131], v[196:199], v[208:211], v[128:131]
    v_mfma_f32_16x16x32_bf16 v[132:135], v[196:199], v[212:215], v[132:135]
    v_mfma_f32_16x16x32_bf16 v[136:139], v[196:199], v[216:219], v[136:139]
    v_mfma_f32_16x16x32_bf16 v[140:143], v[196:199], v[220:223], v[140:143]
    v_mfma_f32_16x16x32_bf16 v[144:147], v[200:203], v[208:211], v[144:147]
    v_mfma_f32_16x16x32_bf16 v[148:151], v[200:203], v[212:215], v[148:151]
    v_mfma_f32_16x16x32_bf16 v[152:155], v[200:203], v[216:219], v[152:155]
    v_mfma_f32_16x16x32_bf16 v[156:159], v[200:203], v[220:223], v[156:159]
    v_mfma_f32_16x16x32_bf16 v[160:163], v[204:207], v[208:211], v[160:163]
    v_mfma_f32_16x16x32_bf16 v[164:167], v[204:207], v[212:215], v[164:167]
    v_mfma_f32_16x16x32_bf16 v[168:171], v[204:207], v[216:219], v[168:171]
    v_mfma_f32_16x16x32_bf16 v[172:175], v[204:207], v[220:223], v[172:175]
    s_waitcnt vmcnt(0)
    s_mov_b32 s78, 0
op_94:
    v_max3_u32 v6, v248, v249, v250
    v_max3_u32 v7, v251, v40, v41
    v_max3_u32 v6, v42, v43, v6
    v_max3_u32 v7, v64, v65, v7
    v_max3_u32 v6, v66, v67, v6
    v_max3_u32 v7, v68, v69, v7
    v_max3_u32 v6, v70, v71, v6
    v_max_u32 v6, v6, v7
    v_cmp_eq_u32 vcc, -1, v6
    s_add_u32 s78, s78, 1
    s_cmp_eq_u64 vcc, 0
    s_cbranch_scc1 ok_95
    s_cmp_gt_u32 s78, 0x8000
    s_cbranch_scc1 ok_95
    s_sleep 8
    s_add_u32 s82, s64, 131072
    buffer_load_dwordx4 v[248:251], v0, s[16:19], s82 offen sc1
    s_add_u32 s82, s65, 131072
    buffer_load_dwordx4 v[40:43], v0, s[16:19], s82 offen sc1
    s_add_u32 s82, s66, 131072
    buffer_load_dwordx4 v[64:67], v0, s[16:19], s82 offen sc1
    s_add_u32 s82, s69, 131072
    buffer_load_dwordx4 v[68:71], v0, s[16:19], s82 offen sc1
    s_waitcnt vmcnt(0)
    s_branch op_94
ok_95:
    v_mfma_f32_16x16x32_bf16 v[96:99], v[224:227], v[248:251], v[96:99]
    v_mfma_f32_16x16x32_bf16 v[100:103], v[224:227], v[40:43], v[100:103]
    v_mfma_f32_16x16x32_bf16 v[104:107], v[224:227], v[64:67], v[104:107]
    v_mfma_f32_16x16x32_bf16 v[108:111], v[224:227], v[68:71], v[108:111]
    v_mfma_f32_16x16x32_bf16 v[112:115], v[228:231], v[248:251], v[112:115]
    v_mfma_f32_16x16x32_bf16 v[116:119], v[228:231], v[40:43], v[116:119]
    v_mfma_f32_16x16x32_bf16 v[120:123], v[228:231], v[64:67], v[120:123]
    v_mfma_f32_16x16x32_bf16 v[124:127], v[228:231], v[68:71], v[124:127]
    v_mfma_f32_16x16x32_bf16 v[128:131], v[232:235], v[248:251], v[128:131]
    v_mfma_f32_16x16x32_bf16 v[132:135], v[232:235], v[40:43], v[132:135]
    v_mfma_f32_16x16x32_bf16 v[136:139], v[232:235], v[64:67], v[136:139]
    v_mfma_f32_16x16x32_bf16 v[140:143], v[232:235], v[68:71], v[140:143]
    v_mfma_f32_16x16x32_bf16 v[144:147], v[236:239], v[248:251], v[144:147]
    v_mfma_f32_16x16x32_bf16 v[148:151], v[236:239], v[40:43], v[148:151]
    v_mfma_f32_16x16x32_bf16 v[152:155], v[236:239], v[64:67], v[152:155]
    v_mfma_f32_16x16x32_bf16 v[156:159], v[236:239], v[68:71], v[156:159]
    v_mfma_f32_16x16x32_bf16 v[160:163], v[244:247], v[248:251], v[160:163]
    v_mfma_f32_16x16x32_bf16 v[164:167], v[244:247], v[40:43], v[164:167]
    v_mfma_f32_16x16x32_bf16 v[168:171], v[244:247], v[64:67], v[168:171]
    v_mfma_f32_16x16x32_bf16 v[172:175], v[244:247], v[68:71], v[172:175]
    s_nop 3
    s_add_u32 s36, s28, 1
    s_and_b32 s36, s36, 3
    s_mul_i32 s36, s36, 15360
    s_add_u32 s36, s36, 0
    v_add_u32 v6, s36, v2
    ds_write_b128 v6, v[100:103] offset:0
    ds_write_b128 v6, v[116:119] offset:1024
    ds_write_b128 v6, v[132:135] offset:2048
    ds_write_b128 v6, v[148:151] offset:3072
    ds_write_b128 v6, v[164:167] offset:4096
    s_add_u32 s36, s28, 2
    s_and_b32 s36, s36, 3
    s_mul_i32 s36, s36, 15360
    s_add_u32 s36, s36, 5120
    v_add_u32 v6, s36, v2
    ds_write_b128 v6, v[104:107] offset:0
    ds_write_b128 v6, v[120:123] offset:1024
    ds_write_b128 v6, v[136:139] offset:2048
    ds_write_b128 v6, v[152:155] offset:3072
    ds_write_b128 v6, v[168:171] offset:4096
    s_add_u32 s36, s28, 3
    s_and_b32 s36, s36, 3
    s_mul_i32 s36, s36, 15360
    s_add_u32 s36, s36, 10240
    v_add_u32 v6, s36, v2
    ds_write_b128 v6, v[108:111] offset:0
    ds_write_b128 v6, v[124:127] offset:1024
    ds_write_b128 v6, v[140:143] offset:2048
    ds_write_b128 v6, v[156:159] offset:3072
    ds_write_b128 v6, v[172:175] offset:4096
    s_mul_i32 s36, s28, 15360
    s_add_u32 s36, s36, 0
    v_add_u32 v6, s36, v2
    v_lshlrev_b32 v8, 16, v16
    v_and_b32 v9, 0xffff0000, v16
    v_pk_add_f32 v[96:97], v[96:97], v[8:9]
    v_lshlrev_b32 v8, 16, v17
    v_and_b32 v9, 0xffff0000, v17
    v_pk_add_f32 v[98:99], v[98:99], v[8:9]
    v_lshlrev_b32 v8, 16, v18
    v_and_b32 v9, 0xffff0000, v18
    v_pk_add_f32 v[112:113], v[112:113], v[8:9]
    v_lshlrev_b32 v8, 16, v19
    v_and_b32 v9, 0xffff0000, v19
    v_pk_add_f32 v[114:115], v[114:115], v[8:9]
    v_lshlrev_b32 v8, 16, v32
    v_and_b32 v9, 0xffff0000, v32
    v_pk_add_f32 v[128:129], v[128:129], v[8:9]
    v_lshlrev_b32 v8, 16, v33
    v_and_b32 v9, 0xffff0000, v33
    v_pk_add_f32 v[130:131], v[130:131], v[8:9]
    v_lshlrev_b32 v8, 16, v34
    v_and_b32 v9, 0xffff0000, v34
    v_pk_add_f32 v[144:145], v[144:145], v[8:9]
    v_lshlrev_b32 v8, 16, v35
    v_and_b32 v9, 0xffff0000, v35
    v_pk_add_f32 v[146:147], v[146:147], v[8:9]
    v_lshlrev_b32 v8, 16, v252
    v_and_b32 v9, 0xffff0000, v252
    v_pk_add_f32 v[160:161], v[160:161], v[8:9]
    v_lshlrev_b32 v8, 16, v253
    v_and_b32 v9, 0xffff0000, v253
    v_pk_add_f32 v[162:163], v[162:163], v[8:9]
    s_waitcnt lgkmcnt(0)
    s_barrier
    ds_read_b128 v[36:39], v6 offset:0
    ds_read_b128 v[40:43], v6 offset:5120
    ds_read_b128 v[44:47], v6 offset:10240
    ds_read_b128 v[48:51], v6 offset:1024
    ds_read_b128 v[52:55], v6 offset:6144
    ds_read_b128 v[56:59], v6 offset:11264
    ds_read_b128 v[60:63], v6 offset:2048
    ds_read_b128 v[64:67], v6 offset:7168
    ds_read_b128 v[68:71], v6 offset:12288
    ds_read_b128 v[72:75], v6 offset:3072
    ds_read_b128 v[76:79], v6 offset:8192
    ds_read_b128 v[80:83], v6 offset:13312
    ds_read_b128 v[84:87], v6 offset:4096
    ds_read_b128 v[88:91], v6 offset:9216
    ds_read_b128 v[92:95], v6 offset:14336
    s_waitcnt lgkmcnt(12)
    v_pk_add_f32 v[96:97], v[96:97], v[36:37]
    v_pk_add_f32 v[98:99], v[98:99], v[38:39]
    v_pk_add_f32 v[96:97], v[96:97], v[40:41]
    v_pk_add_f32 v[98:99], v[98:99], v[42:43]
    v_pk_add_f32 v[96:97], v[96:97], v[44:45]
    v_pk_add_f32 v[98:99], v[98:99], v[46:47]
    v_cvt_pk_bf16_f32 v96, v96, v97
    v_cvt_pk_bf16_f32 v97, v98, v99
    buffer_store_dwordx2 v[96:97], v10, s[24:27], 0 offen offset:0
    s_waitcnt lgkmcnt(9)
    v_pk_add_f32 v[112:113], v[112:113], v[48:49]
    v_pk_add_f32 v[114:115], v[114:115], v[50:51]
    v_pk_add_f32 v[112:113], v[112:113], v[52:53]
    v_pk_add_f32 v[114:115], v[114:115], v[54:55]
    v_pk_add_f32 v[112:113], v[112:113], v[56:57]
    v_pk_add_f32 v[114:115], v[114:115], v[58:59]
    v_cvt_pk_bf16_f32 v112, v112, v113
    v_cvt_pk_bf16_f32 v113, v114, v115
    buffer_store_dwordx2 v[112:113], v10, s[24:27], 0 offen offset:32
    s_waitcnt lgkmcnt(6)
    v_pk_add_f32 v[128:129], v[128:129], v[60:61]
    v_pk_add_f32 v[130:131], v[130:131], v[62:63]
    v_pk_add_f32 v[128:129], v[128:129], v[64:65]
    v_pk_add_f32 v[130:131], v[130:131], v[66:67]
    v_pk_add_f32 v[128:129], v[128:129], v[68:69]
    v_pk_add_f32 v[130:131], v[130:131], v[70:71]
    v_cvt_pk_bf16_f32 v128, v128, v129
    v_cvt_pk_bf16_f32 v129, v130, v131
    buffer_store_dwordx2 v[128:129], v10, s[24:27], 0 offen offset:64
    s_waitcnt lgkmcnt(3)
    v_pk_add_f32 v[144:145], v[144:145], v[72:73]
    v_pk_add_f32 v[146:147], v[146:147], v[74:75]
    v_pk_add_f32 v[144:145], v[144:145], v[76:77]
    v_pk_add_f32 v[146:147], v[146:147], v[78:79]
    v_pk_add_f32 v[144:145], v[144:145], v[80:81]
    v_pk_add_f32 v[146:147], v[146:147], v[82:83]
    v_cvt_pk_bf16_f32 v144, v144, v145
    v_cvt_pk_bf16_f32 v145, v146, v147
    buffer_store_dwordx2 v[144:145], v10, s[24:27], 0 offen offset:96
    s_waitcnt lgkmcnt(0)
    v_pk_add_f32 v[160:161], v[160:161], v[84:85]
    v_pk_add_f32 v[162:163], v[162:163], v[86:87]
    v_pk_add_f32 v[160:161], v[160:161], v[88:89]
    v_pk_add_f32 v[162:163], v[162:163], v[90:91]
    v_pk_add_f32 v[160:161], v[160:161], v[92:93]
    v_pk_add_f32 v[162:163], v[162:163], v[94:95]
    v_cvt_pk_bf16_f32 v160, v160, v161
    v_cvt_pk_bf16_f32 v161, v162, v163
    buffer_store_dwordx2 v[160:161], v10, s[24:27], 0 offen offset:128
k_end:
    s_endpgm
.section .rodata,"a"
.p2align 6
.amdhsa_kernel parallel_sum__grouped_kv_mqa__swiglu_ffn__prompt_kernel
  .amdhsa_next_free_vgpr 256
  .amdhsa_next_free_sgpr 102
  .amdhsa_accum_offset 256
  .amdhsa_group_segment_fixed_size 0
  .amdhsa_kernarg_size 96
  .amdhsa_user_sgpr_count 2
  .amdhsa_user_sgpr_kernarg_segment_ptr 1
  .amdhsa_system_sgpr_workgroup_id_x 1
.end_amdhsa_kernel
```
